```python
import torch

def _softmax(x, axis=-1):
    return torch.softmax(x, dim=axis)
def _gelu(x):
    return torch.nn.functional.gelu(x, approximate="tanh")
def _silu(x):
    return torch.nn.functional.silu(x)
def _sigmoid(x):
    return torch.sigmoid(x)
def _layernorm(x, axis=-1, eps=1e-5):
    m = x.mean(dim=axis, keepdim=True)
    v = x.var(dim=axis, keepdim=True, unbiased=False)
    return (x - m) / torch.sqrt(v + eps)
def _scatter_add(tgt, idx, src, axis=0):
    return tgt.clone().index_add_(axis, idx, src)
def _segment_sum(src, seg, n):
    out = torch.zeros((n,) + src.shape[1:], dtype=src.dtype)
    return out.index_add_(0, seg, src)
def _pad(x, pw):
    flat = tuple(v for pair in reversed(pw) for v in pair)
    return torch.nn.functional.pad(x, flat)

kernel_name = 'recurrent_scan__ssm_conv_s4d__dense_activation_silu__prompt'

def setup_inputs():

    _w = (lambda a: (lambda t: t.to(torch.bfloat16) if t.is_floating_point() else t)(torch.as_tensor(a)))
    def _A_setup():
        Bsz, L, D, N = 1, 2048, 576, 128
        return {
            "u": _w((lambda *s: torch.randn(*s, dtype=torch.bfloat16) * 0.05)(Bsz, L, D)),
            "log_A_real": _w((lambda *s: torch.randn(*s, dtype=torch.bfloat16) * 6.4)(D, N) * 0.5),
            "A_imag": _w((lambda *s: torch.randn(*s, dtype=torch.bfloat16) * 0.2)(D, N) * 3.14),
            "C_real": _w((lambda *s: torch.randn(*s, dtype=torch.bfloat16) * 0.4)(D, N) / N ** 0.5),
            "C_imag": _w((lambda *s: torch.randn(*s, dtype=torch.bfloat16) * 0.4)(D, N) / N ** 0.5),
            "log_dt": _w((lambda *s: torch.randn(*s, dtype=torch.bfloat16) * 0.2)(D) * 0.5 - 4.0),
            "D_skip": _w((lambda *s: torch.randn(*s, dtype=torch.bfloat16) * 0.2)(D)),
        }
    _A_in = _A_setup()

    def _B_setup():
        B, S, D, F = 1, 2048, 576, 4608
        return {
            "x": _w((lambda *s: torch.randn(*s, dtype=torch.bfloat16) * 0.05)(B, S, D)),
            "w1": _w((lambda *s: torch.randn(*s, dtype=torch.bfloat16) * 0.8)(D, F) * (D ** -0.5)),
            "w2": _w((lambda *s: torch.randn(*s, dtype=torch.bfloat16) * 0.1)(F, D) * (F ** -0.5)),
        }
    _B_in = _B_setup()

    return {
        "A_u": _A_in["u"],
        "A_log_A_real": _A_in["log_A_real"],
        "A_A_imag": _A_in["A_imag"],
        "A_C_real": _A_in["C_real"],
        "A_C_imag": _A_in["C_imag"],
        "A_log_dt": _A_in["log_dt"],
        "A_D_skip": _A_in["D_skip"],
        "B_x": _B_in["x"],
        "B_w1": _B_in["w1"],
        "B_w2": _B_in["w2"],
    }

def reference(A_u, A_log_A_real, A_A_imag, A_C_real, A_C_imag, A_log_dt, A_D_skip, B_x, B_w1, B_w2):
    def _A_ref(u, log_A_real, A_imag, C_real, C_imag, log_dt, D_skip):
        L = u.shape[1]
        dt = torch.exp(log_dt)
        A = -torch.exp(log_A_real) + 1j * A_imag
        C = (C_real + 1j * C_imag) * dt[:, None]
        pos = (lambda x, dt: x.to(dt))(torch.arange(L), log_dt.dtype)
        P = torch.exp((A * dt[:, None])[:, :, None] * pos[None, None, :])
        K = 2.0 * torch.einsum("dn,dnl->dl", C, P).real
        L2 = 2 * L
        u_t = (lambda x, *d: x.permute(*d))(u, 0, 2, 1)
        Kf = (lambda x, *a, **k: torch.fft.rfft(x.float(), *a, **k))(K, L2)
        Uf = (lambda x, *a, **k: torch.fft.rfft(x.float(), *a, **k))(u_t, L2)
        y = (lambda x, *a, **k: torch.fft.irfft(x, *a, **k).to(torch.bfloat16))(Uf * Kf[None, :, :], L2)[:, :, :L]
        y = (lambda x, *d: x.permute(*d))(y, 0, 2, 1)
        return y + u * D_skip[None, None, :]

    def _B_ref(x, w1, w2):
        h = torch.einsum("bsd,df->bsf", x, w1)
        h = _silu(h)
        out = torch.einsum("bsf,fd->bsd", h, w2)
        return out

    x = A_u
    xn = _layernorm(x, axis=-1)
    s = _A_ref(xn, A_log_A_real, A_A_imag, A_C_real, A_C_imag, A_log_dt, A_D_skip)
    g = _silu(_B_ref(xn, B_w1, B_w2))
    return x + s * g
```

```asm
; @launch grid=(256,1,1) block=(256,1,1) lds=163840
.amdgcn_target "amdgcn-amd-amdhsa--gfx950"
.text
.globl recurrent_scan__ssm_conv_s4d__dense_activation_silu__prompt_kernel
.p2align 8
.type recurrent_scan__ssm_conv_s4d__dense_activation_silu__prompt_kernel,@function
recurrent_scan__ssm_conv_s4d__dense_activation_silu__prompt_kernel:
    s_cmp_ge_u32 s2, 256
    s_cbranch_scc1 L_end
L_code_begin:
    s_cmp_ge_u32 s2, 192
    s_cbranch_scc1 L_conv
    s_load_dwordx2 s[4:5], s[0:1], 0
    s_load_dwordx2 s[8:9], s[0:1], 64
    s_load_dwordx2 s[12:13], s[0:1], 72
    s_load_dwordx2 s[16:17], s[0:1], 96
    s_load_dwordx2 s[56:57], s[0:1], 80
    s_load_dwordx2 s[60:61], s[0:1], 48
    s_and_b32 s36, s2, 7
    s_lshr_b32 s37, s2, 3
    s_mul_i32 s38, s37, 43
    s_lshr_b32 s38, s38, 7
    s_mul_i32 s39, s38, 3
    s_sub_u32 s49, s37, s39
    s_and_b32 s40, s36, 3
    s_mul_i32 s40, s40, 3
    s_add_u32 s21, s40, s49
    s_lshr_b32 s36, s36, 2
    s_lshl_b32 s36, s36, 3
    s_add_u32 s20, s36, s38
    v_lshrrev_b32 v144, 6, v0
    v_and_b32 v145, 63, v0
    v_mov_b32 v255, v0
    v_readfirstlane_b32 s22, v144
    v_lshrrev_b32 v146, 3, v145
    v_and_b32 v147, 7, v145
    v_lshrrev_b32 v148, 1, v146
    v_xor_b32 v147, v147, v148
    v_lshlrev_b32 v147, 4, v147
    v_mul_u32_u24 v146, 1152, v146
    v_add_u32 v184, v146, v147
    v_xor_b32 v147, 64, v147
    v_add_u32 v185, v146, v147
    v_add_u32 v185, 8192, v185
    v_add_u32 v186, 16384, v184
    v_add_u32 v187, 16384, v185
    v_and_b32 v149, 31, v145
    v_lshrrev_b32 v150, 5, v145
    v_mul_u32_u24 v161, 1152, v149
    v_lshl_add_u32 v161, v150, 7, v161
    s_lshl_b32 s36, s20, 2
    s_add_u32 s36, s36, s22
    s_mul_i32 s37, s36, 36864
    s_lshl_b32 s38, s22, 12
    s_mul_i32 s39, s49, 384
    s_add_u32 s39, s39, s37
    s_waitcnt lgkmcnt(0)
    s_mov_b32 s6, 2359296
    s_mov_b32 s7, 0x20000
    s_load_dword s23, s[16:17], 0
    s_mul_i32 s39, s21, 24
    v_add_u32 v162, s39, v145
    v_and_b32 v163, 31, v162
    v_lshrrev_b32 v162, 5, v162
    v_mul_u32_u24 v163, 1152, v163
    v_lshl_add_u32 v162, v162, 7, v163
    s_mov_b32 exec_lo, 0xffffff
    s_mov_b32 exec_hi, 0
    buffer_load_dword a253, v162, s[4:7], s37 offen
    s_mov_b64 exec, -1
    s_add_u32 m0, s38, 0
    s_add_u32 s46, s37, 0
    buffer_load_dwordx4 v184, s[4:7], s46 offen offset:0 lds
    s_mov_b32 s10, 5308416
    s_mov_b32 s11, 0x20000
    s_mov_b32 s14, 5308416
    s_mov_b32 s15, 0x20000
    s_mov_b32 s18, 268435456
    s_mov_b32 s19, 0x20000
    s_mov_b32 s58, 2359296
    s_mov_b32 s59, 0x20000
    s_mov_b32 s62, 1152
    s_mov_b32 s63, 0x20000
    v_lshrrev_b32 v151, 3, v149
    v_lshlrev_b32 v151, 10, v151
    v_and_b32 v152, 7, v149
    v_lshlrev_b32 v152, 7, v152
    buffer_load_dwordx4 v185, s[4:7], s46 offen offset:1024 lds
    v_add_u32 v151, v151, v152
    v_add_u32 v151, s38, v151
    v_bfe_u32 v152, v149, 1, 3
    v_or_b32 v153, 0, v150
    v_xor_b32 v153, v153, v152
    v_lshl_add_u32 v188, v153, 4, v151
    v_or_b32 v153, 2, v150
    v_xor_b32 v153, v153, v152
    v_lshl_add_u32 v189, v153, 4, v151
    v_or_b32 v153, 4, v150
    v_xor_b32 v153, v153, v152
    v_lshl_add_u32 v190, v153, 4, v151
    v_or_b32 v153, 6, v150
    v_xor_b32 v153, v153, v152
    buffer_load_dwordx4 v186, s[4:7], s46 offen offset:2048 lds
    v_lshl_add_u32 v191, v153, 4, v151
    s_mul_i32 s39, s21, 3
    s_add_u32 s39, s39, 0
    s_lshr_b32 s54, s39, 2
    s_lshl_b32 s40, s54, 14
    s_and_b32 s39, s39, 3
    s_lshl_b32 s39, s39, 1
    v_or_b32 v153, s39, v150
    v_xor_b32 v153, v153, v152
    v_lshl_add_u32 v153, v153, 4, v151
    v_add_u32 v192, s40, v153
    s_mul_i32 s39, s21, 3
    s_add_u32 s39, s39, 1
    s_lshr_b32 s55, s39, 2
    buffer_load_dwordx4 v187, s[4:7], s46 offen offset:3072 lds
    s_lshl_b32 s40, s55, 14
    s_and_b32 s39, s39, 3
    s_lshl_b32 s39, s39, 1
    v_or_b32 v153, s39, v150
    v_xor_b32 v153, v153, v152
    v_lshl_add_u32 v153, v153, 4, v151
    v_add_u32 v193, s40, v153
    s_mul_i32 s39, s21, 3
    s_add_u32 s39, s39, 2
    s_lshr_b32 s43, s39, 2
    s_lshl_b32 s40, s43, 14
    s_and_b32 s39, s39, 3
    s_lshl_b32 s39, s39, 1
    v_or_b32 v153, s39, v150
    s_add_u32 m0, s38, 16384
    s_add_u32 s46, s37, 128
    buffer_load_dwordx4 v184, s[4:7], s46 offen offset:0 lds
    v_xor_b32 v153, v153, v152
    v_lshl_add_u32 v153, v153, 4, v151
    v_add_u32 v194, s40, v153
    v_bfe_u32 v153, v145, 2, 2
    v_bfe_u32 v154, v145, 4, 1
    v_and_b32 v155, 3, v145
    v_lshlrev_b32 v154, 5, v154
    v_lshl_add_u32 v154, v155, 3, v154
    v_lshrrev_b32 v155, 1, v153
    v_lshl_add_u32 v154, v155, 6, v154
    v_lshl_add_u32 v155, v150, 3, v153
    v_lshl_add_u32 v240, v155, 7, v154
    v_lshl_add_u32 v155, v150, 2, v153
    v_lshl_add_u32 v244, v155, 7, v154
    buffer_load_dwordx4 v185, s[4:7], s46 offen offset:1024 lds
    v_add_u32 v241, 36864, v240
    v_xor_b32 v242, 64, v240
    v_add_u32 v243, 36864, v242
    v_lshrrev_b32 v153, 3, v145
    v_and_b32 v154, 7, v145
    v_bfe_u32 v155, v153, 1, 1
    v_lshlrev_b32 v155, 2, v155
    v_xor_b32 v154, v154, v155
    v_lshlrev_b32 v154, 4, v154
    v_mul_u32_u24 v155, 9216, v153
    v_add_u32 v246, v155, v154
    v_mul_u32_u24 v155, 1152, v153
    v_add_u32 v250, v155, v154
    v_lshlrev_b32 v254, 4, v145
    buffer_load_dwordx4 v186, s[4:7], s46 offen offset:2048 lds
    v_add_u32 v247, 72704, v246
    v_add_u32 v251, 8192, v250
    v_add_u32 v248, 145408, v246
    v_add_u32 v252, 16384, v250
    v_add_u32 v249, 218112, v246
    v_add_u32 v253, 24576, v250
    s_mul_i32 s39, s22, 9
    s_add_u32 s39, s39, 0
    s_lshl_b32 s29, s39, 10
    s_mul_i32 s39, s39, 73728
    s_mul_i32 s40, s21, 768
    s_add_u32 s24, s39, s40
    s_mul_i32 s39, s22, 9
    s_add_u32 s39, s39, 4
    buffer_load_dwordx4 v187, s[4:7], s46 offen offset:3072 lds
    s_lshl_b32 s30, s39, 10
    s_mul_i32 s39, s39, 73728
    s_mul_i32 s40, s21, 768
    s_add_u32 s25, s39, s40
    s_mul_i32 s39, s22, 9
    s_add_u32 s39, s39, 8
    s_lshl_b32 s31, s39, 10
    s_mul_i32 s39, s39, 73728
    s_mul_i32 s40, s21, 768
    s_add_u32 s26, s39, s40
    s_mul_i32 s39, s22, 6
    s_add_u32 s39, s39, 0
    s_lshl_b32 s32, s39, 10
    s_mul_i32 s39, s39, 9216
    s_add_u32 m0, s38, 32768
    s_add_u32 s46, s37, 256
    buffer_load_dwordx4 v184, s[4:7], s46 offen offset:0 lds
    s_mul_i32 s40, s21, 442368
    s_add_u32 s27, s39, s40
    s_mul_i32 s39, s22, 6
    s_add_u32 s39, s39, 4
    s_lshl_b32 s33, s39, 10
    s_mul_i32 s39, s39, 9216
    s_mul_i32 s40, s21, 442368
    s_add_u32 s28, s39, s40
    s_lshl_b32 s39, s20, 2
    s_add_u32 s39, s39, s22
    s_mul_i32 s39, s39, 442368
    s_lshl_b32 s40, s21, 11
    s_add_u32 s39, s39, s40
    s_add_u32 s34, s39, 5242880
    buffer_load_dwordx4 v185, s[4:7], s46 offen offset:1024 lds
    v_lshlrev_b32 v158, 11, v150
    v_lshl_add_u32 v158, v149, 1, v158
    s_lshl_b32 s39, s22, 6
    s_add_u32 s39, s39, 147456
    v_add_u32 v235, s39, v158
    v_lshrrev_b32 v159, 4, v255
    v_mul_u32_u24 v159, 4224, v159
    v_and_b32 v160, 15, v255
    v_lshl_add_u32 v236, v160, 3, v159
    v_lshl_add_u32 v237, v160, 4, v159
    v_lshlrev_b32 v160, 4, v255
    v_add_u32 v238, 147456, v160
    v_lshlrev_b32 v239, 3, v149
    s_mul_i32 s50, s21, 202752
    buffer_load_dwordx4 v186, s[4:7], s46 offen offset:2048 lds
    s_add_u32 s50, s50, 65536
    s_lshl_b32 s51, s20, 8
    s_add_u32 s51, s51, s50
    s_add_u32 s51, s51, 128
    s_lshl_b32 s52, s20, 2
    s_add_u32 s52, s52, s22
    s_lshl_b32 s52, s52, 8
    s_add_u32 s52, s52, 32768
    s_lshl_b32 s39, s21, 4
    s_add_u32 s39, s39, s20
    s_lshl_b32 s39, s39, 7
    s_add_u32 s47, s39, 33554432
    s_cmp_eq_u32 s22, 0
    s_cselect_b32 s84, 1, 0
    buffer_load_dwordx4 v187, s[4:7], s46 offen offset:3072 lds
    s_mov_b32 s85, 0
    s_mov_b32 s41, 0x3f803f80
    s_mov_b32 s44, 0x3ae38e39
    v_mov_b32 v228, 0
    v_mov_b32 v229, 0
    v_lshrrev_b32 v153, 3, v149
    v_lshlrev_b32 v153, 2, v153
    v_and_b32 v154, 3, v149
    v_add_u32 v153, v153, v154
    v_bfe_u32 v154, v149, 2, 1
    v_and_b32 v155, 1, v153
    v_lshlrev_b32 v155, 4, v155
    v_mov_b32 v158, 0x3f80
    v_lshlrev_b32 v155, v155, v158
    s_add_u32 m0, s38, 49152
    s_add_u32 s46, s37, 384
    buffer_load_dwordx4 v184, s[4:7], s46 offen offset:0 lds
    v_cmp_eq_u32 vcc, v154, v150
    v_lshrrev_b32 v153, 1, v153
    s_nop 0
    v_cndmask_b32 v155, 0, v155, vcc
    v_cmp_eq_u32 vcc, 0, v153
    s_nop 1
    v_cndmask_b32 v176, 0, v155, vcc
    v_cmp_eq_u32 vcc, 1, v153
    s_nop 1
    v_cndmask_b32 v177, 0, v155, vcc
    v_cmp_eq_u32 vcc, 2, v153
    s_nop 1
    v_cndmask_b32 v178, 0, v155, vcc
    v_cmp_eq_u32 vcc, 3, v153
    s_nop 1
    v_cndmask_b32 v179, 0, v155, vcc
    v_cmp_eq_u32 vcc, 4, v153
    s_nop 1
    v_cndmask_b32 v180, 0, v155, vcc
    v_cmp_eq_u32 vcc, 5, v153
    s_nop 1
    v_cndmask_b32 v181, 0, v155, vcc
    v_cmp_eq_u32 vcc, 6, v153
    s_nop 1
    v_cndmask_b32 v182, 0, v155, vcc
    v_cmp_eq_u32 vcc, 7, v153
    s_nop 1
    v_cndmask_b32 v183, 0, v155, vcc
    v_mul_u32_u24 v153, 911, v255
    v_lshrrev_b32 v153, 16, v153
    v_mul_u32_u24 v154, 72, v153
    v_sub_u32 v154, v255, v154
    v_mul_u32_u24 v154, 9216, v154
    buffer_load_dwordx4 v185, s[4:7], s46 offen offset:1024 lds
    v_lshl_add_u32 v164, v153, 7, v154
    s_and_b32 s39, s20, 7
    s_mul_i32 s39, s39, 663552
    s_mul_i32 s40, s21, 768
    s_add_u32 s53, s39, s40
    buffer_load_dwordx4 v186, s[4:7], s46 offen offset:2048 lds
    buffer_load_dwordx4 v187, s[4:7], s46 offen offset:3072 lds
    s_add_u32 m0, s38, 65536
    s_add_u32 s46, s37, 512
    buffer_load_dwordx4 v184, s[4:7], s46 offen offset:0 lds
    buffer_load_dwordx4 v185, s[4:7], s46 offen offset:1024 lds
    buffer_load_dwordx4 v186, s[4:7], s46 offen offset:2048 lds
    buffer_load_dwordx4 v187, s[4:7], s46 offen offset:3072 lds
    s_waitcnt vmcnt(16)
    ds_read_b128 v[0:3], v188 offset:0
    ds_read_b128 v[4:7], v189 offset:0
    ds_read_b128 v[8:11], v190 offset:0
    ds_read_b128 v[12:15], v191 offset:0
    s_add_u32 m0, s38, 81920
    s_add_u32 s46, s37, 640
    buffer_load_dwordx4 v184, s[4:7], s46 offen offset:0 lds
    buffer_load_dwordx4 v185, s[4:7], s46 offen offset:1024 lds
    buffer_load_dwordx4 v186, s[4:7], s46 offen offset:2048 lds
    buffer_load_dwordx4 v187, s[4:7], s46 offen offset:3072 lds
    s_waitcnt vmcnt(16)
    ds_read_b128 v[16:19], v188 offset:16384
    ds_read_b128 v[20:23], v189 offset:16384
    ds_read_b128 v[24:27], v190 offset:16384
    ds_read_b128 v[28:31], v191 offset:16384
    s_waitcnt lgkmcnt(0)
    v_dot2c_f32_bf16 v228, s41, v0
    v_dot2c_f32_bf16 v229, v0, v0
    v_dot2c_f32_bf16 v228, s41, v1
    v_dot2c_f32_bf16 v229, v1, v1
    v_dot2c_f32_bf16 v228, s41, v2
    v_dot2c_f32_bf16 v229, v2, v2
    v_dot2c_f32_bf16 v228, s41, v3
    v_dot2c_f32_bf16 v229, v3, v3
    v_dot2c_f32_bf16 v228, s41, v4
    v_dot2c_f32_bf16 v229, v4, v4
    v_dot2c_f32_bf16 v228, s41, v5
    v_dot2c_f32_bf16 v229, v5, v5
    v_dot2c_f32_bf16 v228, s41, v6
    v_dot2c_f32_bf16 v229, v6, v6
    v_dot2c_f32_bf16 v228, s41, v7
    v_dot2c_f32_bf16 v229, v7, v7
    v_dot2c_f32_bf16 v228, s41, v8
    v_dot2c_f32_bf16 v229, v8, v8
    v_dot2c_f32_bf16 v228, s41, v9
    v_dot2c_f32_bf16 v229, v9, v9
    v_dot2c_f32_bf16 v228, s41, v10
    v_dot2c_f32_bf16 v229, v10, v10
    v_dot2c_f32_bf16 v228, s41, v11
    v_dot2c_f32_bf16 v229, v11, v11
    v_dot2c_f32_bf16 v228, s41, v12
    v_dot2c_f32_bf16 v229, v12, v12
    v_dot2c_f32_bf16 v228, s41, v13
    v_dot2c_f32_bf16 v229, v13, v13
    v_dot2c_f32_bf16 v228, s41, v14
    v_dot2c_f32_bf16 v229, v14, v14
    v_dot2c_f32_bf16 v228, s41, v15
    v_dot2c_f32_bf16 v229, v15, v15
    s_add_u32 m0, s38, 98304
    s_add_u32 s46, s37, 768
    buffer_load_dwordx4 v184, s[4:7], s46 offen offset:0 lds
    buffer_load_dwordx4 v185, s[4:7], s46 offen offset:1024 lds
    buffer_load_dwordx4 v186, s[4:7], s46 offen offset:2048 lds
    buffer_load_dwordx4 v187, s[4:7], s46 offen offset:3072 lds
    s_waitcnt vmcnt(16)
    ds_read_b128 v[32:35], v188 offset:32768
    ds_read_b128 v[36:39], v189 offset:32768
    ds_read_b128 v[40:43], v190 offset:32768
    ds_read_b128 v[44:47], v191 offset:32768
    v_dot2c_f32_bf16 v228, s41, v16
    v_dot2c_f32_bf16 v229, v16, v16
    v_dot2c_f32_bf16 v228, s41, v17
    v_dot2c_f32_bf16 v229, v17, v17
    v_dot2c_f32_bf16 v228, s41, v18
    v_dot2c_f32_bf16 v229, v18, v18
    v_dot2c_f32_bf16 v228, s41, v19
    v_dot2c_f32_bf16 v229, v19, v19
    v_dot2c_f32_bf16 v228, s41, v20
    v_dot2c_f32_bf16 v229, v20, v20
    v_dot2c_f32_bf16 v228, s41, v21
    v_dot2c_f32_bf16 v229, v21, v21
    v_dot2c_f32_bf16 v228, s41, v22
    v_dot2c_f32_bf16 v229, v22, v22
    v_dot2c_f32_bf16 v228, s41, v23
    v_dot2c_f32_bf16 v229, v23, v23
    v_dot2c_f32_bf16 v228, s41, v24
    v_dot2c_f32_bf16 v229, v24, v24
    v_dot2c_f32_bf16 v228, s41, v25
    v_dot2c_f32_bf16 v229, v25, v25
    v_dot2c_f32_bf16 v228, s41, v26
    v_dot2c_f32_bf16 v229, v26, v26
    v_dot2c_f32_bf16 v228, s41, v27
    v_dot2c_f32_bf16 v229, v27, v27
    v_dot2c_f32_bf16 v228, s41, v28
    v_dot2c_f32_bf16 v229, v28, v28
    v_dot2c_f32_bf16 v228, s41, v29
    v_dot2c_f32_bf16 v229, v29, v29
    v_dot2c_f32_bf16 v228, s41, v30
    v_dot2c_f32_bf16 v229, v30, v30
    v_dot2c_f32_bf16 v228, s41, v31
    v_dot2c_f32_bf16 v229, v31, v31
    s_add_u32 m0, s38, 114688
    s_add_u32 s46, s37, 896
    buffer_load_dwordx4 v184, s[4:7], s46 offen offset:0 lds
    buffer_load_dwordx4 v185, s[4:7], s46 offen offset:1024 lds
    buffer_load_dwordx4 v186, s[4:7], s46 offen offset:2048 lds
    buffer_load_dwordx4 v187, s[4:7], s46 offen offset:3072 lds
    s_waitcnt vmcnt(16)
    ds_read_b128 v[48:51], v188 offset:49152
    ds_read_b128 v[52:55], v189 offset:49152
    ds_read_b128 v[56:59], v190 offset:49152
    ds_read_b128 v[60:63], v191 offset:49152
    s_waitcnt lgkmcnt(7)
    v_dot2c_f32_bf16 v228, s41, v32
    v_dot2c_f32_bf16 v229, v32, v32
    v_dot2c_f32_bf16 v228, s41, v33
    v_dot2c_f32_bf16 v229, v33, v33
    v_dot2c_f32_bf16 v228, s41, v34
    v_dot2c_f32_bf16 v229, v34, v34
    v_dot2c_f32_bf16 v228, s41, v35
    v_dot2c_f32_bf16 v229, v35, v35
    s_waitcnt lgkmcnt(6)
    v_dot2c_f32_bf16 v228, s41, v36
    v_dot2c_f32_bf16 v229, v36, v36
    v_dot2c_f32_bf16 v228, s41, v37
    v_dot2c_f32_bf16 v229, v37, v37
    v_dot2c_f32_bf16 v228, s41, v38
    v_dot2c_f32_bf16 v229, v38, v38
    v_dot2c_f32_bf16 v228, s41, v39
    v_dot2c_f32_bf16 v229, v39, v39
    s_waitcnt lgkmcnt(5)
    v_dot2c_f32_bf16 v228, s41, v40
    v_dot2c_f32_bf16 v229, v40, v40
    v_dot2c_f32_bf16 v228, s41, v41
    v_dot2c_f32_bf16 v229, v41, v41
    v_dot2c_f32_bf16 v228, s41, v42
    v_dot2c_f32_bf16 v229, v42, v42
    v_dot2c_f32_bf16 v228, s41, v43
    v_dot2c_f32_bf16 v229, v43, v43
    s_waitcnt lgkmcnt(4)
    v_dot2c_f32_bf16 v228, s41, v44
    v_dot2c_f32_bf16 v229, v44, v44
    v_dot2c_f32_bf16 v228, s41, v45
    v_dot2c_f32_bf16 v229, v45, v45
    v_dot2c_f32_bf16 v228, s41, v46
    v_dot2c_f32_bf16 v229, v46, v46
    v_dot2c_f32_bf16 v228, s41, v47
    v_dot2c_f32_bf16 v229, v47, v47
    s_add_u32 m0, s38, 131072
    s_add_u32 s46, s37, 1024
    buffer_load_dwordx4 v184, s[4:7], s46 offen offset:0 lds
    buffer_load_dwordx4 v185, s[4:7], s46 offen offset:1024 lds
    buffer_load_dwordx4 v186, s[4:7], s46 offen offset:2048 lds
    buffer_load_dwordx4 v187, s[4:7], s46 offen offset:3072 lds
    s_waitcnt vmcnt(16)
    v_add_u32 v188, 0x10000, v188
    v_add_u32 v189, 0x10000, v189
    v_add_u32 v190, 0x10000, v190
    v_add_u32 v191, 0x10000, v191
    ds_read_b128 v[64:67], v188 offset:0
    ds_read_b128 v[68:71], v189 offset:0
    ds_read_b128 v[72:75], v190 offset:0
    ds_read_b128 v[76:79], v191 offset:0
    s_waitcnt lgkmcnt(7)
    v_dot2c_f32_bf16 v228, s41, v48
    v_dot2c_f32_bf16 v229, v48, v48
    v_dot2c_f32_bf16 v228, s41, v49
    v_dot2c_f32_bf16 v229, v49, v49
    v_dot2c_f32_bf16 v228, s41, v50
    v_dot2c_f32_bf16 v229, v50, v50
    v_dot2c_f32_bf16 v228, s41, v51
    v_dot2c_f32_bf16 v229, v51, v51
    s_waitcnt lgkmcnt(6)
    v_dot2c_f32_bf16 v228, s41, v52
    v_dot2c_f32_bf16 v229, v52, v52
    v_dot2c_f32_bf16 v228, s41, v53
    v_dot2c_f32_bf16 v229, v53, v53
    v_dot2c_f32_bf16 v228, s41, v54
    v_dot2c_f32_bf16 v229, v54, v54
    v_dot2c_f32_bf16 v228, s41, v55
    v_dot2c_f32_bf16 v229, v55, v55
    s_waitcnt lgkmcnt(5)
    v_dot2c_f32_bf16 v228, s41, v56
    v_dot2c_f32_bf16 v229, v56, v56
    v_dot2c_f32_bf16 v228, s41, v57
    v_dot2c_f32_bf16 v229, v57, v57
    v_dot2c_f32_bf16 v228, s41, v58
    v_dot2c_f32_bf16 v229, v58, v58
    v_dot2c_f32_bf16 v228, s41, v59
    v_dot2c_f32_bf16 v229, v59, v59
    s_waitcnt lgkmcnt(4)
    v_dot2c_f32_bf16 v228, s41, v60
    v_dot2c_f32_bf16 v229, v60, v60
    v_dot2c_f32_bf16 v228, s41, v61
    v_dot2c_f32_bf16 v229, v61, v61
    v_dot2c_f32_bf16 v228, s41, v62
    v_dot2c_f32_bf16 v229, v62, v62
    v_dot2c_f32_bf16 v228, s41, v63
    v_dot2c_f32_bf16 v229, v63, v63
    s_waitcnt vmcnt(12)
    ds_read_b128 v[80:83], v188 offset:16384
    ds_read_b128 v[84:87], v189 offset:16384
    ds_read_b128 v[88:91], v190 offset:16384
    ds_read_b128 v[92:95], v191 offset:16384
    s_waitcnt lgkmcnt(7)
    v_dot2c_f32_bf16 v228, s41, v64
    v_dot2c_f32_bf16 v229, v64, v64
    v_dot2c_f32_bf16 v228, s41, v65
    v_dot2c_f32_bf16 v229, v65, v65
    v_dot2c_f32_bf16 v228, s41, v66
    v_dot2c_f32_bf16 v229, v66, v66
    v_dot2c_f32_bf16 v228, s41, v67
    v_dot2c_f32_bf16 v229, v67, v67
    s_waitcnt lgkmcnt(6)
    v_dot2c_f32_bf16 v228, s41, v68
    v_dot2c_f32_bf16 v229, v68, v68
    v_dot2c_f32_bf16 v228, s41, v69
    v_dot2c_f32_bf16 v229, v69, v69
    v_dot2c_f32_bf16 v228, s41, v70
    v_dot2c_f32_bf16 v229, v70, v70
    v_dot2c_f32_bf16 v228, s41, v71
    v_dot2c_f32_bf16 v229, v71, v71
    s_waitcnt lgkmcnt(5)
    v_dot2c_f32_bf16 v228, s41, v72
    v_dot2c_f32_bf16 v229, v72, v72
    v_dot2c_f32_bf16 v228, s41, v73
    v_dot2c_f32_bf16 v229, v73, v73
    v_dot2c_f32_bf16 v228, s41, v74
    v_dot2c_f32_bf16 v229, v74, v74
    v_dot2c_f32_bf16 v228, s41, v75
    v_dot2c_f32_bf16 v229, v75, v75
    s_waitcnt lgkmcnt(4)
    v_dot2c_f32_bf16 v228, s41, v76
    v_dot2c_f32_bf16 v229, v76, v76
    v_dot2c_f32_bf16 v228, s41, v77
    v_dot2c_f32_bf16 v229, v77, v77
    v_dot2c_f32_bf16 v228, s41, v78
    v_dot2c_f32_bf16 v229, v78, v78
    v_dot2c_f32_bf16 v228, s41, v79
    v_dot2c_f32_bf16 v229, v79, v79
    s_waitcnt vmcnt(8)
    ds_read_b128 v[96:99], v188 offset:32768
    ds_read_b128 v[100:103], v189 offset:32768
    ds_read_b128 v[104:107], v190 offset:32768
    ds_read_b128 v[108:111], v191 offset:32768
    s_waitcnt lgkmcnt(7)
    v_dot2c_f32_bf16 v228, s41, v80
    v_dot2c_f32_bf16 v229, v80, v80
    v_dot2c_f32_bf16 v228, s41, v81
    v_dot2c_f32_bf16 v229, v81, v81
    v_dot2c_f32_bf16 v228, s41, v82
    v_dot2c_f32_bf16 v229, v82, v82
    v_dot2c_f32_bf16 v228, s41, v83
    v_dot2c_f32_bf16 v229, v83, v83
    s_waitcnt lgkmcnt(6)
    v_dot2c_f32_bf16 v228, s41, v84
    v_dot2c_f32_bf16 v229, v84, v84
    v_dot2c_f32_bf16 v228, s41, v85
    v_dot2c_f32_bf16 v229, v85, v85
    v_dot2c_f32_bf16 v228, s41, v86
    v_dot2c_f32_bf16 v229, v86, v86
    v_dot2c_f32_bf16 v228, s41, v87
    v_dot2c_f32_bf16 v229, v87, v87
    s_waitcnt lgkmcnt(5)
    v_dot2c_f32_bf16 v228, s41, v88
    v_dot2c_f32_bf16 v229, v88, v88
    v_dot2c_f32_bf16 v228, s41, v89
    v_dot2c_f32_bf16 v229, v89, v89
    v_dot2c_f32_bf16 v228, s41, v90
    v_dot2c_f32_bf16 v229, v90, v90
    v_dot2c_f32_bf16 v228, s41, v91
    v_dot2c_f32_bf16 v229, v91, v91
    s_waitcnt lgkmcnt(4)
    v_dot2c_f32_bf16 v228, s41, v92
    v_dot2c_f32_bf16 v229, v92, v92
    v_dot2c_f32_bf16 v228, s41, v93
    v_dot2c_f32_bf16 v229, v93, v93
    v_dot2c_f32_bf16 v228, s41, v94
    v_dot2c_f32_bf16 v229, v94, v94
    v_dot2c_f32_bf16 v228, s41, v95
    v_dot2c_f32_bf16 v229, v95, v95
    s_waitcnt vmcnt(4)
    ds_read_b128 v[112:115], v188 offset:49152
    ds_read_b128 v[116:119], v189 offset:49152
    ds_read_b128 v[120:123], v190 offset:49152
    ds_read_b128 v[124:127], v191 offset:49152
    s_waitcnt lgkmcnt(7)
    v_dot2c_f32_bf16 v228, s41, v96
    v_dot2c_f32_bf16 v229, v96, v96
    v_dot2c_f32_bf16 v228, s41, v97
    v_dot2c_f32_bf16 v229, v97, v97
    v_dot2c_f32_bf16 v228, s41, v98
    v_dot2c_f32_bf16 v229, v98, v98
    v_dot2c_f32_bf16 v228, s41, v99
    v_dot2c_f32_bf16 v229, v99, v99
    s_waitcnt lgkmcnt(6)
    v_dot2c_f32_bf16 v228, s41, v100
    v_dot2c_f32_bf16 v229, v100, v100
    v_dot2c_f32_bf16 v228, s41, v101
    v_dot2c_f32_bf16 v229, v101, v101
    v_dot2c_f32_bf16 v228, s41, v102
    v_dot2c_f32_bf16 v229, v102, v102
    v_dot2c_f32_bf16 v228, s41, v103
    v_dot2c_f32_bf16 v229, v103, v103
    s_waitcnt lgkmcnt(5)
    v_dot2c_f32_bf16 v228, s41, v104
    v_dot2c_f32_bf16 v229, v104, v104
    v_dot2c_f32_bf16 v228, s41, v105
    v_dot2c_f32_bf16 v229, v105, v105
    v_dot2c_f32_bf16 v228, s41, v106
    v_dot2c_f32_bf16 v229, v106, v106
    v_dot2c_f32_bf16 v228, s41, v107
    v_dot2c_f32_bf16 v229, v107, v107
    s_waitcnt lgkmcnt(4)
    v_dot2c_f32_bf16 v228, s41, v108
    v_dot2c_f32_bf16 v229, v108, v108
    v_dot2c_f32_bf16 v228, s41, v109
    v_dot2c_f32_bf16 v229, v109, v109
    v_dot2c_f32_bf16 v228, s41, v110
    v_dot2c_f32_bf16 v229, v110, v110
    v_dot2c_f32_bf16 v228, s41, v111
    v_dot2c_f32_bf16 v229, v111, v111
    s_waitcnt vmcnt(0)
    v_add_u32 v188, 0x10000, v188
    v_add_u32 v189, 0x10000, v189
    v_add_u32 v190, 0x10000, v190
    v_add_u32 v191, 0x10000, v191
    ds_read_b128 v[128:131], v188 offset:0
    ds_read_b128 v[132:135], v189 offset:0
    ds_read_b128 v[136:139], v190 offset:0
    ds_read_b128 v[140:143], v191 offset:0
    ds_read_b128 v[216:219], v192
    ds_read_b128 v[220:223], v193
    ds_read_b128 v[224:227], v194
    s_waitcnt lgkmcnt(10)
    v_dot2c_f32_bf16 v228, s41, v112
    v_dot2c_f32_bf16 v229, v112, v112
    v_dot2c_f32_bf16 v228, s41, v113
    v_dot2c_f32_bf16 v229, v113, v113
    v_dot2c_f32_bf16 v228, s41, v114
    v_dot2c_f32_bf16 v229, v114, v114
    v_dot2c_f32_bf16 v228, s41, v115
    v_dot2c_f32_bf16 v229, v115, v115
    s_waitcnt lgkmcnt(9)
    v_dot2c_f32_bf16 v228, s41, v116
    v_dot2c_f32_bf16 v229, v116, v116
    v_dot2c_f32_bf16 v228, s41, v117
    v_dot2c_f32_bf16 v229, v117, v117
    v_dot2c_f32_bf16 v228, s41, v118
    v_dot2c_f32_bf16 v229, v118, v118
    v_dot2c_f32_bf16 v228, s41, v119
    v_dot2c_f32_bf16 v229, v119, v119
    s_waitcnt lgkmcnt(8)
    v_dot2c_f32_bf16 v228, s41, v120
    v_dot2c_f32_bf16 v229, v120, v120
    v_dot2c_f32_bf16 v228, s41, v121
    v_dot2c_f32_bf16 v229, v121, v121
    v_dot2c_f32_bf16 v228, s41, v122
    v_dot2c_f32_bf16 v229, v122, v122
    v_dot2c_f32_bf16 v228, s41, v123
    v_dot2c_f32_bf16 v229, v123, v123
    s_waitcnt lgkmcnt(7)
    v_dot2c_f32_bf16 v228, s41, v124
    v_dot2c_f32_bf16 v229, v124, v124
    v_dot2c_f32_bf16 v228, s41, v125
    v_dot2c_f32_bf16 v229, v125, v125
    v_dot2c_f32_bf16 v228, s41, v126
    v_dot2c_f32_bf16 v229, v126, v126
    v_dot2c_f32_bf16 v228, s41, v127
    v_dot2c_f32_bf16 v229, v127, v127
    s_waitcnt lgkmcnt(6)
    v_dot2c_f32_bf16 v228, s41, v128
    v_dot2c_f32_bf16 v228, s41, v129
    v_dot2c_f32_bf16 v228, s41, v130
    v_dot2c_f32_bf16 v228, s41, v131
    s_waitcnt lgkmcnt(5)
    v_dot2c_f32_bf16 v228, s41, v132
    v_dot2c_f32_bf16 v228, s41, v133
    v_dot2c_f32_bf16 v228, s41, v134
    v_dot2c_f32_bf16 v228, s41, v135
    s_waitcnt lgkmcnt(4)
    v_dot2c_f32_bf16 v228, s41, v136
    v_dot2c_f32_bf16 v228, s41, v137
    v_dot2c_f32_bf16 v228, s41, v138
    v_dot2c_f32_bf16 v228, s41, v139
    s_waitcnt lgkmcnt(3)
    v_dot2c_f32_bf16 v228, s41, v140
    v_dot2c_f32_bf16 v228, s41, v141
    v_dot2c_f32_bf16 v228, s41, v142
    v_dot2c_f32_bf16 v228, s41, v143
    v_dot2c_f32_bf16 v229, v128, v128
    v_dot2c_f32_bf16 v229, v129, v129
    v_dot2c_f32_bf16 v229, v130, v130
    v_dot2c_f32_bf16 v229, v131, v131
    v_dot2c_f32_bf16 v229, v132, v132
    v_dot2c_f32_bf16 v229, v133, v133
    v_dot2c_f32_bf16 v229, v134, v134
    v_dot2c_f32_bf16 v229, v135, v135
    v_dot2c_f32_bf16 v229, v136, v136
    v_dot2c_f32_bf16 v229, v137, v137
    v_dot2c_f32_bf16 v229, v138, v138
    v_dot2c_f32_bf16 v229, v139, v139
    v_dot2c_f32_bf16 v229, v140, v140
    v_dot2c_f32_bf16 v229, v141, v141
    v_dot2c_f32_bf16 v229, v142, v142
    v_dot2c_f32_bf16 v229, v143, v143
    s_waitcnt lgkmcnt(0)
    s_mul_i32 s23, s23, 1664525
    s_add_u32 s23, s23, 1013904223
    v_mov_b32 v230, v228
    s_nop 0
    v_mov_b32 v231, v229
    s_nop 0
    v_permlane32_swap_b32 v228, v230
    v_permlane32_swap_b32 v229, v231
    v_add_f32 v228, v228, v230
    v_add_f32 v229, v229, v231
    v_mul_f32 v228, s44, v228
    v_cvt_pk_bf16_f32 v230, v228, v228
    v_lshlrev_b32 v230, 16, v230
    v_xor_b32 v232, 0x80000000, v230
    v_mov_b32 v184, v232
    v_mov_b32 v185, v232
    v_mov_b32 v186, v232
    v_mov_b32 v187, v232
    v_mov_b32 v188, v232
    v_mov_b32 v189, v232
    v_mov_b32 v190, v232
    v_mov_b32 v191, v232
    v_mov_b32 v192, v232
    v_mov_b32 v193, v232
    v_mov_b32 v194, v232
    v_mov_b32 v195, v232
    v_mov_b32 v196, v232
    v_mov_b32 v197, v232
    v_mov_b32 v198, v232
    v_mov_b32 v199, v232
    s_nop 1
    v_mfma_f32_32x32x16_bf16 v[144:159], v[176:179], v[0:3], v[184:199]
    v_mfma_f32_32x32x16_bf16 v[144:159], v[180:183], v[4:7], v[144:159]
    s_barrier
    s_add_u32 m0, s29, 0
    s_add_u32 s46, s24, 0
    buffer_load_dwordx4 v246, s[8:11], s46 offen offset:0 lds
    v_mul_f32 v230, v228, v228
    v_fma_f32 v229, v229, s44, -v230
    v_mfma_f32_32x32x16_bf16 v[160:175], v[176:179], v[8:11], v[184:199]
    v_mfma_f32_32x32x16_bf16 v[160:175], v[180:183], v[12:15], v[160:175]
    buffer_load_dwordx4 v247, s[8:11], s46 offen offset:1024 lds
    v_max_f32 v229, 0, v229
    v_cvt_pk_bf16_f32 v229, v229, v229
    s_nop 1
    v_mfma_f32_32x32x16_bf16 v[200:215], v[176:179], v[16:19], v[184:199]
    v_mfma_f32_32x32x16_bf16 v[200:215], v[180:183], v[20:23], v[200:215]
    buffer_load_dwordx4 v248, s[8:11], s46 offen offset:2048 lds
    v_lshlrev_b32 v229, 16, v229
    v_add_f32 v229, 0x3727c5ac, v229
    v_cvt_pk_bf16_f32 v0, v144, v145
    v_cvt_pk_bf16_f32 v1, v146, v147
    v_cvt_pk_bf16_f32 v2, v148, v149
    v_cvt_pk_bf16_f32 v3, v150, v151
    v_cvt_pk_bf16_f32 v4, v152, v153
    v_cvt_pk_bf16_f32 v5, v154, v155
    v_cvt_pk_bf16_f32 v6, v156, v157
    v_cvt_pk_bf16_f32 v7, v158, v159
    v_mfma_f32_32x32x16_bf16 v[144:159], v[176:179], v[24:27], v[184:199]
    v_mfma_f32_32x32x16_bf16 v[144:159], v[180:183], v[28:31], v[144:159]
    buffer_load_dwordx4 v249, s[8:11], s46 offen offset:3072 lds
    v_cvt_pk_bf16_f32 v229, v229, v229
    v_lshlrev_b32 v229, 16, v229
    v_cvt_pk_bf16_f32 v8, v160, v161
    v_cvt_pk_bf16_f32 v9, v162, v163
    v_cvt_pk_bf16_f32 v10, v164, v165
    v_cvt_pk_bf16_f32 v11, v166, v167
    v_cvt_pk_bf16_f32 v12, v168, v169
    v_cvt_pk_bf16_f32 v13, v170, v171
    v_cvt_pk_bf16_f32 v14, v172, v173
    v_cvt_pk_bf16_f32 v15, v174, v175
    v_mfma_f32_32x32x16_bf16 v[160:175], v[176:179], v[32:35], v[184:199]
    v_mfma_f32_32x32x16_bf16 v[160:175], v[180:183], v[36:39], v[160:175]
    s_add_u32 m0, s30, 0
    s_add_u32 s46, s25, 0
    buffer_load_dwordx4 v246, s[8:11], s46 offen offset:0 lds
    v_sqrt_f32 v229, v229
    s_nop 0
    v_cvt_pk_bf16_f32 v16, v200, v201
    v_cvt_pk_bf16_f32 v17, v202, v203
    v_cvt_pk_bf16_f32 v18, v204, v205
    v_cvt_pk_bf16_f32 v19, v206, v207
    v_cvt_pk_bf16_f32 v20, v208, v209
    v_cvt_pk_bf16_f32 v21, v210, v211
    v_cvt_pk_bf16_f32 v22, v212, v213
    v_cvt_pk_bf16_f32 v23, v214, v215
    v_mfma_f32_32x32x16_bf16 v[200:215], v[176:179], v[40:43], v[184:199]
    v_mfma_f32_32x32x16_bf16 v[200:215], v[180:183], v[44:47], v[200:215]
    buffer_load_dwordx4 v247, s[8:11], s46 offen offset:1024 lds
    v_cvt_pk_bf16_f32 v229, v229, v229
    v_lshlrev_b32 v229, 16, v229
    v_cvt_pk_bf16_f32 v24, v144, v145
    v_cvt_pk_bf16_f32 v25, v146, v147
    v_cvt_pk_bf16_f32 v26, v148, v149
    v_cvt_pk_bf16_f32 v27, v150, v151
    v_cvt_pk_bf16_f32 v28, v152, v153
    v_cvt_pk_bf16_f32 v29, v154, v155
    v_cvt_pk_bf16_f32 v30, v156, v157
    v_cvt_pk_bf16_f32 v31, v158, v159
    v_mfma_f32_32x32x16_bf16 v[144:159], v[176:179], v[48:51], v[184:199]
    v_mfma_f32_32x32x16_bf16 v[144:159], v[180:183], v[52:55], v[144:159]
    buffer_load_dwordx4 v248, s[8:11], s46 offen offset:2048 lds
    v_rcp_f32 v233, v229
    s_nop 0
    v_cvt_pk_bf16_f32 v32, v160, v161
    v_cvt_pk_bf16_f32 v33, v162, v163
    v_cvt_pk_bf16_f32 v34, v164, v165
    v_cvt_pk_bf16_f32 v35, v166, v167
    v_cvt_pk_bf16_f32 v36, v168, v169
    v_cvt_pk_bf16_f32 v37, v170, v171
    v_cvt_pk_bf16_f32 v38, v172, v173
    v_cvt_pk_bf16_f32 v39, v174, v175
    v_mfma_f32_32x32x16_bf16 v[160:175], v[176:179], v[56:59], v[184:199]
    v_mfma_f32_32x32x16_bf16 v[160:175], v[180:183], v[60:63], v[160:175]
    buffer_load_dwordx4 v249, s[8:11], s46 offen offset:3072 lds
    v_mul_f32 v245, 0xbfb8aa3b, v233
    v_mul_f32 v234, v232, v233
    v_cvt_pk_bf16_f32 v40, v200, v201
    v_cvt_pk_bf16_f32 v41, v202, v203
    v_cvt_pk_bf16_f32 v42, v204, v205
    v_cvt_pk_bf16_f32 v43, v206, v207
    v_cvt_pk_bf16_f32 v44, v208, v209
    v_cvt_pk_bf16_f32 v45, v210, v211
    v_cvt_pk_bf16_f32 v46, v212, v213
    v_cvt_pk_bf16_f32 v47, v214, v215
    v_mfma_f32_32x32x16_bf16 v[200:215], v[176:179], v[64:67], v[184:199]
    v_mfma_f32_32x32x16_bf16 v[200:215], v[180:183], v[68:71], v[200:215]
    s_add_u32 m0, s31, 0
    s_add_u32 s46, s26, 0
    buffer_load_dwordx4 v246, s[8:11], s46 offen offset:0 lds
    v_accvgpr_write_b32 a72, v233
    v_accvgpr_write_b32 a73, v234
    v_cvt_pk_bf16_f32 v48, v144, v145
    v_cvt_pk_bf16_f32 v49, v146, v147
    v_cvt_pk_bf16_f32 v50, v148, v149
    v_cvt_pk_bf16_f32 v51, v150, v151
    v_cvt_pk_bf16_f32 v52, v152, v153
    v_cvt_pk_bf16_f32 v53, v154, v155
    v_cvt_pk_bf16_f32 v54, v156, v157
    v_cvt_pk_bf16_f32 v55, v158, v159
    v_mfma_f32_32x32x16_bf16 v[144:159], v[176:179], v[72:75], v[184:199]
    v_mfma_f32_32x32x16_bf16 v[144:159], v[180:183], v[76:79], v[144:159]
    s_add_u32 m0, s29, 36864
    s_add_u32 s46, s24, 2654208
    buffer_load_dwordx4 v246, s[8:11], s46 offen offset:0 lds
    v_cvt_pk_bf16_f32 v56, v160, v161
    v_cvt_pk_bf16_f32 v57, v162, v163
    v_cvt_pk_bf16_f32 v58, v164, v165
    v_cvt_pk_bf16_f32 v59, v166, v167
    v_cvt_pk_bf16_f32 v60, v168, v169
    v_cvt_pk_bf16_f32 v61, v170, v171
    v_cvt_pk_bf16_f32 v62, v172, v173
    v_cvt_pk_bf16_f32 v63, v174, v175
    v_mfma_f32_32x32x16_bf16 v[160:175], v[176:179], v[80:83], v[184:199]
    v_mfma_f32_32x32x16_bf16 v[160:175], v[180:183], v[84:87], v[160:175]
    buffer_load_dwordx4 v247, s[8:11], s46 offen offset:1024 lds
    v_cvt_pk_bf16_f32 v64, v200, v201
    v_cvt_pk_bf16_f32 v65, v202, v203
    v_cvt_pk_bf16_f32 v66, v204, v205
    v_cvt_pk_bf16_f32 v67, v206, v207
    v_cvt_pk_bf16_f32 v68, v208, v209
    v_cvt_pk_bf16_f32 v69, v210, v211
    v_cvt_pk_bf16_f32 v70, v212, v213
    v_cvt_pk_bf16_f32 v71, v214, v215
    v_mfma_f32_32x32x16_bf16 v[200:215], v[176:179], v[88:91], v[184:199]
    v_mfma_f32_32x32x16_bf16 v[200:215], v[180:183], v[92:95], v[200:215]
    buffer_load_dwordx4 v248, s[8:11], s46 offen offset:2048 lds
    v_cvt_pk_bf16_f32 v72, v144, v145
    v_cvt_pk_bf16_f32 v73, v146, v147
    v_cvt_pk_bf16_f32 v74, v148, v149
    v_cvt_pk_bf16_f32 v75, v150, v151
    v_cvt_pk_bf16_f32 v76, v152, v153
    v_cvt_pk_bf16_f32 v77, v154, v155
    v_cvt_pk_bf16_f32 v78, v156, v157
    v_cvt_pk_bf16_f32 v79, v158, v159
    v_mfma_f32_32x32x16_bf16 v[144:159], v[176:179], v[96:99], v[184:199]
    v_mfma_f32_32x32x16_bf16 v[144:159], v[180:183], v[100:103], v[144:159]
    buffer_load_dwordx4 v249, s[8:11], s46 offen offset:3072 lds
    v_cvt_pk_bf16_f32 v80, v160, v161
    v_cvt_pk_bf16_f32 v81, v162, v163
    v_cvt_pk_bf16_f32 v82, v164, v165
    v_cvt_pk_bf16_f32 v83, v166, v167
    v_cvt_pk_bf16_f32 v84, v168, v169
    v_cvt_pk_bf16_f32 v85, v170, v171
    v_cvt_pk_bf16_f32 v86, v172, v173
    v_cvt_pk_bf16_f32 v87, v174, v175
    v_mfma_f32_32x32x16_bf16 v[160:175], v[176:179], v[104:107], v[184:199]
    v_mfma_f32_32x32x16_bf16 v[160:175], v[180:183], v[108:111], v[160:175]
    s_add_u32 m0, s30, 36864
    s_add_u32 s46, s25, 2654208
    buffer_load_dwordx4 v246, s[8:11], s46 offen offset:0 lds
    v_cvt_pk_bf16_f32 v88, v200, v201
    v_cvt_pk_bf16_f32 v89, v202, v203
    v_cvt_pk_bf16_f32 v90, v204, v205
    v_cvt_pk_bf16_f32 v91, v206, v207
    v_cvt_pk_bf16_f32 v92, v208, v209
    v_cvt_pk_bf16_f32 v93, v210, v211
    v_cvt_pk_bf16_f32 v94, v212, v213
    v_cvt_pk_bf16_f32 v95, v214, v215
    v_mfma_f32_32x32x16_bf16 v[200:215], v[176:179], v[112:115], v[184:199]
    v_mfma_f32_32x32x16_bf16 v[200:215], v[180:183], v[116:119], v[200:215]
    buffer_load_dwordx4 v247, s[8:11], s46 offen offset:1024 lds
    v_cvt_pk_bf16_f32 v96, v144, v145
    v_cvt_pk_bf16_f32 v97, v146, v147
    v_cvt_pk_bf16_f32 v98, v148, v149
    v_cvt_pk_bf16_f32 v99, v150, v151
    v_cvt_pk_bf16_f32 v100, v152, v153
    v_cvt_pk_bf16_f32 v101, v154, v155
    v_cvt_pk_bf16_f32 v102, v156, v157
    v_cvt_pk_bf16_f32 v103, v158, v159
    v_mfma_f32_32x32x16_bf16 v[144:159], v[176:179], v[120:123], v[184:199]
    v_mfma_f32_32x32x16_bf16 v[144:159], v[180:183], v[124:127], v[144:159]
    buffer_load_dwordx4 v248, s[8:11], s46 offen offset:2048 lds
    v_cvt_pk_bf16_f32 v104, v160, v161
    v_cvt_pk_bf16_f32 v105, v162, v163
    v_cvt_pk_bf16_f32 v106, v164, v165
    v_cvt_pk_bf16_f32 v107, v166, v167
    v_cvt_pk_bf16_f32 v108, v168, v169
    v_cvt_pk_bf16_f32 v109, v170, v171
    v_cvt_pk_bf16_f32 v110, v172, v173
    v_cvt_pk_bf16_f32 v111, v174, v175
    v_mfma_f32_32x32x16_bf16 v[160:175], v[176:179], v[128:131], v[184:199]
    v_mfma_f32_32x32x16_bf16 v[160:175], v[180:183], v[132:135], v[160:175]
    buffer_load_dwordx4 v249, s[8:11], s46 offen offset:3072 lds
    v_cvt_pk_bf16_f32 v112, v200, v201
    v_cvt_pk_bf16_f32 v113, v202, v203
    v_cvt_pk_bf16_f32 v114, v204, v205
    v_cvt_pk_bf16_f32 v115, v206, v207
    v_cvt_pk_bf16_f32 v116, v208, v209
    v_cvt_pk_bf16_f32 v117, v210, v211
    v_cvt_pk_bf16_f32 v118, v212, v213
    v_cvt_pk_bf16_f32 v119, v214, v215
    v_mfma_f32_32x32x16_bf16 v[200:215], v[176:179], v[136:139], v[184:199]
    v_mfma_f32_32x32x16_bf16 v[200:215], v[180:183], v[140:143], v[200:215]
    s_add_u32 m0, s31, 36864
    s_add_u32 s46, s26, 2654208
    buffer_load_dwordx4 v246, s[8:11], s46 offen offset:0 lds
    v_cvt_pk_bf16_f32 v120, v144, v145
    v_cvt_pk_bf16_f32 v121, v146, v147
    v_cvt_pk_bf16_f32 v122, v148, v149
    v_cvt_pk_bf16_f32 v123, v150, v151
    v_cvt_pk_bf16_f32 v124, v152, v153
    v_cvt_pk_bf16_f32 v125, v154, v155
    v_cvt_pk_bf16_f32 v126, v156, v157
    v_cvt_pk_bf16_f32 v127, v158, v159
    s_nop 7
    v_cvt_pk_bf16_f32 v128, v160, v161
    v_cvt_pk_bf16_f32 v129, v162, v163
    v_cvt_pk_bf16_f32 v130, v164, v165
    v_cvt_pk_bf16_f32 v131, v166, v167
    v_cvt_pk_bf16_f32 v132, v168, v169
    v_cvt_pk_bf16_f32 v133, v170, v171
    v_cvt_pk_bf16_f32 v134, v172, v173
    v_cvt_pk_bf16_f32 v135, v174, v175
    s_nop 1
    v_cvt_pk_bf16_f32 v136, v200, v201
    v_cvt_pk_bf16_f32 v137, v202, v203
    v_cvt_pk_bf16_f32 v138, v204, v205
    v_cvt_pk_bf16_f32 v139, v206, v207
    v_cvt_pk_bf16_f32 v140, v208, v209
    v_cvt_pk_bf16_f32 v141, v210, v211
    v_cvt_pk_bf16_f32 v142, v212, v213
    v_cvt_pk_bf16_f32 v143, v214, v215
    v_mov_b32 v255, s23
    s_waitcnt vmcnt(9)
    s_barrier
    ds_read_b64_tr_b16 a[0:1], v240 offset:0
    ds_read_b64_tr_b16 a[2:3], v240 offset:512
    ds_read_b64_tr_b16 a[4:5], v240 offset:2048
    ds_read_b64_tr_b16 a[6:7], v240 offset:2560
    ds_read_b64_tr_b16 a[8:9], v240 offset:4096
    ds_read_b64_tr_b16 a[10:11], v240 offset:4608
    ds_read_b64_tr_b16 a[12:13], v240 offset:6144
    ds_read_b64_tr_b16 a[14:15], v240 offset:6656
    ds_read_b64_tr_b16 a[16:17], v240 offset:8192
    ds_read_b64_tr_b16 a[18:19], v240 offset:8704
    ds_read_b64_tr_b16 a[20:21], v240 offset:10240
    ds_read_b64_tr_b16 a[22:23], v240 offset:10752
    ds_read_b64_tr_b16 a[24:25], v240 offset:12288
    ds_read_b64_tr_b16 a[26:27], v240 offset:12800
    s_waitcnt lgkmcnt(6)
    v_mfma_f32_32x32x16_bf16 v[144:159], a[0:3], v[0:3], 0
    ds_read_b64_tr_b16 a[28:29], v240 offset:14336
    ds_read_b64_tr_b16 a[30:31], v240 offset:14848
    s_add_u32 m0, s29, 73728
    s_add_u32 s46, s24, 128
    buffer_load_dwordx4 v246, s[8:11], s46 offen offset:0 lds
    v_lshlrev_b32 v176, 16, v216
    v_mfma_f32_32x32x16_bf16 v[144:159], a[4:7], v[4:7], v[144:159]
    ds_read_b64_tr_b16 a[0:1], v240 offset:16384
    ds_read_b64_tr_b16 a[2:3], v240 offset:16896
    v_and_b32 v177, 0xffff0000, v216
    v_lshlrev_b32 v178, 16, v217
    v_and_b32 v179, 0xffff0000, v217
    v_lshlrev_b32 v180, 16, v218
    v_mfma_f32_32x32x16_bf16 v[144:159], a[8:11], v[8:11], v[144:159]
    ds_read_b64_tr_b16 a[4:5], v240 offset:18432
    ds_read_b64_tr_b16 a[6:7], v240 offset:18944
    v_and_b32 v181, 0xffff0000, v218
    v_lshlrev_b32 v182, 16, v219
    v_and_b32 v183, 0xffff0000, v219
    v_fma_f32 v176, v176, v233, v234
    v_mfma_f32_32x32x16_bf16 v[144:159], a[12:15], v[12:15], v[144:159]
    ds_read_b64_tr_b16 a[8:9], v240 offset:20480
    ds_read_b64_tr_b16 a[10:11], v240 offset:20992
    buffer_load_dwordx4 v247, s[8:11], s46 offen offset:1024 lds
    v_fma_f32 v177, v177, v233, v234
    v_fma_f32 v178, v178, v233, v234
    s_waitcnt lgkmcnt(6)
    v_mfma_f32_32x32x16_bf16 v[144:159], a[16:19], v[16:19], v[144:159]
    ds_read_b64_tr_b16 a[12:13], v240 offset:22528
    ds_read_b64_tr_b16 a[14:15], v240 offset:23040
    v_fma_f32 v179, v179, v233, v234
    v_fma_f32 v180, v180, v233, v234
    v_fma_f32 v181, v181, v233, v234
    v_fma_f32 v182, v182, v233, v234
    v_mfma_f32_32x32x16_bf16 v[144:159], a[20:23], v[20:23], v[144:159]
    ds_read_b64_tr_b16 a[16:17], v240 offset:24576
    ds_read_b64_tr_b16 a[18:19], v240 offset:25088
    v_fma_f32 v183, v183, v233, v234
    v_cvt_pk_bf16_f32 v216, v176, v177
    v_cvt_pk_bf16_f32 v217, v178, v179
    v_cvt_pk_bf16_f32 v218, v180, v181
    v_mfma_f32_32x32x16_bf16 v[144:159], a[24:27], v[24:27], v[144:159]
    ds_read_b64_tr_b16 a[20:21], v240 offset:26624
    ds_read_b64_tr_b16 a[22:23], v240 offset:27136
    buffer_load_dwordx4 v248, s[8:11], s46 offen offset:2048 lds
    v_cvt_pk_bf16_f32 v219, v182, v183
    ds_write_b16 v235, v216 offset:0
    v_lshlrev_b32 v176, 16, v220
    v_mfma_f32_32x32x16_bf16 v[144:159], a[28:31], v[28:31], v[144:159]
    ds_read_b64_tr_b16 a[24:25], v240 offset:28672
    ds_read_b64_tr_b16 a[26:27], v240 offset:29184
    v_and_b32 v177, 0xffff0000, v220
    ds_write_b16_d16_hi v235, v216 offset:256
    v_lshlrev_b32 v178, 16, v221
    s_waitcnt lgkmcnt(8)
    v_mfma_f32_32x32x16_bf16 v[144:159], a[0:3], v[32:35], v[144:159]
    ds_read_b64_tr_b16 a[28:29], v240 offset:30720
    ds_read_b64_tr_b16 a[30:31], v240 offset:31232
    v_and_b32 v179, 0xffff0000, v221
    v_lshlrev_b32 v180, 16, v222
    ds_write_b16 v235, v217 offset:512
    v_and_b32 v181, 0xffff0000, v222
    v_mfma_f32_32x32x16_bf16 v[144:159], a[4:7], v[36:39], v[144:159]
    ds_read_b64_tr_b16 a[0:1], v240 offset:32768
    ds_read_b64_tr_b16 a[2:3], v240 offset:33280
    buffer_load_dwordx4 v249, s[8:11], s46 offen offset:3072 lds
    v_lshlrev_b32 v182, 16, v223
    ds_write_b16_d16_hi v235, v217 offset:768
    v_and_b32 v183, 0xffff0000, v223
    v_mfma_f32_32x32x16_bf16 v[144:159], a[8:11], v[40:43], v[144:159]
    ds_read_b64_tr_b16 a[4:5], v240 offset:34816
    ds_read_b64_tr_b16 a[6:7], v240 offset:35328
    v_fma_f32 v176, v176, v233, v234
    v_fma_f32 v177, v177, v233, v234
    ds_write_b16 v235, v218 offset:1024
    v_fma_f32 v178, v178, v233, v234
    v_mfma_f32_32x32x16_bf16 v[144:159], a[12:15], v[44:47], v[144:159]
    s_waitcnt vmcnt(4)
    s_barrier
    ds_read_b64_tr_b16 a[8:9], v241 offset:0
    ds_read_b64_tr_b16 a[10:11], v241 offset:512
    v_fma_f32 v179, v179, v233, v234
    s_waitcnt lgkmcnt(9)
    v_mfma_f32_32x32x16_bf16 v[144:159], a[16:19], v[48:51], v[144:159]
    ds_read_b64_tr_b16 a[12:13], v241 offset:2048
    ds_read_b64_tr_b16 a[14:15], v241 offset:2560
    s_add_u32 m0, s30, 73728
    s_add_u32 s46, s25, 128
    buffer_load_dwordx4 v246, s[8:11], s46 offen offset:0 lds
    ds_write_b16_d16_hi v235, v218 offset:1280
    v_mfma_f32_32x32x16_bf16 v[144:159], a[20:23], v[52:55], v[144:159]
    ds_read_b64_tr_b16 a[16:17], v241 offset:4096
    ds_read_b64_tr_b16 a[18:19], v241 offset:4608
    v_fma_f32 v180, v180, v233, v234
    v_fma_f32 v181, v181, v233, v234
    v_fma_f32 v182, v182, v233, v234
    ds_write_b16 v235, v219 offset:1536
    v_mfma_f32_32x32x16_bf16 v[144:159], a[24:27], v[56:59], v[144:159]
    ds_read_b64_tr_b16 a[20:21], v241 offset:6144
    ds_read_b64_tr_b16 a[22:23], v241 offset:6656
    v_fma_f32 v183, v183, v233, v234
    v_cvt_pk_bf16_f32 v220, v176, v177
    ds_write_b16_d16_hi v235, v219 offset:1792
    v_cvt_pk_bf16_f32 v221, v178, v179
    v_mfma_f32_32x32x16_bf16 v[144:159], a[28:31], v[60:63], v[144:159]
    ds_read_b64_tr_b16 a[24:25], v241 offset:8192
    ds_read_b64_tr_b16 a[26:27], v241 offset:8704
    buffer_load_dwordx4 v247, s[8:11], s46 offen offset:1024 lds
    v_cvt_pk_bf16_f32 v222, v180, v181
    v_cvt_pk_bf16_f32 v223, v182, v183
    s_waitcnt lgkmcnt(9)
    v_mfma_f32_32x32x16_bf16 v[144:159], a[0:3], v[64:67], v[144:159]
    ds_read_b64_tr_b16 a[28:29], v241 offset:10240
    ds_read_b64_tr_b16 a[30:31], v241 offset:10752
    ds_write_b16 v235, v220 offset:4096
    v_lshlrev_b32 v176, 16, v224
    v_and_b32 v177, 0xffff0000, v224
    v_mfma_f32_32x32x16_bf16 v[144:159], a[4:7], v[68:71], v[144:159]
    ds_read_b64_tr_b16 a[0:1], v241 offset:12288
    ds_read_b64_tr_b16 a[2:3], v241 offset:12800
    ds_write_b16_d16_hi v235, v220 offset:4352
    v_lshlrev_b32 v178, 16, v225
    v_and_b32 v179, 0xffff0000, v225
    v_lshlrev_b32 v180, 16, v226
    v_mfma_f32_32x32x16_bf16 v[144:159], a[8:11], v[72:75], v[144:159]
    ds_read_b64_tr_b16 a[4:5], v241 offset:14336
    ds_read_b64_tr_b16 a[6:7], v241 offset:14848
    buffer_load_dwordx4 v248, s[8:11], s46 offen offset:2048 lds
    ds_write_b16 v235, v221 offset:4608
    v_and_b32 v181, 0xffff0000, v226
    v_lshlrev_b32 v182, 16, v227
    v_mfma_f32_32x32x16_bf16 v[144:159], a[12:15], v[76:79], v[144:159]
    ds_read_b64_tr_b16 a[8:9], v241 offset:16384
    ds_read_b64_tr_b16 a[10:11], v241 offset:16896
    ds_write_b16_d16_hi v235, v221 offset:4864
    v_and_b32 v183, 0xffff0000, v227
    v_fma_f32 v176, v176, v233, v234
    s_waitcnt lgkmcnt(10)
    v_mfma_f32_32x32x16_bf16 v[144:159], a[16:19], v[80:83], v[144:159]
    ds_read_b64_tr_b16 a[12:13], v241 offset:18432
    ds_read_b64_tr_b16 a[14:15], v241 offset:18944
    v_fma_f32 v177, v177, v233, v234
    ds_write_b16 v235, v222 offset:5120
    v_fma_f32 v178, v178, v233, v234
    v_fma_f32 v179, v179, v233, v234
    v_mfma_f32_32x32x16_bf16 v[144:159], a[20:23], v[84:87], v[144:159]
    ds_read_b64_tr_b16 a[16:17], v241 offset:20480
    ds_read_b64_tr_b16 a[18:19], v241 offset:20992
    buffer_load_dwordx4 v249, s[8:11], s46 offen offset:3072 lds
    ds_write_b16_d16_hi v235, v222 offset:5376
    v_fma_f32 v180, v180, v233, v234
    v_fma_f32 v181, v181, v233, v234
    v_mfma_f32_32x32x16_bf16 v[144:159], a[24:27], v[88:91], v[144:159]
    ds_read_b64_tr_b16 a[20:21], v241 offset:22528
    ds_read_b64_tr_b16 a[22:23], v241 offset:23040
    v_fma_f32 v182, v182, v233, v234
    ds_write_b16 v235, v223 offset:5632
    v_fma_f32 v183, v183, v233, v234
    v_cvt_pk_bf16_f32 v224, v176, v177
    v_mfma_f32_32x32x16_bf16 v[144:159], a[28:31], v[92:95], v[144:159]
    ds_read_b64_tr_b16 a[24:25], v241 offset:24576
    ds_read_b64_tr_b16 a[26:27], v241 offset:25088
    ds_write_b16_d16_hi v235, v223 offset:5888
    v_cvt_pk_bf16_f32 v225, v178, v179
    v_cvt_pk_bf16_f32 v226, v180, v181
    s_waitcnt lgkmcnt(10)
    v_mfma_f32_32x32x16_bf16 v[144:159], a[0:3], v[96:99], v[144:159]
    ds_read_b64_tr_b16 a[28:29], v241 offset:26624
    ds_read_b64_tr_b16 a[30:31], v241 offset:27136
    s_add_u32 m0, s31, 73728
    s_add_u32 s46, s26, 128
    buffer_load_dwordx4 v246, s[8:11], s46 offen offset:0 lds
    v_cvt_pk_bf16_f32 v227, v182, v183
    v_mfma_f32_32x32x16_bf16 v[144:159], a[4:7], v[100:103], v[144:159]
    ds_read_b64_tr_b16 a[0:1], v241 offset:28672
    ds_read_b64_tr_b16 a[2:3], v241 offset:29184
    ds_write_b16 v235, v224 offset:8192
    v_mfma_f32_32x32x16_bf16 v[144:159], a[8:11], v[104:107], v[144:159]
    ds_read_b64_tr_b16 a[4:5], v241 offset:30720
    ds_read_b64_tr_b16 a[6:7], v241 offset:31232
    ds_write_b16_d16_hi v235, v224 offset:8448
    v_mfma_f32_32x32x16_bf16 v[144:159], a[12:15], v[108:111], v[144:159]
    ds_read_b64_tr_b16 a[8:9], v241 offset:32768
    ds_read_b64_tr_b16 a[10:11], v241 offset:33280
    s_add_u32 m0, s29, 110592
    s_add_u32 s46, s24, 2654336
    buffer_load_dwordx4 v246, s[8:11], s46 offen offset:0 lds
    s_waitcnt lgkmcnt(8)
    v_mfma_f32_32x32x16_bf16 v[144:159], a[16:19], v[112:115], v[144:159]
    ds_read_b64_tr_b16 a[12:13], v241 offset:34816
    ds_read_b64_tr_b16 a[14:15], v241 offset:35328
    ds_write_b16 v235, v225 offset:8704
    v_mfma_f32_32x32x16_bf16 v[144:159], a[20:23], v[116:119], v[144:159]
    ds_read_b64_tr_b16 a[16:17], v242 offset:0
    ds_read_b64_tr_b16 a[18:19], v242 offset:512
    ds_write_b16_d16_hi v235, v225 offset:8960
    v_mfma_f32_32x32x16_bf16 v[144:159], a[24:27], v[120:123], v[144:159]
    ds_read_b64_tr_b16 a[20:21], v242 offset:2048
    ds_read_b64_tr_b16 a[22:23], v242 offset:2560
    buffer_load_dwordx4 v247, s[8:11], s46 offen offset:1024 lds
    ds_write_b16 v235, v226 offset:9216
    v_mfma_f32_32x32x16_bf16 v[144:159], a[28:31], v[124:127], v[144:159]
    ds_read_b64_tr_b16 a[24:25], v242 offset:4096
    ds_read_b64_tr_b16 a[26:27], v242 offset:4608
    ds_write_b16_d16_hi v235, v226 offset:9472
    s_waitcnt lgkmcnt(10)
    v_mfma_f32_32x32x16_bf16 v[144:159], a[0:3], v[128:131], v[144:159]
    ds_read_b64_tr_b16 a[28:29], v242 offset:6144
    ds_read_b64_tr_b16 a[30:31], v242 offset:6656
    ds_write_b16 v235, v227 offset:9728
    v_mfma_f32_32x32x16_bf16 v[144:159], a[4:7], v[132:135], v[144:159]
    ds_read_b64_tr_b16 a[0:1], v242 offset:8192
    ds_read_b64_tr_b16 a[2:3], v242 offset:8704
    buffer_load_dwordx4 v248, s[8:11], s46 offen offset:2048 lds
    ds_write_b16_d16_hi v235, v227 offset:9984
    v_mfma_f32_32x32x16_bf16 v[144:159], a[8:11], v[136:139], v[144:159]
    ds_read_b64_tr_b16 a[4:5], v242 offset:10240
    ds_read_b64_tr_b16 a[6:7], v242 offset:10752
    s_waitcnt lgkmcnt(0)
    s_barrier
    ds_read_b128 v[216:219], v238 offset:0
    ds_read_b128 v[220:223], v238 offset:4096
    ds_read_b128 v[224:227], v238 offset:8192
    v_mfma_f32_32x32x16_bf16 v[144:159], a[12:15], v[140:143], v[144:159]
    ds_read_b64_tr_b16 a[8:9], v242 offset:12288
    ds_read_b64_tr_b16 a[10:11], v242 offset:12800
    v_mfma_f32_32x32x16_bf16 v[160:175], a[16:19], v[0:3], 0
    ds_read_b64_tr_b16 a[12:13], v242 offset:14336
    ds_read_b64_tr_b16 a[14:15], v242 offset:14848
    s_waitcnt lgkmcnt(4)
    s_cmp_lg_u32 s20, 0
    s_cbranch_scc1 Lnz_1
    v_mov_b32 v176, 0
    v_mov_b32 v177, 0
    buffer_store_dwordx2 v[176:177], v236, s[16:19], s50 offen sc1
    s_add_u32 s50, s50, 67584
    buffer_store_dwordx2 v[176:177], v236, s[16:19], s50 offen sc1
    s_add_u32 s50, s50, 67584
    buffer_store_dwordx2 v[176:177], v236, s[16:19], s50 offen sc1
Lnz_1:
    v_mfma_f32_32x32x16_bf16 v[160:175], a[20:23], v[4:7], v[160:175]
    ds_read_b64_tr_b16 a[16:17], v242 offset:16384
    ds_read_b64_tr_b16 a[18:19], v242 offset:16896
    buffer_store_dwordx4 v[216:219], v237, s[16:19], s51 offen sc1
    v_add_u32 v240, 73728, v240
    v_add_u32 v241, 73728, v241
    v_mul_f32 v176, v144, v245
    v_mfma_f32_32x32x16_bf16 v[160:175], a[24:27], v[8:11], v[160:175]
    ds_read_b64_tr_b16 a[20:21], v242 offset:18432
    ds_read_b64_tr_b16 a[22:23], v242 offset:18944
    v_mul_f32 v180, v148, v245
    v_mul_f32 v177, v145, v245
    v_mul_f32 v181, v149, v245
    v_mul_f32 v178, v146, v245
    v_mfma_f32_32x32x16_bf16 v[160:175], a[28:31], v[12:15], v[160:175]
    ds_read_b64_tr_b16 a[24:25], v242 offset:20480
    ds_read_b64_tr_b16 a[26:27], v242 offset:20992
    v_mul_f32 v182, v150, v245
    v_mul_f32 v179, v147, v245
    v_mul_f32 v183, v151, v245
    s_waitcnt lgkmcnt(6)
    v_mfma_f32_32x32x16_bf16 v[160:175], a[0:3], v[16:19], v[160:175]
    ds_read_b64_tr_b16 a[28:29], v242 offset:22528
    ds_read_b64_tr_b16 a[30:31], v242 offset:23040
    v_exp_f32 v176, v176
    v_exp_f32 v180, v180
    v_mfma_f32_32x32x16_bf16 v[160:175], a[4:7], v[20:23], v[160:175]
    ds_read_b64_tr_b16 a[0:1], v242 offset:24576
    ds_read_b64_tr_b16 a[2:3], v242 offset:25088
    s_add_u32 s51, s51, 67584
    buffer_store_dwordx4 v[220:223], v237, s[16:19], s51 offen sc1
    v_exp_f32 v177, v177
    v_mfma_f32_32x32x16_bf16 v[160:175], a[8:11], v[24:27], v[160:175]
    ds_read_b64_tr_b16 a[4:5], v242 offset:26624
    ds_read_b64_tr_b16 a[6:7], v242 offset:27136
    v_exp_f32 v181, v181
    v_exp_f32 v178, v178
    v_mfma_f32_32x32x16_bf16 v[160:175], a[12:15], v[28:31], v[160:175]
    ds_read_b64_tr_b16 a[8:9], v242 offset:28672
    ds_read_b64_tr_b16 a[10:11], v242 offset:29184
    v_exp_f32 v182, v182
    s_waitcnt lgkmcnt(6)
    v_mfma_f32_32x32x16_bf16 v[160:175], a[16:19], v[32:35], v[160:175]
    ds_read_b64_tr_b16 a[12:13], v242 offset:30720
    ds_read_b64_tr_b16 a[14:15], v242 offset:31232
    v_exp_f32 v179, v179
    v_exp_f32 v183, v183
    v_mfma_f32_32x32x16_bf16 v[160:175], a[20:23], v[36:39], v[160:175]
    ds_read_b64_tr_b16 a[16:17], v242 offset:32768
    ds_read_b64_tr_b16 a[18:19], v242 offset:33280
    s_add_u32 s51, s51, 67584
    buffer_store_dwordx4 v[224:227], v237, s[16:19], s51 offen sc1
    v_add_f32 v176, 1.0, v176
    v_add_f32 v180, 1.0, v180
    v_mfma_f32_32x32x16_bf16 v[160:175], a[24:27], v[40:43], v[160:175]
    ds_read_b64_tr_b16 a[20:21], v242 offset:34816
    ds_read_b64_tr_b16 a[22:23], v242 offset:35328
    v_add_f32 v177, 1.0, v177
    v_add_f32 v181, 1.0, v181
    v_add_f32 v178, 1.0, v178
    v_add_f32 v182, 1.0, v182
    v_mfma_f32_32x32x16_bf16 v[160:175], a[28:31], v[44:47], v[160:175]
    ds_read_b64_tr_b16 a[24:25], v243 offset:0
    ds_read_b64_tr_b16 a[26:27], v243 offset:512
    v_add_f32 v179, 1.0, v179
    v_rcp_f32 v176, v176
    s_waitcnt lgkmcnt(6)
    v_mfma_f32_32x32x16_bf16 v[160:175], a[0:3], v[48:51], v[160:175]
    ds_read_b64_tr_b16 a[28:29], v243 offset:2048
    ds_read_b64_tr_b16 a[30:31], v243 offset:2560
    v_rcp_f32 v177, v177
    v_rcp_f32 v178, v178
    v_mfma_f32_32x32x16_bf16 v[160:175], a[4:7], v[52:55], v[160:175]
    ds_read_b64_tr_b16 a[0:1], v243 offset:4096
    ds_read_b64_tr_b16 a[2:3], v243 offset:4608
    buffer_load_dwordx4 v249, s[8:11], s46 offen offset:3072 lds
    v_add_f32 v183, 1.0, v183
    v_rcp_f32 v180, v180
    v_mfma_f32_32x32x16_bf16 v[160:175], a[8:11], v[56:59], v[160:175]
    ds_read_b64_tr_b16 a[4:5], v243 offset:6144
    ds_read_b64_tr_b16 a[6:7], v243 offset:6656
    v_rcp_f32 v181, v181
    v_rcp_f32 v182, v182
    v_mfma_f32_32x32x16_bf16 v[160:175], a[12:15], v[60:63], v[160:175]
    ds_read_b64_tr_b16 a[8:9], v243 offset:8192
    ds_read_b64_tr_b16 a[10:11], v243 offset:8704
    v_rcp_f32 v179, v179
    v_mul_f32 v176, v176, v144
    s_waitcnt lgkmcnt(6)
    v_mfma_f32_32x32x16_bf16 v[160:175], a[16:19], v[64:67], v[160:175]
    ds_read_b64_tr_b16 a[12:13], v243 offset:10240
    ds_read_b64_tr_b16 a[14:15], v243 offset:10752
    v_rcp_f32 v183, v183
    v_mul_f32 v180, v180, v148
    v_mul_f32 v177, v177, v145
    v_mfma_f32_32x32x16_bf16 v[160:175], a[20:23], v[68:71], v[160:175]
    ds_read_b64_tr_b16 a[16:17], v243 offset:12288
    ds_read_b64_tr_b16 a[18:19], v243 offset:12800
    s_add_u32 m0, s30, 110592
    s_add_u32 s46, s25, 2654336
    buffer_load_dwordx4 v246, s[8:11], s46 offen offset:0 lds
    v_mul_f32 v181, v181, v149
    v_mfma_f32_32x32x16_bf16 v[160:175], a[24:27], v[72:75], v[160:175]
    ds_read_b64_tr_b16 a[20:21], v243 offset:14336
    ds_read_b64_tr_b16 a[22:23], v243 offset:14848
    v_mul_f32 v178, v178, v146
    v_mul_f32 v182, v182, v150
    v_mul_f32 v179, v179, v147
    v_mul_f32 v183, v183, v151
    v_mfma_f32_32x32x16_bf16 v[160:175], a[28:31], v[76:79], v[160:175]
    ds_read_b64_tr_b16 a[24:25], v243 offset:16384
    ds_read_b64_tr_b16 a[26:27], v243 offset:16896
    v_cvt_pk_bf16_f32 v176, v176, v177
    v_cvt_pk_bf16_f32 v180, v180, v181
    v_cvt_pk_bf16_f32 v178, v178, v179
    s_waitcnt lgkmcnt(6)
    v_mfma_f32_32x32x16_bf16 v[160:175], a[0:3], v[80:83], v[160:175]
    ds_read_b64_tr_b16 a[28:29], v243 offset:18432
    ds_read_b64_tr_b16 a[30:31], v243 offset:18944
    v_cvt_pk_bf16_f32 v182, v182, v183
    v_accvgpr_write_b32 a32, v176
    v_accvgpr_write_b32 a34, v180
    v_accvgpr_write_b32 a33, v178
    v_mfma_f32_32x32x16_bf16 v[160:175], a[4:7], v[84:87], v[160:175]
    ds_read_b64_tr_b16 a[0:1], v243 offset:20480
    ds_read_b64_tr_b16 a[2:3], v243 offset:20992
    buffer_load_dwordx4 v247, s[8:11], s46 offen offset:1024 lds
    v_accvgpr_write_b32 a35, v182
    v_mul_f32 v176, v152, v245
    v_mul_f32 v180, v156, v245
    v_mfma_f32_32x32x16_bf16 v[160:175], a[8:11], v[88:91], v[160:175]
    ds_read_b64_tr_b16 a[4:5], v243 offset:22528
    ds_read_b64_tr_b16 a[6:7], v243 offset:23040
    v_mul_f32 v177, v153, v245
    v_mul_f32 v181, v157, v245
    v_mul_f32 v178, v154, v245
    v_mul_f32 v182, v158, v245
    v_mfma_f32_32x32x16_bf16 v[160:175], a[12:15], v[92:95], v[160:175]
    ds_read_b64_tr_b16 a[8:9], v243 offset:24576
    ds_read_b64_tr_b16 a[10:11], v243 offset:25088
    v_mul_f32 v179, v155, v245
    v_exp_f32 v176, v176
    s_waitcnt lgkmcnt(6)
    v_mfma_f32_32x32x16_bf16 v[160:175], a[16:19], v[96:99], v[160:175]
    ds_read_b64_tr_b16 a[12:13], v243 offset:26624
    ds_read_b64_tr_b16 a[14:15], v243 offset:27136
    v_exp_f32 v177, v177
    v_exp_f32 v178, v178
    v_mfma_f32_32x32x16_bf16 v[160:175], a[20:23], v[100:103], v[160:175]
    ds_read_b64_tr_b16 a[16:17], v243 offset:28672
    ds_read_b64_tr_b16 a[18:19], v243 offset:29184
    buffer_load_dwordx4 v248, s[8:11], s46 offen offset:2048 lds
    v_mul_f32 v183, v159, v245
    v_exp_f32 v180, v180
    v_mfma_f32_32x32x16_bf16 v[160:175], a[24:27], v[104:107], v[160:175]
    ds_read_b64_tr_b16 a[20:21], v243 offset:30720
    ds_read_b64_tr_b16 a[22:23], v243 offset:31232
    v_exp_f32 v181, v181
    v_exp_f32 v182, v182
    v_mfma_f32_32x32x16_bf16 v[160:175], a[28:31], v[108:111], v[160:175]
    ds_read_b64_tr_b16 a[24:25], v243 offset:32768
    ds_read_b64_tr_b16 a[26:27], v243 offset:33280
    v_exp_f32 v179, v179
    v_add_f32 v176, 1.0, v176
    s_waitcnt lgkmcnt(6)
    v_mfma_f32_32x32x16_bf16 v[160:175], a[0:3], v[112:115], v[160:175]
    ds_read_b64_tr_b16 a[28:29], v243 offset:34816
    ds_read_b64_tr_b16 a[30:31], v243 offset:35328
    v_exp_f32 v183, v183
    v_add_f32 v180, 1.0, v180
    v_add_f32 v177, 1.0, v177
    v_mfma_f32_32x32x16_bf16 v[160:175], a[4:7], v[116:119], v[160:175]
    s_waitcnt vmcnt(10)
    s_barrier
    ds_read_b64_tr_b16 a[0:1], v240 offset:0
    ds_read_b64_tr_b16 a[2:3], v240 offset:512
    buffer_load_dwordx4 v249, s[8:11], s46 offen offset:3072 lds
    v_add_f32 v181, 1.0, v181
    v_mfma_f32_32x32x16_bf16 v[160:175], a[8:11], v[120:123], v[160:175]
    ds_read_b64_tr_b16 a[4:5], v240 offset:2048
    ds_read_b64_tr_b16 a[6:7], v240 offset:2560
    v_add_f32 v178, 1.0, v178
    v_add_f32 v182, 1.0, v182
    v_add_f32 v179, 1.0, v179
    v_add_f32 v183, 1.0, v183
    v_mfma_f32_32x32x16_bf16 v[160:175], a[12:15], v[124:127], v[160:175]
    ds_read_b64_tr_b16 a[8:9], v240 offset:4096
    ds_read_b64_tr_b16 a[10:11], v240 offset:4608
    v_rcp_f32 v176, v176
    s_waitcnt lgkmcnt(6)
    v_mfma_f32_32x32x16_bf16 v[160:175], a[16:19], v[128:131], v[160:175]
    ds_read_b64_tr_b16 a[12:13], v240 offset:6144
    ds_read_b64_tr_b16 a[14:15], v240 offset:6656
    v_rcp_f32 v180, v180
    v_rcp_f32 v177, v177
    v_mfma_f32_32x32x16_bf16 v[160:175], a[20:23], v[132:135], v[160:175]
    ds_read_b64_tr_b16 a[16:17], v240 offset:8192
    ds_read_b64_tr_b16 a[18:19], v240 offset:8704
    s_add_u32 m0, s31, 110592
    s_add_u32 s46, s26, 2654336
    buffer_load_dwordx4 v246, s[8:11], s46 offen offset:0 lds
    v_mfma_f32_32x32x16_bf16 v[160:175], a[24:27], v[136:139], v[160:175]
    ds_read_b64_tr_b16 a[20:21], v240 offset:10240
    ds_read_b64_tr_b16 a[22:23], v240 offset:10752
    v_rcp_f32 v181, v181
    v_rcp_f32 v178, v178
    v_mfma_f32_32x32x16_bf16 v[160:175], a[28:31], v[140:143], v[160:175]
    ds_read_b64_tr_b16 a[24:25], v240 offset:12288
    ds_read_b64_tr_b16 a[26:27], v240 offset:12800
    v_rcp_f32 v182, v182
    v_rcp_f32 v179, v179
    v_rcp_f32 v183, v183
    v_mul_f32 v176, v176, v152
    v_mul_f32 v180, v180, v156
    v_mul_f32 v177, v177, v153
    v_mul_f32 v181, v181, v157
    v_mul_f32 v178, v178, v154
    v_mul_f32 v182, v182, v158
    v_mul_f32 v179, v179, v155
    v_mul_f32 v183, v183, v159
    v_cvt_pk_bf16_f32 v176, v176, v177
    v_cvt_pk_bf16_f32 v180, v180, v181
    v_cvt_pk_bf16_f32 v178, v178, v179
    v_cvt_pk_bf16_f32 v182, v182, v183
    v_accvgpr_write_b32 a36, v176
    v_accvgpr_write_b32 a38, v180
    v_accvgpr_write_b32 a37, v178
    v_accvgpr_write_b32 a39, v182
    s_waitcnt lgkmcnt(6)
    v_mfma_f32_32x32x16_bf16 v[144:159], a[0:3], v[0:3], 0
    ds_read_b64_tr_b16 a[28:29], v240 offset:14336
    ds_read_b64_tr_b16 a[30:31], v240 offset:14848
    s_add_u32 m0, s29, 0
    s_add_u32 s46, s24, 256
    buffer_load_dwordx4 v246, s[8:11], s46 offen offset:0 lds
    v_mul_f32 v176, v160, v245
    v_mfma_f32_32x32x16_bf16 v[144:159], a[4:7], v[4:7], v[144:159]
    ds_read_b64_tr_b16 a[0:1], v240 offset:16384
    ds_read_b64_tr_b16 a[2:3], v240 offset:16896
    buffer_load_dwordx4 v247, s[8:11], s46 offen offset:1024 lds
    v_add_u32 v242, 73728, v242
    v_add_u32 v243, 73728, v243
    v_mul_f32 v180, v164, v245
    v_mfma_f32_32x32x16_bf16 v[144:159], a[8:11], v[8:11], v[144:159]
    ds_read_b64_tr_b16 a[4:5], v240 offset:18432
    ds_read_b64_tr_b16 a[6:7], v240 offset:18944
    v_mul_f32 v177, v161, v245
    v_mul_f32 v181, v165, v245
    v_mul_f32 v178, v162, v245
    v_mul_f32 v182, v166, v245
    v_mfma_f32_32x32x16_bf16 v[144:159], a[12:15], v[12:15], v[144:159]
    ds_read_b64_tr_b16 a[8:9], v240 offset:20480
    ds_read_b64_tr_b16 a[10:11], v240 offset:20992
    v_mul_f32 v179, v163, v245
    v_exp_f32 v176, v176
    s_waitcnt lgkmcnt(6)
    v_mfma_f32_32x32x16_bf16 v[144:159], a[16:19], v[16:19], v[144:159]
    ds_read_b64_tr_b16 a[12:13], v240 offset:22528
    ds_read_b64_tr_b16 a[14:15], v240 offset:23040
    v_exp_f32 v177, v177
    v_exp_f32 v178, v178
    v_mfma_f32_32x32x16_bf16 v[144:159], a[20:23], v[20:23], v[144:159]
    ds_read_b64_tr_b16 a[16:17], v240 offset:24576
    ds_read_b64_tr_b16 a[18:19], v240 offset:25088
    buffer_load_dwordx4 v248, s[8:11], s46 offen offset:2048 lds
    v_mul_f32 v183, v167, v245
    v_exp_f32 v180, v180
    v_mfma_f32_32x32x16_bf16 v[144:159], a[24:27], v[24:27], v[144:159]
    ds_read_b64_tr_b16 a[20:21], v240 offset:26624
    ds_read_b64_tr_b16 a[22:23], v240 offset:27136
    v_exp_f32 v181, v181
    v_exp_f32 v182, v182
    v_mfma_f32_32x32x16_bf16 v[144:159], a[28:31], v[28:31], v[144:159]
    ds_read_b64_tr_b16 a[24:25], v240 offset:28672
    ds_read_b64_tr_b16 a[26:27], v240 offset:29184
    v_exp_f32 v179, v179
    v_add_f32 v176, 1.0, v176
    s_waitcnt lgkmcnt(6)
    v_mfma_f32_32x32x16_bf16 v[144:159], a[0:3], v[32:35], v[144:159]
    ds_read_b64_tr_b16 a[28:29], v240 offset:30720
    ds_read_b64_tr_b16 a[30:31], v240 offset:31232
    v_exp_f32 v183, v183
    v_add_f32 v180, 1.0, v180
    v_add_f32 v177, 1.0, v177
    v_mfma_f32_32x32x16_bf16 v[144:159], a[4:7], v[36:39], v[144:159]
    ds_read_b64_tr_b16 a[0:1], v240 offset:32768
    ds_read_b64_tr_b16 a[2:3], v240 offset:33280
    buffer_load_dwordx4 v249, s[8:11], s46 offen offset:3072 lds
    v_add_f32 v181, 1.0, v181
    v_add_f32 v178, 1.0, v178
    v_add_f32 v182, 1.0, v182
    v_mfma_f32_32x32x16_bf16 v[144:159], a[8:11], v[40:43], v[144:159]
    ds_read_b64_tr_b16 a[4:5], v240 offset:34816
    ds_read_b64_tr_b16 a[6:7], v240 offset:35328
    v_add_f32 v179, 1.0, v179
    v_add_f32 v183, 1.0, v183
    v_rcp_f32 v176, v176
    v_mfma_f32_32x32x16_bf16 v[144:159], a[12:15], v[44:47], v[144:159]
    s_waitcnt vmcnt(4)
    s_barrier
    ds_read_b64_tr_b16 a[8:9], v241 offset:0
    ds_read_b64_tr_b16 a[10:11], v241 offset:512
    s_waitcnt lgkmcnt(6)
    v_mfma_f32_32x32x16_bf16 v[144:159], a[16:19], v[48:51], v[144:159]
    ds_read_b64_tr_b16 a[12:13], v241 offset:2048
    ds_read_b64_tr_b16 a[14:15], v241 offset:2560
    s_mov_b64 exec, 1
    buffer_store_dword v255, off, s[16:19], s47 sc1
    s_mov_b64 exec, -1
    v_mfma_f32_32x32x16_bf16 v[144:159], a[20:23], v[52:55], v[144:159]
    ds_read_b64_tr_b16 a[16:17], v241 offset:4096
    ds_read_b64_tr_b16 a[18:19], v241 offset:4608
    s_add_u32 m0, s30, 0
    s_add_u32 s46, s25, 256
    buffer_load_dwordx4 v246, s[8:11], s46 offen offset:0 lds
    v_mfma_f32_32x32x16_bf16 v[144:159], a[24:27], v[56:59], v[144:159]
    ds_read_b64_tr_b16 a[20:21], v241 offset:6144
    ds_read_b64_tr_b16 a[22:23], v241 offset:6656
    v_rcp_f32 v180, v180
    v_rcp_f32 v177, v177
    v_mfma_f32_32x32x16_bf16 v[144:159], a[28:31], v[60:63], v[144:159]
    ds_read_b64_tr_b16 a[24:25], v241 offset:8192
    ds_read_b64_tr_b16 a[26:27], v241 offset:8704
    v_rcp_f32 v181, v181
    s_waitcnt lgkmcnt(6)
    v_mfma_f32_32x32x16_bf16 v[144:159], a[0:3], v[64:67], v[144:159]
    ds_read_b64_tr_b16 a[28:29], v241 offset:10240
    ds_read_b64_tr_b16 a[30:31], v241 offset:10752
    v_rcp_f32 v178, v178
    v_rcp_f32 v182, v182
    v_mfma_f32_32x32x16_bf16 v[144:159], a[4:7], v[68:71], v[144:159]
    ds_read_b64_tr_b16 a[0:1], v241 offset:12288
    ds_read_b64_tr_b16 a[2:3], v241 offset:12800
    buffer_load_dwordx4 v247, s[8:11], s46 offen offset:1024 lds
    v_rcp_f32 v179, v179
    v_mul_f32 v176, v176, v160
    v_mfma_f32_32x32x16_bf16 v[144:159], a[8:11], v[72:75], v[144:159]
    ds_read_b64_tr_b16 a[4:5], v241 offset:14336
    ds_read_b64_tr_b16 a[6:7], v241 offset:14848
    v_rcp_f32 v183, v183
    v_mul_f32 v180, v180, v164
    v_mul_f32 v177, v177, v161
    v_mfma_f32_32x32x16_bf16 v[144:159], a[12:15], v[76:79], v[144:159]
    ds_read_b64_tr_b16 a[8:9], v241 offset:16384
    ds_read_b64_tr_b16 a[10:11], v241 offset:16896
    v_mul_f32 v181, v181, v165
    v_mul_f32 v178, v178, v162
    v_mul_f32 v182, v182, v166
    s_waitcnt lgkmcnt(6)
    v_mfma_f32_32x32x16_bf16 v[144:159], a[16:19], v[80:83], v[144:159]
    ds_read_b64_tr_b16 a[12:13], v241 offset:18432
    ds_read_b64_tr_b16 a[14:15], v241 offset:18944
    v_mul_f32 v179, v179, v163
    v_mul_f32 v183, v183, v167
    v_cvt_pk_bf16_f32 v176, v176, v177
    v_cvt_pk_bf16_f32 v180, v180, v181
    v_mfma_f32_32x32x16_bf16 v[144:159], a[20:23], v[84:87], v[144:159]
    ds_read_b64_tr_b16 a[16:17], v241 offset:20480
    ds_read_b64_tr_b16 a[18:19], v241 offset:20992
    buffer_load_dwordx4 v248, s[8:11], s46 offen offset:2048 lds
    v_cvt_pk_bf16_f32 v178, v178, v179
    v_cvt_pk_bf16_f32 v182, v182, v183
    v_accvgpr_write_b32 a40, v176
    v_mfma_f32_32x32x16_bf16 v[144:159], a[24:27], v[88:91], v[144:159]
    ds_read_b64_tr_b16 a[20:21], v241 offset:22528
    ds_read_b64_tr_b16 a[22:23], v241 offset:23040
    v_accvgpr_write_b32 a42, v180
    v_accvgpr_write_b32 a41, v178
    v_accvgpr_write_b32 a43, v182
    v_mul_f32 v176, v168, v245
    v_mfma_f32_32x32x16_bf16 v[144:159], a[28:31], v[92:95], v[144:159]
    ds_read_b64_tr_b16 a[24:25], v241 offset:24576
    ds_read_b64_tr_b16 a[26:27], v241 offset:25088
    v_mul_f32 v180, v172, v245
    v_mul_f32 v177, v169, v245
    v_mul_f32 v181, v173, v245
    s_waitcnt lgkmcnt(6)
    v_mfma_f32_32x32x16_bf16 v[144:159], a[0:3], v[96:99], v[144:159]
    ds_read_b64_tr_b16 a[28:29], v241 offset:26624
    ds_read_b64_tr_b16 a[30:31], v241 offset:27136
    v_mul_f32 v178, v170, v245
    v_mul_f32 v182, v174, v245
    v_mul_f32 v179, v171, v245
    v_mul_f32 v183, v175, v245
    v_mfma_f32_32x32x16_bf16 v[144:159], a[4:7], v[100:103], v[144:159]
    ds_read_b64_tr_b16 a[0:1], v241 offset:28672
    ds_read_b64_tr_b16 a[2:3], v241 offset:29184
    buffer_load_dwordx4 v249, s[8:11], s46 offen offset:3072 lds
    v_exp_f32 v176, v176
    v_mfma_f32_32x32x16_bf16 v[144:159], a[8:11], v[104:107], v[144:159]
    ds_read_b64_tr_b16 a[4:5], v241 offset:30720
    ds_read_b64_tr_b16 a[6:7], v241 offset:31232
    v_exp_f32 v180, v180
    v_exp_f32 v177, v177
    v_mfma_f32_32x32x16_bf16 v[144:159], a[12:15], v[108:111], v[144:159]
    ds_read_b64_tr_b16 a[8:9], v241 offset:32768
    ds_read_b64_tr_b16 a[10:11], v241 offset:33280
    v_exp_f32 v181, v181
    s_waitcnt lgkmcnt(6)
    v_mfma_f32_32x32x16_bf16 v[144:159], a[16:19], v[112:115], v[144:159]
    ds_read_b64_tr_b16 a[12:13], v241 offset:34816
    ds_read_b64_tr_b16 a[14:15], v241 offset:35328
    v_exp_f32 v178, v178
    v_exp_f32 v182, v182
    v_mfma_f32_32x32x16_bf16 v[144:159], a[20:23], v[116:119], v[144:159]
    ds_read_b64_tr_b16 a[16:17], v242 offset:0
    ds_read_b64_tr_b16 a[18:19], v242 offset:512
    s_add_u32 m0, s31, 0
    s_add_u32 s46, s26, 256
    buffer_load_dwordx4 v246, s[8:11], s46 offen offset:0 lds
    v_mfma_f32_32x32x16_bf16 v[144:159], a[24:27], v[120:123], v[144:159]
    ds_read_b64_tr_b16 a[20:21], v242 offset:2048
    ds_read_b64_tr_b16 a[22:23], v242 offset:2560
    v_exp_f32 v179, v179
    v_exp_f32 v183, v183
    v_mfma_f32_32x32x16_bf16 v[144:159], a[28:31], v[124:127], v[144:159]
    ds_read_b64_tr_b16 a[24:25], v242 offset:4096
    ds_read_b64_tr_b16 a[26:27], v242 offset:4608
    v_add_f32 v176, 1.0, v176
    v_add_f32 v180, 1.0, v180
    v_add_f32 v177, 1.0, v177
    s_waitcnt lgkmcnt(6)
    v_mfma_f32_32x32x16_bf16 v[144:159], a[0:3], v[128:131], v[144:159]
    ds_read_b64_tr_b16 a[28:29], v242 offset:6144
    ds_read_b64_tr_b16 a[30:31], v242 offset:6656
    v_add_f32 v181, 1.0, v181
    v_add_f32 v178, 1.0, v178
    v_add_f32 v182, 1.0, v182
    v_add_f32 v179, 1.0, v179
    v_mfma_f32_32x32x16_bf16 v[144:159], a[4:7], v[132:135], v[144:159]
    ds_read_b64_tr_b16 a[0:1], v242 offset:8192
    ds_read_b64_tr_b16 a[2:3], v242 offset:8704
    s_add_u32 m0, s29, 36864
    s_add_u32 s46, s24, 2654464
    buffer_load_dwordx4 v246, s[8:11], s46 offen offset:0 lds
    v_add_f32 v183, 1.0, v183
    v_mfma_f32_32x32x16_bf16 v[144:159], a[8:11], v[136:139], v[144:159]
    ds_read_b64_tr_b16 a[4:5], v242 offset:10240
    ds_read_b64_tr_b16 a[6:7], v242 offset:10752
    v_rcp_f32 v176, v176
    v_rcp_f32 v180, v180
    v_mfma_f32_32x32x16_bf16 v[144:159], a[12:15], v[140:143], v[144:159]
    ds_read_b64_tr_b16 a[8:9], v242 offset:12288
    ds_read_b64_tr_b16 a[10:11], v242 offset:12800
    v_rcp_f32 v177, v177
    v_rcp_f32 v181, v181
    v_rcp_f32 v178, v178
    v_rcp_f32 v182, v182
    v_rcp_f32 v179, v179
    v_rcp_f32 v183, v183
    v_mul_f32 v176, v176, v168
    v_mul_f32 v180, v180, v172
    v_mul_f32 v177, v177, v169
    v_mul_f32 v181, v181, v173
    v_mul_f32 v178, v178, v170
    v_mul_f32 v182, v182, v174
    v_mul_f32 v179, v179, v171
    v_mul_f32 v183, v183, v175
    v_cvt_pk_bf16_f32 v176, v176, v177
    v_cvt_pk_bf16_f32 v180, v180, v181
    v_cvt_pk_bf16_f32 v178, v178, v179
    v_cvt_pk_bf16_f32 v182, v182, v183
    v_accvgpr_write_b32 a44, v176
    v_accvgpr_write_b32 a46, v180
    v_accvgpr_write_b32 a45, v178
    v_accvgpr_write_b32 a47, v182
    s_waitcnt lgkmcnt(6)
    v_mfma_f32_32x32x16_bf16 v[160:175], a[16:19], v[0:3], 0
    ds_read_b64_tr_b16 a[12:13], v242 offset:14336
    ds_read_b64_tr_b16 a[14:15], v242 offset:14848
    buffer_load_dwordx4 v247, s[8:11], s46 offen offset:1024 lds
    v_subrev_u32 v240, 73728, v240
    v_subrev_u32 v241, 73728, v241
    v_mul_f32 v176, v144, v245
    v_mfma_f32_32x32x16_bf16 v[160:175], a[20:23], v[4:7], v[160:175]
    ds_read_b64_tr_b16 a[16:17], v242 offset:16384
    ds_read_b64_tr_b16 a[18:19], v242 offset:16896
    buffer_load_dwordx4 v248, s[8:11], s46 offen offset:2048 lds
    v_mul_f32 v180, v148, v245
    v_mul_f32 v177, v145, v245
    v_mul_f32 v181, v149, v245
    v_mfma_f32_32x32x16_bf16 v[160:175], a[24:27], v[8:11], v[160:175]
    ds_read_b64_tr_b16 a[20:21], v242 offset:18432
    ds_read_b64_tr_b16 a[22:23], v242 offset:18944
    v_mul_f32 v178, v146, v245
    v_mul_f32 v182, v150, v245
    v_mul_f32 v179, v147, v245
    v_mul_f32 v183, v151, v245
    v_mfma_f32_32x32x16_bf16 v[160:175], a[28:31], v[12:15], v[160:175]
    ds_read_b64_tr_b16 a[24:25], v242 offset:20480
    ds_read_b64_tr_b16 a[26:27], v242 offset:20992
    v_exp_f32 v176, v176
    s_waitcnt lgkmcnt(6)
    v_mfma_f32_32x32x16_bf16 v[160:175], a[0:3], v[16:19], v[160:175]
    ds_read_b64_tr_b16 a[28:29], v242 offset:22528
    ds_read_b64_tr_b16 a[30:31], v242 offset:23040
    v_exp_f32 v180, v180
    v_exp_f32 v177, v177
    v_mfma_f32_32x32x16_bf16 v[160:175], a[4:7], v[20:23], v[160:175]
    ds_read_b64_tr_b16 a[0:1], v242 offset:24576
    ds_read_b64_tr_b16 a[2:3], v242 offset:25088
    buffer_load_dwordx4 v249, s[8:11], s46 offen offset:3072 lds
    v_exp_f32 v181, v181
    v_mfma_f32_32x32x16_bf16 v[160:175], a[8:11], v[24:27], v[160:175]
    ds_read_b64_tr_b16 a[4:5], v242 offset:26624
    ds_read_b64_tr_b16 a[6:7], v242 offset:27136
    v_exp_f32 v178, v178
    v_exp_f32 v182, v182
    v_mfma_f32_32x32x16_bf16 v[160:175], a[12:15], v[28:31], v[160:175]
    ds_read_b64_tr_b16 a[8:9], v242 offset:28672
    ds_read_b64_tr_b16 a[10:11], v242 offset:29184
    v_exp_f32 v179, v179
    v_add_f32 v176, 1.0, v176
    s_waitcnt lgkmcnt(6)
    v_mfma_f32_32x32x16_bf16 v[160:175], a[16:19], v[32:35], v[160:175]
    ds_read_b64_tr_b16 a[12:13], v242 offset:30720
    ds_read_b64_tr_b16 a[14:15], v242 offset:31232
    v_exp_f32 v183, v183
    v_add_f32 v180, 1.0, v180
    v_add_f32 v177, 1.0, v177
    v_mfma_f32_32x32x16_bf16 v[160:175], a[20:23], v[36:39], v[160:175]
    ds_read_b64_tr_b16 a[16:17], v242 offset:32768
    ds_read_b64_tr_b16 a[18:19], v242 offset:33280
    s_add_u32 m0, s30, 36864
    s_add_u32 s46, s25, 2654464
    buffer_load_dwordx4 v246, s[8:11], s46 offen offset:0 lds
    v_add_f32 v181, 1.0, v181
    v_mfma_f32_32x32x16_bf16 v[160:175], a[24:27], v[40:43], v[160:175]
    ds_read_b64_tr_b16 a[20:21], v242 offset:34816
    ds_read_b64_tr_b16 a[22:23], v242 offset:35328
    v_add_f32 v178, 1.0, v178
    v_add_f32 v182, 1.0, v182
    v_add_f32 v179, 1.0, v179
    v_add_f32 v183, 1.0, v183
    v_mfma_f32_32x32x16_bf16 v[160:175], a[28:31], v[44:47], v[160:175]
    ds_read_b64_tr_b16 a[24:25], v243 offset:0
    ds_read_b64_tr_b16 a[26:27], v243 offset:512
    v_rcp_f32 v176, v176
    s_waitcnt lgkmcnt(6)
    v_mfma_f32_32x32x16_bf16 v[160:175], a[0:3], v[48:51], v[160:175]
    ds_read_b64_tr_b16 a[28:29], v243 offset:2048
    ds_read_b64_tr_b16 a[30:31], v243 offset:2560
    v_rcp_f32 v180, v180
    v_rcp_f32 v177, v177
    v_mfma_f32_32x32x16_bf16 v[160:175], a[4:7], v[52:55], v[160:175]
    ds_read_b64_tr_b16 a[0:1], v243 offset:4096
    ds_read_b64_tr_b16 a[2:3], v243 offset:4608
    buffer_load_dwordx4 v247, s[8:11], s46 offen offset:1024 lds
    v_rcp_f32 v181, v181
    v_mfma_f32_32x32x16_bf16 v[160:175], a[8:11], v[56:59], v[160:175]
    ds_read_b64_tr_b16 a[4:5], v243 offset:6144
    ds_read_b64_tr_b16 a[6:7], v243 offset:6656
    v_rcp_f32 v178, v178
    v_rcp_f32 v182, v182
    v_mfma_f32_32x32x16_bf16 v[160:175], a[12:15], v[60:63], v[160:175]
    ds_read_b64_tr_b16 a[8:9], v243 offset:8192
    ds_read_b64_tr_b16 a[10:11], v243 offset:8704
    v_rcp_f32 v179, v179
    v_mul_f32 v176, v176, v144
    s_waitcnt lgkmcnt(6)
    v_mfma_f32_32x32x16_bf16 v[160:175], a[16:19], v[64:67], v[160:175]
    ds_read_b64_tr_b16 a[12:13], v243 offset:10240
    ds_read_b64_tr_b16 a[14:15], v243 offset:10752
    v_rcp_f32 v183, v183
    v_mul_f32 v180, v180, v148
    v_mul_f32 v177, v177, v145
    v_mfma_f32_32x32x16_bf16 v[160:175], a[20:23], v[68:71], v[160:175]
    ds_read_b64_tr_b16 a[16:17], v243 offset:12288
    ds_read_b64_tr_b16 a[18:19], v243 offset:12800
    buffer_load_dwordx4 v248, s[8:11], s46 offen offset:2048 lds
    v_mul_f32 v181, v181, v149
    v_mul_f32 v178, v178, v146
    v_mul_f32 v182, v182, v150
    v_mfma_f32_32x32x16_bf16 v[160:175], a[24:27], v[72:75], v[160:175]
    ds_read_b64_tr_b16 a[20:21], v243 offset:14336
    ds_read_b64_tr_b16 a[22:23], v243 offset:14848
    v_mul_f32 v179, v179, v147
    v_mul_f32 v183, v183, v151
    v_cvt_pk_bf16_f32 v176, v176, v177
    v_cvt_pk_bf16_f32 v180, v180, v181
    v_mfma_f32_32x32x16_bf16 v[160:175], a[28:31], v[76:79], v[160:175]
    ds_read_b64_tr_b16 a[24:25], v243 offset:16384
    ds_read_b64_tr_b16 a[26:27], v243 offset:16896
    v_cvt_pk_bf16_f32 v178, v178, v179
    v_cvt_pk_bf16_f32 v182, v182, v183
    v_accvgpr_write_b32 a48, v176
    s_waitcnt lgkmcnt(6)
    v_mfma_f32_32x32x16_bf16 v[160:175], a[0:3], v[80:83], v[160:175]
    ds_read_b64_tr_b16 a[28:29], v243 offset:18432
    ds_read_b64_tr_b16 a[30:31], v243 offset:18944
    v_accvgpr_write_b32 a50, v180
    v_accvgpr_write_b32 a49, v178
    v_accvgpr_write_b32 a51, v182
    v_mul_f32 v176, v152, v245
    v_mfma_f32_32x32x16_bf16 v[160:175], a[4:7], v[84:87], v[160:175]
    ds_read_b64_tr_b16 a[0:1], v243 offset:20480
    ds_read_b64_tr_b16 a[2:3], v243 offset:20992
    buffer_load_dwordx4 v249, s[8:11], s46 offen offset:3072 lds
    v_mul_f32 v180, v156, v245
    v_mul_f32 v177, v153, v245
    v_mul_f32 v181, v157, v245
    v_mfma_f32_32x32x16_bf16 v[160:175], a[8:11], v[88:91], v[160:175]
    ds_read_b64_tr_b16 a[4:5], v243 offset:22528
    ds_read_b64_tr_b16 a[6:7], v243 offset:23040
    v_mul_f32 v178, v154, v245
    v_mul_f32 v182, v158, v245
    v_mul_f32 v179, v155, v245
    v_mul_f32 v183, v159, v245
    v_mfma_f32_32x32x16_bf16 v[160:175], a[12:15], v[92:95], v[160:175]
    ds_read_b64_tr_b16 a[8:9], v243 offset:24576
    ds_read_b64_tr_b16 a[10:11], v243 offset:25088
    v_exp_f32 v176, v176
    s_waitcnt lgkmcnt(6)
    v_mfma_f32_32x32x16_bf16 v[160:175], a[16:19], v[96:99], v[160:175]
    ds_read_b64_tr_b16 a[12:13], v243 offset:26624
    ds_read_b64_tr_b16 a[14:15], v243 offset:27136
    v_exp_f32 v180, v180
    v_exp_f32 v177, v177
    v_mfma_f32_32x32x16_bf16 v[160:175], a[20:23], v[100:103], v[160:175]
    ds_read_b64_tr_b16 a[16:17], v243 offset:28672
    ds_read_b64_tr_b16 a[18:19], v243 offset:29184
    s_add_u32 m0, s31, 36864
    s_add_u32 s46, s26, 2654464
    buffer_load_dwordx4 v246, s[8:11], s46 offen offset:0 lds
    v_mfma_f32_32x32x16_bf16 v[160:175], a[24:27], v[104:107], v[160:175]
    ds_read_b64_tr_b16 a[20:21], v243 offset:30720
    ds_read_b64_tr_b16 a[22:23], v243 offset:31232
    v_exp_f32 v181, v181
    v_exp_f32 v178, v178
    v_mfma_f32_32x32x16_bf16 v[160:175], a[28:31], v[108:111], v[160:175]
    ds_read_b64_tr_b16 a[24:25], v243 offset:32768
    ds_read_b64_tr_b16 a[26:27], v243 offset:33280
    v_exp_f32 v182, v182
    s_waitcnt lgkmcnt(6)
    v_mfma_f32_32x32x16_bf16 v[160:175], a[0:3], v[112:115], v[160:175]
    ds_read_b64_tr_b16 a[28:29], v243 offset:34816
    ds_read_b64_tr_b16 a[30:31], v243 offset:35328
    v_exp_f32 v179, v179
    v_exp_f32 v183, v183
    v_mfma_f32_32x32x16_bf16 v[160:175], a[4:7], v[116:119], v[160:175]
    s_waitcnt vmcnt(9)
    s_barrier
    ds_read_b64_tr_b16 a[0:1], v240 offset:0
    ds_read_b64_tr_b16 a[2:3], v240 offset:512
    s_add_u32 m0, s29, 73728
    s_add_u32 s46, s24, 384
    buffer_load_dwordx4 v246, s[8:11], s46 offen offset:0 lds
    v_mfma_f32_32x32x16_bf16 v[160:175], a[8:11], v[120:123], v[160:175]
    ds_read_b64_tr_b16 a[4:5], v240 offset:2048
    ds_read_b64_tr_b16 a[6:7], v240 offset:2560
    v_add_f32 v176, 1.0, v176
    v_add_f32 v180, 1.0, v180
    v_add_f32 v177, 1.0, v177
    v_add_f32 v181, 1.0, v181
    v_mfma_f32_32x32x16_bf16 v[160:175], a[12:15], v[124:127], v[160:175]
    ds_read_b64_tr_b16 a[8:9], v240 offset:4096
    ds_read_b64_tr_b16 a[10:11], v240 offset:4608
    v_add_f32 v178, 1.0, v178
    v_add_f32 v182, 1.0, v182
    v_add_f32 v179, 1.0, v179
    s_waitcnt lgkmcnt(6)
    v_mfma_f32_32x32x16_bf16 v[160:175], a[16:19], v[128:131], v[160:175]
    ds_read_b64_tr_b16 a[12:13], v240 offset:6144
    ds_read_b64_tr_b16 a[14:15], v240 offset:6656
    v_rcp_f32 v176, v176
    v_rcp_f32 v177, v177
    v_mfma_f32_32x32x16_bf16 v[160:175], a[20:23], v[132:135], v[160:175]
    ds_read_b64_tr_b16 a[16:17], v240 offset:8192
    ds_read_b64_tr_b16 a[18:19], v240 offset:8704
    buffer_load_dwordx4 v247, s[8:11], s46 offen offset:1024 lds
    v_add_f32 v183, 1.0, v183
    v_rcp_f32 v180, v180
    v_mfma_f32_32x32x16_bf16 v[160:175], a[24:27], v[136:139], v[160:175]
    ds_read_b64_tr_b16 a[20:21], v240 offset:10240
    ds_read_b64_tr_b16 a[22:23], v240 offset:10752
    v_rcp_f32 v181, v181
    v_rcp_f32 v178, v178
    v_mfma_f32_32x32x16_bf16 v[160:175], a[28:31], v[140:143], v[160:175]
    ds_read_b64_tr_b16 a[24:25], v240 offset:12288
    ds_read_b64_tr_b16 a[26:27], v240 offset:12800
    v_rcp_f32 v182, v182
    v_rcp_f32 v179, v179
    v_rcp_f32 v183, v183
    v_mul_f32 v176, v176, v152
    v_mul_f32 v180, v180, v156
    v_mul_f32 v177, v177, v153
    v_mul_f32 v181, v181, v157
    v_mul_f32 v178, v178, v154
    v_mul_f32 v182, v182, v158
    v_mul_f32 v179, v179, v155
    v_mul_f32 v183, v183, v159
    v_cvt_pk_bf16_f32 v176, v176, v177
    v_cvt_pk_bf16_f32 v180, v180, v181
    v_cvt_pk_bf16_f32 v178, v178, v179
    v_cvt_pk_bf16_f32 v182, v182, v183
    v_accvgpr_write_b32 a52, v176
    v_accvgpr_write_b32 a54, v180
    v_accvgpr_write_b32 a53, v178
    v_accvgpr_write_b32 a55, v182
    s_waitcnt lgkmcnt(6)
    v_mfma_f32_32x32x16_bf16 v[144:159], a[0:3], v[0:3], 0
    ds_read_b64_tr_b16 a[28:29], v240 offset:14336
    ds_read_b64_tr_b16 a[30:31], v240 offset:14848
    buffer_load_dwordx4 v248, s[8:11], s46 offen offset:2048 lds
    v_subrev_u32 v242, 73728, v242
    v_subrev_u32 v243, 73728, v243
    v_mul_f32 v176, v160, v245
    v_mfma_f32_32x32x16_bf16 v[144:159], a[4:7], v[4:7], v[144:159]
    ds_read_b64_tr_b16 a[0:1], v240 offset:16384
    ds_read_b64_tr_b16 a[2:3], v240 offset:16896
    buffer_load_dwordx4 v249, s[8:11], s46 offen offset:3072 lds
    v_mul_f32 v180, v164, v245
    v_mul_f32 v177, v161, v245
    v_mul_f32 v181, v165, v245
    v_mfma_f32_32x32x16_bf16 v[144:159], a[8:11], v[8:11], v[144:159]
    ds_read_b64_tr_b16 a[4:5], v240 offset:18432
    ds_read_b64_tr_b16 a[6:7], v240 offset:18944
    v_mul_f32 v178, v162, v245
    v_mul_f32 v182, v166, v245
    v_mul_f32 v179, v163, v245
    v_mul_f32 v183, v167, v245
    v_mfma_f32_32x32x16_bf16 v[144:159], a[12:15], v[12:15], v[144:159]
    ds_read_b64_tr_b16 a[8:9], v240 offset:20480
    ds_read_b64_tr_b16 a[10:11], v240 offset:20992
    v_exp_f32 v176, v176
    s_waitcnt lgkmcnt(6)
    v_mfma_f32_32x32x16_bf16 v[144:159], a[16:19], v[16:19], v[144:159]
    ds_read_b64_tr_b16 a[12:13], v240 offset:22528
    ds_read_b64_tr_b16 a[14:15], v240 offset:23040
    v_exp_f32 v180, v180
    v_exp_f32 v177, v177
    v_mfma_f32_32x32x16_bf16 v[144:159], a[20:23], v[20:23], v[144:159]
    ds_read_b64_tr_b16 a[16:17], v240 offset:24576
    ds_read_b64_tr_b16 a[18:19], v240 offset:25088
    s_add_u32 m0, s30, 73728
    s_add_u32 s46, s25, 384
    buffer_load_dwordx4 v246, s[8:11], s46 offen offset:0 lds
    v_mfma_f32_32x32x16_bf16 v[144:159], a[24:27], v[24:27], v[144:159]
    ds_read_b64_tr_b16 a[20:21], v240 offset:26624
    ds_read_b64_tr_b16 a[22:23], v240 offset:27136
    v_exp_f32 v181, v181
    v_exp_f32 v178, v178
    v_mfma_f32_32x32x16_bf16 v[144:159], a[28:31], v[28:31], v[144:159]
    ds_read_b64_tr_b16 a[24:25], v240 offset:28672
    ds_read_b64_tr_b16 a[26:27], v240 offset:29184
    v_exp_f32 v182, v182
    s_waitcnt lgkmcnt(6)
    v_mfma_f32_32x32x16_bf16 v[144:159], a[0:3], v[32:35], v[144:159]
    ds_read_b64_tr_b16 a[28:29], v240 offset:30720
    ds_read_b64_tr_b16 a[30:31], v240 offset:31232
    v_exp_f32 v179, v179
    v_exp_f32 v183, v183
    v_mfma_f32_32x32x16_bf16 v[144:159], a[4:7], v[36:39], v[144:159]
    ds_read_b64_tr_b16 a[0:1], v240 offset:32768
    ds_read_b64_tr_b16 a[2:3], v240 offset:33280
    buffer_load_dwordx4 v247, s[8:11], s46 offen offset:1024 lds
    v_add_f32 v176, 1.0, v176
    v_add_f32 v180, 1.0, v180
    v_add_f32 v177, 1.0, v177
    v_mfma_f32_32x32x16_bf16 v[144:159], a[8:11], v[40:43], v[144:159]
    ds_read_b64_tr_b16 a[4:5], v240 offset:34816
    ds_read_b64_tr_b16 a[6:7], v240 offset:35328
    v_add_f32 v181, 1.0, v181
    v_add_f32 v178, 1.0, v178
    v_add_f32 v182, 1.0, v182
    v_add_f32 v179, 1.0, v179
    v_mfma_f32_32x32x16_bf16 v[144:159], a[12:15], v[44:47], v[144:159]
    s_waitcnt vmcnt(6)
    s_barrier
    ds_read_b64_tr_b16 a[8:9], v241 offset:0
    ds_read_b64_tr_b16 a[10:11], v241 offset:512
    v_add_f32 v183, 1.0, v183
    s_waitcnt lgkmcnt(6)
    v_mfma_f32_32x32x16_bf16 v[144:159], a[16:19], v[48:51], v[144:159]
    ds_read_b64_tr_b16 a[12:13], v241 offset:2048
    ds_read_b64_tr_b16 a[14:15], v241 offset:2560
    v_rcp_f32 v176, v176
    v_rcp_f32 v180, v180
    v_mfma_f32_32x32x16_bf16 v[144:159], a[20:23], v[52:55], v[144:159]
    ds_read_b64_tr_b16 a[16:17], v241 offset:4096
    ds_read_b64_tr_b16 a[18:19], v241 offset:4608
    buffer_load_dwordx4 v248, s[8:11], s46 offen offset:2048 lds
    v_rcp_f32 v177, v177
    v_mfma_f32_32x32x16_bf16 v[144:159], a[24:27], v[56:59], v[144:159]
    ds_read_b64_tr_b16 a[20:21], v241 offset:6144
    ds_read_b64_tr_b16 a[22:23], v241 offset:6656
    v_rcp_f32 v181, v181
    v_rcp_f32 v178, v178
    v_mfma_f32_32x32x16_bf16 v[144:159], a[28:31], v[60:63], v[144:159]
    ds_read_b64_tr_b16 a[24:25], v241 offset:8192
    ds_read_b64_tr_b16 a[26:27], v241 offset:8704
    v_rcp_f32 v182, v182
    s_waitcnt lgkmcnt(6)
    v_mfma_f32_32x32x16_bf16 v[144:159], a[0:3], v[64:67], v[144:159]
    ds_read_b64_tr_b16 a[28:29], v241 offset:10240
    ds_read_b64_tr_b16 a[30:31], v241 offset:10752
    v_rcp_f32 v179, v179
    v_rcp_f32 v183, v183
    v_mfma_f32_32x32x16_bf16 v[144:159], a[4:7], v[68:71], v[144:159]
    ds_read_b64_tr_b16 a[0:1], v241 offset:12288
    ds_read_b64_tr_b16 a[2:3], v241 offset:12800
    buffer_load_dwordx4 v249, s[8:11], s46 offen offset:3072 lds
    v_mul_f32 v176, v176, v160
    v_mul_f32 v180, v180, v164
    v_mul_f32 v177, v177, v161
    v_mfma_f32_32x32x16_bf16 v[144:159], a[8:11], v[72:75], v[144:159]
    ds_read_b64_tr_b16 a[4:5], v241 offset:14336
    ds_read_b64_tr_b16 a[6:7], v241 offset:14848
    v_mul_f32 v181, v181, v165
    v_mul_f32 v178, v178, v162
    v_mul_f32 v182, v182, v166
    v_mul_f32 v179, v179, v163
    v_mfma_f32_32x32x16_bf16 v[144:159], a[12:15], v[76:79], v[144:159]
    ds_read_b64_tr_b16 a[8:9], v241 offset:16384
    ds_read_b64_tr_b16 a[10:11], v241 offset:16896
    v_mul_f32 v183, v183, v167
    v_cvt_pk_bf16_f32 v176, v176, v177
    v_cvt_pk_bf16_f32 v180, v180, v181
    s_waitcnt lgkmcnt(6)
    v_mfma_f32_32x32x16_bf16 v[144:159], a[16:19], v[80:83], v[144:159]
    ds_read_b64_tr_b16 a[12:13], v241 offset:18432
    ds_read_b64_tr_b16 a[14:15], v241 offset:18944
    v_cvt_pk_bf16_f32 v178, v178, v179
    v_cvt_pk_bf16_f32 v182, v182, v183
    v_accvgpr_write_b32 a56, v176
    v_accvgpr_write_b32 a58, v180
    v_mfma_f32_32x32x16_bf16 v[144:159], a[20:23], v[84:87], v[144:159]
    ds_read_b64_tr_b16 a[16:17], v241 offset:20480
    ds_read_b64_tr_b16 a[18:19], v241 offset:20992
    s_add_u32 m0, s31, 73728
    s_add_u32 s46, s26, 384
    buffer_load_dwordx4 v246, s[8:11], s46 offen offset:0 lds
    v_accvgpr_write_b32 a57, v178
    v_mfma_f32_32x32x16_bf16 v[144:159], a[24:27], v[88:91], v[144:159]
    ds_read_b64_tr_b16 a[20:21], v241 offset:22528
    ds_read_b64_tr_b16 a[22:23], v241 offset:23040
    v_accvgpr_write_b32 a59, v182
    v_mul_f32 v176, v168, v245
    v_mul_f32 v180, v172, v245
    v_mul_f32 v177, v169, v245
    v_mfma_f32_32x32x16_bf16 v[144:159], a[28:31], v[92:95], v[144:159]
    ds_read_b64_tr_b16 a[24:25], v241 offset:24576
    ds_read_b64_tr_b16 a[26:27], v241 offset:25088
    v_mul_f32 v181, v173, v245
    v_mul_f32 v178, v170, v245
    v_mul_f32 v182, v174, v245
    s_waitcnt lgkmcnt(6)
    v_mfma_f32_32x32x16_bf16 v[144:159], a[0:3], v[96:99], v[144:159]
    ds_read_b64_tr_b16 a[28:29], v241 offset:26624
    ds_read_b64_tr_b16 a[30:31], v241 offset:27136
    v_mul_f32 v179, v171, v245
    v_mul_f32 v183, v175, v245
    v_exp_f32 v176, v176
    v_mfma_f32_32x32x16_bf16 v[144:159], a[4:7], v[100:103], v[144:159]
    ds_read_b64_tr_b16 a[0:1], v241 offset:28672
    ds_read_b64_tr_b16 a[2:3], v241 offset:29184
    s_add_u32 m0, s29, 110592
    s_add_u32 s46, s24, 2654592
    buffer_load_dwordx4 v246, s[8:11], s46 offen offset:0 lds
    v_mfma_f32_32x32x16_bf16 v[144:159], a[8:11], v[104:107], v[144:159]
    ds_read_b64_tr_b16 a[4:5], v241 offset:30720
    ds_read_b64_tr_b16 a[6:7], v241 offset:31232
    v_exp_f32 v180, v180
    v_exp_f32 v177, v177
    v_mfma_f32_32x32x16_bf16 v[144:159], a[12:15], v[108:111], v[144:159]
    ds_read_b64_tr_b16 a[8:9], v241 offset:32768
    ds_read_b64_tr_b16 a[10:11], v241 offset:33280
    v_exp_f32 v181, v181
    s_waitcnt lgkmcnt(6)
    v_mfma_f32_32x32x16_bf16 v[144:159], a[16:19], v[112:115], v[144:159]
    ds_read_b64_tr_b16 a[12:13], v241 offset:34816
    ds_read_b64_tr_b16 a[14:15], v241 offset:35328
    v_exp_f32 v178, v178
    v_exp_f32 v182, v182
    v_mfma_f32_32x32x16_bf16 v[144:159], a[20:23], v[116:119], v[144:159]
    ds_read_b64_tr_b16 a[16:17], v242 offset:0
    ds_read_b64_tr_b16 a[18:19], v242 offset:512
    buffer_load_dwordx4 v247, s[8:11], s46 offen offset:1024 lds
    v_exp_f32 v179, v179
    v_add_f32 v176, 1.0, v176
    v_mfma_f32_32x32x16_bf16 v[144:159], a[24:27], v[120:123], v[144:159]
    ds_read_b64_tr_b16 a[20:21], v242 offset:2048
    ds_read_b64_tr_b16 a[22:23], v242 offset:2560
    v_exp_f32 v183, v183
    v_add_f32 v180, 1.0, v180
    v_add_f32 v177, 1.0, v177
    v_mfma_f32_32x32x16_bf16 v[144:159], a[28:31], v[124:127], v[144:159]
    ds_read_b64_tr_b16 a[24:25], v242 offset:4096
    ds_read_b64_tr_b16 a[26:27], v242 offset:4608
    v_add_f32 v181, 1.0, v181
    v_add_f32 v178, 1.0, v178
    v_add_f32 v182, 1.0, v182
    s_waitcnt lgkmcnt(6)
    v_mfma_f32_32x32x16_bf16 v[144:159], a[0:3], v[128:131], v[144:159]
    ds_read_b64_tr_b16 a[28:29], v242 offset:6144
    ds_read_b64_tr_b16 a[30:31], v242 offset:6656
    v_add_f32 v179, 1.0, v179
    v_add_f32 v183, 1.0, v183
    v_rcp_f32 v176, v176
    v_mfma_f32_32x32x16_bf16 v[144:159], a[4:7], v[132:135], v[144:159]
    ds_read_b64_tr_b16 a[0:1], v242 offset:8192
    ds_read_b64_tr_b16 a[2:3], v242 offset:8704
    buffer_load_dwordx4 v248, s[8:11], s46 offen offset:2048 lds
    v_rcp_f32 v180, v180
    v_mfma_f32_32x32x16_bf16 v[144:159], a[8:11], v[136:139], v[144:159]
    ds_read_b64_tr_b16 a[4:5], v242 offset:10240
    ds_read_b64_tr_b16 a[6:7], v242 offset:10752
    v_rcp_f32 v177, v177
    v_rcp_f32 v181, v181
    v_mfma_f32_32x32x16_bf16 v[144:159], a[12:15], v[140:143], v[144:159]
    ds_read_b64_tr_b16 a[8:9], v242 offset:12288
    ds_read_b64_tr_b16 a[10:11], v242 offset:12800
    v_rcp_f32 v178, v178
    v_rcp_f32 v182, v182
    v_rcp_f32 v179, v179
    v_rcp_f32 v183, v183
    v_mul_f32 v176, v176, v168
    v_mul_f32 v180, v180, v172
    v_mul_f32 v177, v177, v169
    v_mul_f32 v181, v181, v173
    v_mul_f32 v178, v178, v170
    v_mul_f32 v182, v182, v174
    v_mul_f32 v179, v179, v171
    v_mul_f32 v183, v183, v175
    v_cvt_pk_bf16_f32 v176, v176, v177
    v_cvt_pk_bf16_f32 v180, v180, v181
    v_cvt_pk_bf16_f32 v178, v178, v179
    v_cvt_pk_bf16_f32 v182, v182, v183
    v_accvgpr_write_b32 a60, v176
    v_accvgpr_write_b32 a62, v180
    v_accvgpr_write_b32 a61, v178
    v_accvgpr_write_b32 a63, v182
    s_waitcnt lgkmcnt(6)
    v_mfma_f32_32x32x16_bf16 v[160:175], a[16:19], v[0:3], 0
    ds_read_b64_tr_b16 a[12:13], v242 offset:14336
    ds_read_b64_tr_b16 a[14:15], v242 offset:14848
    buffer_load_dwordx4 v249, s[8:11], s46 offen offset:3072 lds
    v_add_u32 v240, 73728, v240
    v_add_u32 v241, 73728, v241
    v_mul_f32 v176, v144, v245
    v_mfma_f32_32x32x16_bf16 v[160:175], a[20:23], v[4:7], v[160:175]
    ds_read_b64_tr_b16 a[16:17], v242 offset:16384
    ds_read_b64_tr_b16 a[18:19], v242 offset:16896
    s_add_u32 m0, s30, 110592
    s_add_u32 s46, s25, 2654592
    buffer_load_dwordx4 v246, s[8:11], s46 offen offset:0 lds
    v_mul_f32 v180, v148, v245
    v_mfma_f32_32x32x16_bf16 v[160:175], a[24:27], v[8:11], v[160:175]
    ds_read_b64_tr_b16 a[20:21], v242 offset:18432
    ds_read_b64_tr_b16 a[22:23], v242 offset:18944
    v_mul_f32 v177, v145, v245
    v_mul_f32 v181, v149, v245
    v_mul_f32 v178, v146, v245
    v_mul_f32 v182, v150, v245
    v_mfma_f32_32x32x16_bf16 v[160:175], a[28:31], v[12:15], v[160:175]
    ds_read_b64_tr_b16 a[24:25], v242 offset:20480
    ds_read_b64_tr_b16 a[26:27], v242 offset:20992
    v_mul_f32 v179, v147, v245
    v_exp_f32 v176, v176
    s_waitcnt lgkmcnt(6)
    v_mfma_f32_32x32x16_bf16 v[160:175], a[0:3], v[16:19], v[160:175]
    ds_read_b64_tr_b16 a[28:29], v242 offset:22528
    ds_read_b64_tr_b16 a[30:31], v242 offset:23040
    v_exp_f32 v177, v177
    v_exp_f32 v178, v178
    v_mfma_f32_32x32x16_bf16 v[160:175], a[4:7], v[20:23], v[160:175]
    ds_read_b64_tr_b16 a[0:1], v242 offset:24576
    ds_read_b64_tr_b16 a[2:3], v242 offset:25088
    buffer_load_dwordx4 v247, s[8:11], s46 offen offset:1024 lds
    v_mul_f32 v183, v151, v245
    v_exp_f32 v180, v180
    v_mfma_f32_32x32x16_bf16 v[160:175], a[8:11], v[24:27], v[160:175]
    ds_read_b64_tr_b16 a[4:5], v242 offset:26624
    ds_read_b64_tr_b16 a[6:7], v242 offset:27136
    v_exp_f32 v181, v181
    v_exp_f32 v182, v182
    v_mfma_f32_32x32x16_bf16 v[160:175], a[12:15], v[28:31], v[160:175]
    ds_read_b64_tr_b16 a[8:9], v242 offset:28672
    ds_read_b64_tr_b16 a[10:11], v242 offset:29184
    v_exp_f32 v179, v179
    v_add_f32 v176, 1.0, v176
    s_waitcnt lgkmcnt(6)
    v_mfma_f32_32x32x16_bf16 v[160:175], a[16:19], v[32:35], v[160:175]
    ds_read_b64_tr_b16 a[12:13], v242 offset:30720
    ds_read_b64_tr_b16 a[14:15], v242 offset:31232
    v_exp_f32 v183, v183
    v_add_f32 v180, 1.0, v180
    v_add_f32 v177, 1.0, v177
    v_mfma_f32_32x32x16_bf16 v[160:175], a[20:23], v[36:39], v[160:175]
    ds_read_b64_tr_b16 a[16:17], v242 offset:32768
    ds_read_b64_tr_b16 a[18:19], v242 offset:33280
    buffer_load_dwordx4 v248, s[8:11], s46 offen offset:2048 lds
    v_add_f32 v181, 1.0, v181
    v_add_f32 v178, 1.0, v178
    v_add_f32 v182, 1.0, v182
    v_mfma_f32_32x32x16_bf16 v[160:175], a[24:27], v[40:43], v[160:175]
    ds_read_b64_tr_b16 a[20:21], v242 offset:34816
    ds_read_b64_tr_b16 a[22:23], v242 offset:35328
    v_add_f32 v179, 1.0, v179
    v_add_f32 v183, 1.0, v183
    v_rcp_f32 v176, v176
    v_mfma_f32_32x32x16_bf16 v[160:175], a[28:31], v[44:47], v[160:175]
    ds_read_b64_tr_b16 a[24:25], v243 offset:0
    ds_read_b64_tr_b16 a[26:27], v243 offset:512
    v_rcp_f32 v180, v180
    s_waitcnt lgkmcnt(6)
    v_mfma_f32_32x32x16_bf16 v[160:175], a[0:3], v[48:51], v[160:175]
    ds_read_b64_tr_b16 a[28:29], v243 offset:2048
    ds_read_b64_tr_b16 a[30:31], v243 offset:2560
    v_rcp_f32 v177, v177
    v_rcp_f32 v181, v181
    v_mfma_f32_32x32x16_bf16 v[160:175], a[4:7], v[52:55], v[160:175]
    ds_read_b64_tr_b16 a[0:1], v243 offset:4096
    ds_read_b64_tr_b16 a[2:3], v243 offset:4608
    buffer_load_dwordx4 v249, s[8:11], s46 offen offset:3072 lds
    v_rcp_f32 v178, v178
    v_mfma_f32_32x32x16_bf16 v[160:175], a[8:11], v[56:59], v[160:175]
    ds_read_b64_tr_b16 a[4:5], v243 offset:6144
    ds_read_b64_tr_b16 a[6:7], v243 offset:6656
    v_rcp_f32 v182, v182
    v_rcp_f32 v179, v179
    v_mfma_f32_32x32x16_bf16 v[160:175], a[12:15], v[60:63], v[160:175]
    ds_read_b64_tr_b16 a[8:9], v243 offset:8192
    ds_read_b64_tr_b16 a[10:11], v243 offset:8704
    v_mul_f32 v176, v176, v144
    v_rcp_f32 v183, v183
    s_waitcnt lgkmcnt(6)
    v_mfma_f32_32x32x16_bf16 v[160:175], a[16:19], v[64:67], v[160:175]
    ds_read_b64_tr_b16 a[12:13], v243 offset:10240
    ds_read_b64_tr_b16 a[14:15], v243 offset:10752
    v_mul_f32 v180, v180, v148
    v_mul_f32 v177, v177, v145
    v_mul_f32 v181, v181, v149
    v_mul_f32 v178, v178, v146
    v_mfma_f32_32x32x16_bf16 v[160:175], a[20:23], v[68:71], v[160:175]
    ds_read_b64_tr_b16 a[16:17], v243 offset:12288
    ds_read_b64_tr_b16 a[18:19], v243 offset:12800
    s_add_u32 m0, s31, 110592
    s_add_u32 s46, s26, 2654592
    buffer_load_dwordx4 v246, s[8:11], s46 offen offset:0 lds
    v_mul_f32 v182, v182, v150
    v_mfma_f32_32x32x16_bf16 v[160:175], a[24:27], v[72:75], v[160:175]
    ds_read_b64_tr_b16 a[20:21], v243 offset:14336
    ds_read_b64_tr_b16 a[22:23], v243 offset:14848
    v_mul_f32 v179, v179, v147
    v_mul_f32 v183, v183, v151
    v_cvt_pk_bf16_f32 v176, v176, v177
    v_cvt_pk_bf16_f32 v180, v180, v181
    v_mfma_f32_32x32x16_bf16 v[160:175], a[28:31], v[76:79], v[160:175]
    ds_read_b64_tr_b16 a[24:25], v243 offset:16384
    ds_read_b64_tr_b16 a[26:27], v243 offset:16896
    v_cvt_pk_bf16_f32 v178, v178, v179
    v_cvt_pk_bf16_f32 v182, v182, v183
    v_accvgpr_write_b32 a64, v176
    s_waitcnt lgkmcnt(6)
    v_mfma_f32_32x32x16_bf16 v[160:175], a[0:3], v[80:83], v[160:175]
    ds_read_b64_tr_b16 a[28:29], v243 offset:18432
    ds_read_b64_tr_b16 a[30:31], v243 offset:18944
    v_accvgpr_write_b32 a66, v180
    v_accvgpr_write_b32 a65, v178
    v_accvgpr_write_b32 a67, v182
    v_mul_f32 v176, v152, v245
    v_mfma_f32_32x32x16_bf16 v[160:175], a[4:7], v[84:87], v[160:175]
    ds_read_b64_tr_b16 a[0:1], v243 offset:20480
    ds_read_b64_tr_b16 a[2:3], v243 offset:20992
    v_mul_f32 v180, v156, v245
    v_mul_f32 v177, v153, v245
    v_mul_f32 v181, v157, v245
    v_mul_f32 v178, v154, v245
    v_mfma_f32_32x32x16_bf16 v[160:175], a[8:11], v[88:91], v[160:175]
    ds_read_b64_tr_b16 a[4:5], v243 offset:22528
    ds_read_b64_tr_b16 a[6:7], v243 offset:23040
    v_mul_f32 v182, v158, v245
    v_mul_f32 v179, v155, v245
    v_exp_f32 v176, v176
    v_mfma_f32_32x32x16_bf16 v[160:175], a[12:15], v[92:95], v[160:175]
    ds_read_b64_tr_b16 a[8:9], v243 offset:24576
    ds_read_b64_tr_b16 a[10:11], v243 offset:25088
    v_mul_f32 v183, v159, v245
    v_exp_f32 v180, v180
    s_waitcnt lgkmcnt(6)
    v_mfma_f32_32x32x16_bf16 v[160:175], a[16:19], v[96:99], v[160:175]
    ds_read_b64_tr_b16 a[12:13], v243 offset:26624
    ds_read_b64_tr_b16 a[14:15], v243 offset:27136
    v_exp_f32 v177, v177
    v_exp_f32 v181, v181
    v_mfma_f32_32x32x16_bf16 v[160:175], a[20:23], v[100:103], v[160:175]
    ds_read_b64_tr_b16 a[16:17], v243 offset:28672
    ds_read_b64_tr_b16 a[18:19], v243 offset:29184
    v_exp_f32 v178, v178
    v_exp_f32 v182, v182
    v_mfma_f32_32x32x16_bf16 v[160:175], a[24:27], v[104:107], v[160:175]
    ds_read_b64_tr_b16 a[20:21], v243 offset:30720
    ds_read_b64_tr_b16 a[22:23], v243 offset:31232
    v_exp_f32 v179, v179
    v_exp_f32 v183, v183
    v_mfma_f32_32x32x16_bf16 v[160:175], a[28:31], v[108:111], v[160:175]
    ds_read_b64_tr_b16 a[24:25], v243 offset:32768
    ds_read_b64_tr_b16 a[26:27], v243 offset:33280
    v_add_f32 v176, 1.0, v176
    v_add_f32 v180, 1.0, v180
    v_add_f32 v177, 1.0, v177
    s_waitcnt lgkmcnt(6)
    v_mfma_f32_32x32x16_bf16 v[160:175], a[0:3], v[112:115], v[160:175]
    ds_read_b64_tr_b16 a[28:29], v243 offset:34816
    ds_read_b64_tr_b16 a[30:31], v243 offset:35328
    v_add_f32 v181, 1.0, v181
    v_add_f32 v178, 1.0, v178
    v_add_f32 v182, 1.0, v182
    v_add_f32 v179, 1.0, v179
    v_mfma_f32_32x32x16_bf16 v[160:175], a[4:7], v[116:119], v[160:175]
    s_waitcnt vmcnt(9)
    s_barrier
    ds_read_b64_tr_b16 a[0:1], v240 offset:0
    ds_read_b64_tr_b16 a[2:3], v240 offset:512
    s_add_u32 m0, s29, 0
    s_add_u32 s46, s24, 512
    buffer_load_dwordx4 v246, s[8:11], s46 offen offset:0 lds
    v_mfma_f32_32x32x16_bf16 v[160:175], a[8:11], v[120:123], v[160:175]
    ds_read_b64_tr_b16 a[4:5], v240 offset:2048
    ds_read_b64_tr_b16 a[6:7], v240 offset:2560
    v_rcp_f32 v176, v176
    v_rcp_f32 v177, v177
    v_mfma_f32_32x32x16_bf16 v[160:175], a[12:15], v[124:127], v[160:175]
    ds_read_b64_tr_b16 a[8:9], v240 offset:4096
    ds_read_b64_tr_b16 a[10:11], v240 offset:4608
    v_add_f32 v183, 1.0, v183
    v_rcp_f32 v180, v180
    s_waitcnt lgkmcnt(6)
    v_mfma_f32_32x32x16_bf16 v[160:175], a[16:19], v[128:131], v[160:175]
    ds_read_b64_tr_b16 a[12:13], v240 offset:6144
    ds_read_b64_tr_b16 a[14:15], v240 offset:6656
    v_rcp_f32 v181, v181
    v_rcp_f32 v178, v178
    v_mfma_f32_32x32x16_bf16 v[160:175], a[20:23], v[132:135], v[160:175]
    ds_read_b64_tr_b16 a[16:17], v240 offset:8192
    ds_read_b64_tr_b16 a[18:19], v240 offset:8704
    buffer_load_dwordx4 v247, s[8:11], s46 offen offset:1024 lds
    v_rcp_f32 v182, v182
    v_mfma_f32_32x32x16_bf16 v[160:175], a[24:27], v[136:139], v[160:175]
    ds_read_b64_tr_b16 a[20:21], v240 offset:10240
    ds_read_b64_tr_b16 a[22:23], v240 offset:10752
    v_rcp_f32 v179, v179
    v_rcp_f32 v183, v183
    v_mfma_f32_32x32x16_bf16 v[160:175], a[28:31], v[140:143], v[160:175]
    ds_read_b64_tr_b16 a[24:25], v240 offset:12288
    ds_read_b64_tr_b16 a[26:27], v240 offset:12800
    v_mul_f32 v176, v176, v152
    v_mul_f32 v180, v180, v156
    v_mul_f32 v177, v177, v153
    v_mul_f32 v181, v181, v157
    v_mul_f32 v178, v178, v154
    v_mul_f32 v182, v182, v158
    v_mul_f32 v179, v179, v155
    v_mul_f32 v183, v183, v159
    v_cvt_pk_bf16_f32 v176, v176, v177
    v_cvt_pk_bf16_f32 v180, v180, v181
    v_cvt_pk_bf16_f32 v178, v178, v179
    v_cvt_pk_bf16_f32 v182, v182, v183
    v_accvgpr_write_b32 a68, v176
    v_accvgpr_write_b32 a70, v180
    v_accvgpr_write_b32 a69, v178
    v_accvgpr_write_b32 a71, v182
    s_waitcnt lgkmcnt(6)
    v_mfma_f32_32x32x16_bf16 v[144:159], a[0:3], v[0:3], 0
    ds_read_b64_tr_b16 a[28:29], v240 offset:14336
    ds_read_b64_tr_b16 a[30:31], v240 offset:14848
    buffer_load_dwordx4 v248, s[8:11], s46 offen offset:2048 lds
    v_add_u32 v242, 73728, v242
    v_add_u32 v243, 73728, v243
    v_mul_f32 v176, v160, v245
    v_mfma_f32_32x32x16_bf16 v[144:159], a[4:7], v[4:7], v[144:159]
    ds_read_b64_tr_b16 a[0:1], v240 offset:16384
    ds_read_b64_tr_b16 a[2:3], v240 offset:16896
    buffer_load_dwordx4 v249, s[8:11], s46 offen offset:3072 lds
    v_mul_f32 v180, v164, v245
    v_mul_f32 v177, v161, v245
    v_mul_f32 v181, v165, v245
    v_mfma_f32_32x32x16_bf16 v[144:159], a[8:11], v[8:11], v[144:159]
    ds_read_b64_tr_b16 a[4:5], v240 offset:18432
    ds_read_b64_tr_b16 a[6:7], v240 offset:18944
    v_mul_f32 v178, v162, v245
    v_mul_f32 v182, v166, v245
    v_mul_f32 v179, v163, v245
    v_mul_f32 v183, v167, v245
    v_mfma_f32_32x32x16_bf16 v[144:159], a[12:15], v[12:15], v[144:159]
    ds_read_b64_tr_b16 a[8:9], v240 offset:20480
    ds_read_b64_tr_b16 a[10:11], v240 offset:20992
    v_exp_f32 v176, v176
    s_waitcnt lgkmcnt(6)
    v_mfma_f32_32x32x16_bf16 v[144:159], a[16:19], v[16:19], v[144:159]
    ds_read_b64_tr_b16 a[12:13], v240 offset:22528
    ds_read_b64_tr_b16 a[14:15], v240 offset:23040
    v_exp_f32 v180, v180
    v_exp_f32 v177, v177
    v_mfma_f32_32x32x16_bf16 v[144:159], a[20:23], v[20:23], v[144:159]
    ds_read_b64_tr_b16 a[16:17], v240 offset:24576
    ds_read_b64_tr_b16 a[18:19], v240 offset:25088
    s_add_u32 m0, s30, 0
    s_add_u32 s46, s25, 512
    buffer_load_dwordx4 v246, s[8:11], s46 offen offset:0 lds
    v_mfma_f32_32x32x16_bf16 v[144:159], a[24:27], v[24:27], v[144:159]
    ds_read_b64_tr_b16 a[20:21], v240 offset:26624
    ds_read_b64_tr_b16 a[22:23], v240 offset:27136
    v_exp_f32 v181, v181
    v_exp_f32 v178, v178
    v_mfma_f32_32x32x16_bf16 v[144:159], a[28:31], v[28:31], v[144:159]
    ds_read_b64_tr_b16 a[24:25], v240 offset:28672
    ds_read_b64_tr_b16 a[26:27], v240 offset:29184
    v_exp_f32 v182, v182
    s_waitcnt lgkmcnt(6)
    v_mfma_f32_32x32x16_bf16 v[144:159], a[0:3], v[32:35], v[144:159]
    ds_read_b64_tr_b16 a[28:29], v240 offset:30720
    ds_read_b64_tr_b16 a[30:31], v240 offset:31232
    v_exp_f32 v179, v179
    v_exp_f32 v183, v183
    v_mfma_f32_32x32x16_bf16 v[144:159], a[4:7], v[36:39], v[144:159]
    ds_read_b64_tr_b16 a[0:1], v240 offset:32768
    ds_read_b64_tr_b16 a[2:3], v240 offset:33280
    buffer_load_dwordx4 v247, s[8:11], s46 offen offset:1024 lds
    v_add_f32 v176, 1.0, v176
    v_add_f32 v180, 1.0, v180
    v_add_f32 v177, 1.0, v177
    v_mfma_f32_32x32x16_bf16 v[144:159], a[8:11], v[40:43], v[144:159]
    ds_read_b64_tr_b16 a[4:5], v240 offset:34816
    ds_read_b64_tr_b16 a[6:7], v240 offset:35328
    v_add_f32 v181, 1.0, v181
    v_add_f32 v178, 1.0, v178
    v_add_f32 v182, 1.0, v182
    v_add_f32 v179, 1.0, v179
    v_mfma_f32_32x32x16_bf16 v[144:159], a[12:15], v[44:47], v[144:159]
    s_waitcnt vmcnt(6)
    s_barrier
    ds_read_b64_tr_b16 a[8:9], v241 offset:0
    ds_read_b64_tr_b16 a[10:11], v241 offset:512
    v_add_f32 v183, 1.0, v183
    s_waitcnt lgkmcnt(6)
    v_mfma_f32_32x32x16_bf16 v[144:159], a[16:19], v[48:51], v[144:159]
    ds_read_b64_tr_b16 a[12:13], v241 offset:2048
    ds_read_b64_tr_b16 a[14:15], v241 offset:2560
    v_rcp_f32 v176, v176
    v_rcp_f32 v180, v180
    v_mfma_f32_32x32x16_bf16 v[144:159], a[20:23], v[52:55], v[144:159]
    ds_read_b64_tr_b16 a[16:17], v241 offset:4096
    ds_read_b64_tr_b16 a[18:19], v241 offset:4608
    buffer_load_dwordx4 v248, s[8:11], s46 offen offset:2048 lds
    v_rcp_f32 v177, v177
    v_mfma_f32_32x32x16_bf16 v[144:159], a[24:27], v[56:59], v[144:159]
    ds_read_b64_tr_b16 a[20:21], v241 offset:6144
    ds_read_b64_tr_b16 a[22:23], v241 offset:6656
    v_rcp_f32 v181, v181
    v_rcp_f32 v178, v178
    v_mfma_f32_32x32x16_bf16 v[144:159], a[28:31], v[60:63], v[144:159]
    ds_read_b64_tr_b16 a[24:25], v241 offset:8192
    ds_read_b64_tr_b16 a[26:27], v241 offset:8704
    v_rcp_f32 v182, v182
    s_waitcnt lgkmcnt(6)
    v_mfma_f32_32x32x16_bf16 v[144:159], a[0:3], v[64:67], v[144:159]
    ds_read_b64_tr_b16 a[28:29], v241 offset:10240
    ds_read_b64_tr_b16 a[30:31], v241 offset:10752
    v_rcp_f32 v179, v179
    v_rcp_f32 v183, v183
    v_mfma_f32_32x32x16_bf16 v[144:159], a[4:7], v[68:71], v[144:159]
    ds_read_b64_tr_b16 a[0:1], v241 offset:12288
    ds_read_b64_tr_b16 a[2:3], v241 offset:12800
    buffer_load_dwordx4 v249, s[8:11], s46 offen offset:3072 lds
    v_mul_f32 v176, v176, v160
    v_mul_f32 v180, v180, v164
    v_mul_f32 v177, v177, v161
    v_mfma_f32_32x32x16_bf16 v[144:159], a[8:11], v[72:75], v[144:159]
    ds_read_b64_tr_b16 a[4:5], v241 offset:14336
    ds_read_b64_tr_b16 a[6:7], v241 offset:14848
    v_mul_f32 v181, v181, v165
    v_mul_f32 v178, v178, v162
    v_mul_f32 v182, v182, v166
    v_mul_f32 v179, v179, v163
    v_mfma_f32_32x32x16_bf16 v[144:159], a[12:15], v[76:79], v[144:159]
    ds_read_b64_tr_b16 a[8:9], v241 offset:16384
    ds_read_b64_tr_b16 a[10:11], v241 offset:16896
    v_mul_f32 v183, v183, v167
    v_cvt_pk_bf16_f32 v184, v176, v177
    v_cvt_pk_bf16_f32 v186, v180, v181
    s_waitcnt lgkmcnt(6)
    v_mfma_f32_32x32x16_bf16 v[144:159], a[16:19], v[80:83], v[144:159]
    ds_read_b64_tr_b16 a[12:13], v241 offset:18432
    ds_read_b64_tr_b16 a[14:15], v241 offset:18944
    v_cvt_pk_bf16_f32 v185, v178, v179
    v_cvt_pk_bf16_f32 v187, v182, v183
    v_mul_f32 v176, v168, v245
    v_mul_f32 v180, v172, v245
    v_mfma_f32_32x32x16_bf16 v[144:159], a[20:23], v[84:87], v[144:159]
    ds_read_b64_tr_b16 a[16:17], v241 offset:20480
    ds_read_b64_tr_b16 a[18:19], v241 offset:20992
    s_add_u32 m0, s31, 0
    s_add_u32 s46, s26, 512
    buffer_load_dwordx4 v246, s[8:11], s46 offen offset:0 lds
    v_mul_f32 v177, v169, v245
    v_mfma_f32_32x32x16_bf16 v[144:159], a[24:27], v[88:91], v[144:159]
    ds_read_b64_tr_b16 a[20:21], v241 offset:22528
    ds_read_b64_tr_b16 a[22:23], v241 offset:23040
    v_mul_f32 v181, v173, v245
    v_mul_f32 v178, v170, v245
    v_mul_f32 v182, v174, v245
    v_mul_f32 v179, v171, v245
    v_mfma_f32_32x32x16_bf16 v[144:159], a[28:31], v[92:95], v[144:159]
    ds_read_b64_tr_b16 a[24:25], v241 offset:24576
    ds_read_b64_tr_b16 a[26:27], v241 offset:25088
    v_mul_f32 v183, v175, v245
    v_exp_f32 v176, v176
    s_waitcnt lgkmcnt(6)
    v_mfma_f32_32x32x16_bf16 v[144:159], a[0:3], v[96:99], v[144:159]
    ds_read_b64_tr_b16 a[28:29], v241 offset:26624
    ds_read_b64_tr_b16 a[30:31], v241 offset:27136
    v_exp_f32 v180, v180
    v_exp_f32 v177, v177
    v_mfma_f32_32x32x16_bf16 v[144:159], a[4:7], v[100:103], v[144:159]
    ds_read_b64_tr_b16 a[0:1], v241 offset:28672
    ds_read_b64_tr_b16 a[2:3], v241 offset:29184
    s_add_u32 m0, s29, 36864
    s_add_u32 s46, s24, 2654720
    buffer_load_dwordx4 v246, s[8:11], s46 offen offset:0 lds
    v_mfma_f32_32x32x16_bf16 v[144:159], a[8:11], v[104:107], v[144:159]
    ds_read_b64_tr_b16 a[4:5], v241 offset:30720
    ds_read_b64_tr_b16 a[6:7], v241 offset:31232
    v_exp_f32 v181, v181
    v_exp_f32 v178, v178
    v_mfma_f32_32x32x16_bf16 v[144:159], a[12:15], v[108:111], v[144:159]
    ds_read_b64_tr_b16 a[8:9], v241 offset:32768
    ds_read_b64_tr_b16 a[10:11], v241 offset:33280
    v_exp_f32 v182, v182
    s_waitcnt lgkmcnt(6)
    v_mfma_f32_32x32x16_bf16 v[144:159], a[16:19], v[112:115], v[144:159]
    ds_read_b64_tr_b16 a[12:13], v241 offset:34816
    ds_read_b64_tr_b16 a[14:15], v241 offset:35328
    v_exp_f32 v179, v179
    v_exp_f32 v183, v183
    v_mfma_f32_32x32x16_bf16 v[144:159], a[20:23], v[116:119], v[144:159]
    ds_read_b64_tr_b16 a[16:17], v242 offset:0
    ds_read_b64_tr_b16 a[18:19], v242 offset:512
    buffer_load_dwordx4 v247, s[8:11], s46 offen offset:1024 lds
    v_add_f32 v176, 1.0, v176
    v_add_f32 v180, 1.0, v180
    v_add_f32 v177, 1.0, v177
    v_mfma_f32_32x32x16_bf16 v[144:159], a[24:27], v[120:123], v[144:159]
    ds_read_b64_tr_b16 a[20:21], v242 offset:2048
    ds_read_b64_tr_b16 a[22:23], v242 offset:2560
    v_add_f32 v181, 1.0, v181
    v_add_f32 v178, 1.0, v178
    v_add_f32 v182, 1.0, v182
    v_add_f32 v179, 1.0, v179
    v_mfma_f32_32x32x16_bf16 v[144:159], a[28:31], v[124:127], v[144:159]
    ds_read_b64_tr_b16 a[24:25], v242 offset:4096
    ds_read_b64_tr_b16 a[26:27], v242 offset:4608
    v_add_f32 v183, 1.0, v183
    v_rcp_f32 v176, v176
    s_waitcnt lgkmcnt(6)
    v_mfma_f32_32x32x16_bf16 v[144:159], a[0:3], v[128:131], v[144:159]
    ds_read_b64_tr_b16 a[28:29], v242 offset:6144
    ds_read_b64_tr_b16 a[30:31], v242 offset:6656
    v_rcp_f32 v180, v180
    v_rcp_f32 v177, v177
    v_mfma_f32_32x32x16_bf16 v[144:159], a[4:7], v[132:135], v[144:159]
    ds_read_b64_tr_b16 a[0:1], v242 offset:8192
    ds_read_b64_tr_b16 a[2:3], v242 offset:8704
    buffer_load_dwordx4 v248, s[8:11], s46 offen offset:2048 lds
    v_rcp_f32 v181, v181
    v_mfma_f32_32x32x16_bf16 v[144:159], a[8:11], v[136:139], v[144:159]
    ds_read_b64_tr_b16 a[4:5], v242 offset:10240
    ds_read_b64_tr_b16 a[6:7], v242 offset:10752
    v_rcp_f32 v178, v178
    v_rcp_f32 v182, v182
    v_mfma_f32_32x32x16_bf16 v[144:159], a[12:15], v[140:143], v[144:159]
    ds_read_b64_tr_b16 a[8:9], v242 offset:12288
    ds_read_b64_tr_b16 a[10:11], v242 offset:12800
    v_rcp_f32 v179, v179
    v_rcp_f32 v183, v183
    v_mul_f32 v176, v176, v168
    v_mul_f32 v180, v180, v172
    v_mul_f32 v177, v177, v169
    v_mul_f32 v181, v181, v173
    v_mul_f32 v178, v178, v170
    v_mul_f32 v182, v182, v174
    v_mul_f32 v179, v179, v171
    v_mul_f32 v183, v183, v175
    v_cvt_pk_bf16_f32 v188, v176, v177
    v_cvt_pk_bf16_f32 v190, v180, v181
    v_cvt_pk_bf16_f32 v189, v178, v179
    v_cvt_pk_bf16_f32 v191, v182, v183
    s_waitcnt lgkmcnt(6)
    v_mfma_f32_32x32x16_bf16 v[160:175], a[16:19], v[0:3], 0
    ds_read_b64_tr_b16 a[12:13], v242 offset:14336
    ds_read_b64_tr_b16 a[14:15], v242 offset:14848
    buffer_load_dwordx4 v249, s[8:11], s46 offen offset:3072 lds
    v_subrev_u32 v240, 73728, v240
    v_subrev_u32 v241, 73728, v241
    v_mul_f32 v176, v144, v245
    v_mfma_f32_32x32x16_bf16 v[160:175], a[20:23], v[4:7], v[160:175]
    ds_read_b64_tr_b16 a[16:17], v242 offset:16384
    ds_read_b64_tr_b16 a[18:19], v242 offset:16896
    s_add_u32 m0, s30, 36864
    s_add_u32 s46, s25, 2654720
    buffer_load_dwordx4 v246, s[8:11], s46 offen offset:0 lds
    v_mul_f32 v180, v148, v245
    v_mfma_f32_32x32x16_bf16 v[160:175], a[24:27], v[8:11], v[160:175]
    ds_read_b64_tr_b16 a[20:21], v242 offset:18432
    ds_read_b64_tr_b16 a[22:23], v242 offset:18944
    v_mul_f32 v177, v145, v245
    v_mul_f32 v181, v149, v245
    v_mul_f32 v178, v146, v245
    v_mul_f32 v182, v150, v245
    v_mfma_f32_32x32x16_bf16 v[160:175], a[28:31], v[12:15], v[160:175]
    ds_read_b64_tr_b16 a[24:25], v242 offset:20480
    ds_read_b64_tr_b16 a[26:27], v242 offset:20992
    v_mul_f32 v179, v147, v245
    v_exp_f32 v176, v176
    s_waitcnt lgkmcnt(6)
    v_mfma_f32_32x32x16_bf16 v[160:175], a[0:3], v[16:19], v[160:175]
    ds_read_b64_tr_b16 a[28:29], v242 offset:22528
    ds_read_b64_tr_b16 a[30:31], v242 offset:23040
    v_exp_f32 v177, v177
    v_exp_f32 v178, v178
    v_mfma_f32_32x32x16_bf16 v[160:175], a[4:7], v[20:23], v[160:175]
    ds_read_b64_tr_b16 a[0:1], v242 offset:24576
    ds_read_b64_tr_b16 a[2:3], v242 offset:25088
    buffer_load_dwordx4 v247, s[8:11], s46 offen offset:1024 lds
    v_mul_f32 v183, v151, v245
    v_exp_f32 v180, v180
    v_mfma_f32_32x32x16_bf16 v[160:175], a[8:11], v[24:27], v[160:175]
    ds_read_b64_tr_b16 a[4:5], v242 offset:26624
    ds_read_b64_tr_b16 a[6:7], v242 offset:27136
    v_exp_f32 v181, v181
    v_exp_f32 v182, v182
    v_mfma_f32_32x32x16_bf16 v[160:175], a[12:15], v[28:31], v[160:175]
    ds_read_b64_tr_b16 a[8:9], v242 offset:28672
    ds_read_b64_tr_b16 a[10:11], v242 offset:29184
    v_exp_f32 v179, v179
    v_add_f32 v176, 1.0, v176
    s_waitcnt lgkmcnt(6)
    v_mfma_f32_32x32x16_bf16 v[160:175], a[16:19], v[32:35], v[160:175]
    ds_read_b64_tr_b16 a[12:13], v242 offset:30720
    ds_read_b64_tr_b16 a[14:15], v242 offset:31232
    v_exp_f32 v183, v183
    v_add_f32 v180, 1.0, v180
    v_add_f32 v177, 1.0, v177
    v_mfma_f32_32x32x16_bf16 v[160:175], a[20:23], v[36:39], v[160:175]
    ds_read_b64_tr_b16 a[16:17], v242 offset:32768
    ds_read_b64_tr_b16 a[18:19], v242 offset:33280
    buffer_load_dwordx4 v248, s[8:11], s46 offen offset:2048 lds
    v_add_f32 v181, 1.0, v181
    v_add_f32 v178, 1.0, v178
    v_add_f32 v182, 1.0, v182
    v_mfma_f32_32x32x16_bf16 v[160:175], a[24:27], v[40:43], v[160:175]
    ds_read_b64_tr_b16 a[20:21], v242 offset:34816
    ds_read_b64_tr_b16 a[22:23], v242 offset:35328
    v_add_f32 v179, 1.0, v179
    v_add_f32 v183, 1.0, v183
    v_rcp_f32 v176, v176
    v_mfma_f32_32x32x16_bf16 v[160:175], a[28:31], v[44:47], v[160:175]
    ds_read_b64_tr_b16 a[24:25], v243 offset:0
    ds_read_b64_tr_b16 a[26:27], v243 offset:512
    v_rcp_f32 v180, v180
    s_waitcnt lgkmcnt(6)
    v_mfma_f32_32x32x16_bf16 v[160:175], a[0:3], v[48:51], v[160:175]
    ds_read_b64_tr_b16 a[28:29], v243 offset:2048
    ds_read_b64_tr_b16 a[30:31], v243 offset:2560
    v_rcp_f32 v177, v177
    v_rcp_f32 v181, v181
    v_mfma_f32_32x32x16_bf16 v[160:175], a[4:7], v[52:55], v[160:175]
    ds_read_b64_tr_b16 a[0:1], v243 offset:4096
    ds_read_b64_tr_b16 a[2:3], v243 offset:4608
    buffer_load_dwordx4 v249, s[8:11], s46 offen offset:3072 lds
    v_rcp_f32 v178, v178
    v_mfma_f32_32x32x16_bf16 v[160:175], a[8:11], v[56:59], v[160:175]
    ds_read_b64_tr_b16 a[4:5], v243 offset:6144
    ds_read_b64_tr_b16 a[6:7], v243 offset:6656
    v_rcp_f32 v182, v182
    v_rcp_f32 v179, v179
    v_mfma_f32_32x32x16_bf16 v[160:175], a[12:15], v[60:63], v[160:175]
    ds_read_b64_tr_b16 a[8:9], v243 offset:8192
    ds_read_b64_tr_b16 a[10:11], v243 offset:8704
    v_mul_f32 v176, v176, v144
    v_rcp_f32 v183, v183
    s_waitcnt lgkmcnt(6)
    v_mfma_f32_32x32x16_bf16 v[160:175], a[16:19], v[64:67], v[160:175]
    ds_read_b64_tr_b16 a[12:13], v243 offset:10240
    ds_read_b64_tr_b16 a[14:15], v243 offset:10752
    v_mul_f32 v180, v180, v148
    v_mul_f32 v177, v177, v145
    v_mul_f32 v181, v181, v149
    v_mul_f32 v178, v178, v146
    v_mfma_f32_32x32x16_bf16 v[160:175], a[20:23], v[68:71], v[160:175]
    ds_read_b64_tr_b16 a[16:17], v243 offset:12288
    ds_read_b64_tr_b16 a[18:19], v243 offset:12800
    s_add_u32 m0, s31, 36864
    s_add_u32 s46, s26, 2654720
    buffer_load_dwordx4 v246, s[8:11], s46 offen offset:0 lds
    v_mul_f32 v182, v182, v150
    v_mfma_f32_32x32x16_bf16 v[160:175], a[24:27], v[72:75], v[160:175]
    ds_read_b64_tr_b16 a[20:21], v243 offset:14336
    ds_read_b64_tr_b16 a[22:23], v243 offset:14848
    v_mul_f32 v179, v179, v147
    v_mul_f32 v183, v183, v151
    v_cvt_pk_bf16_f32 v192, v176, v177
    v_cvt_pk_bf16_f32 v194, v180, v181
    v_mfma_f32_32x32x16_bf16 v[160:175], a[28:31], v[76:79], v[160:175]
    ds_read_b64_tr_b16 a[24:25], v243 offset:16384
    ds_read_b64_tr_b16 a[26:27], v243 offset:16896
    v_cvt_pk_bf16_f32 v193, v178, v179
    v_cvt_pk_bf16_f32 v195, v182, v183
    v_mul_f32 v176, v152, v245
    s_waitcnt lgkmcnt(6)
    v_mfma_f32_32x32x16_bf16 v[160:175], a[0:3], v[80:83], v[160:175]
    ds_read_b64_tr_b16 a[28:29], v243 offset:18432
    ds_read_b64_tr_b16 a[30:31], v243 offset:18944
    v_mul_f32 v180, v156, v245
    v_mul_f32 v177, v153, v245
    v_mul_f32 v181, v157, v245
    v_mul_f32 v178, v154, v245
    v_mfma_f32_32x32x16_bf16 v[160:175], a[4:7], v[84:87], v[160:175]
    ds_read_b64_tr_b16 a[0:1], v243 offset:20480
    ds_read_b64_tr_b16 a[2:3], v243 offset:20992
    v_mul_f32 v182, v158, v245
    v_mul_f32 v179, v155, v245
    v_exp_f32 v176, v176
    v_mfma_f32_32x32x16_bf16 v[160:175], a[8:11], v[88:91], v[160:175]
    ds_read_b64_tr_b16 a[4:5], v243 offset:22528
    ds_read_b64_tr_b16 a[6:7], v243 offset:23040
    v_exp_f32 v177, v177
    v_exp_f32 v178, v178
    v_mfma_f32_32x32x16_bf16 v[160:175], a[12:15], v[92:95], v[160:175]
    ds_read_b64_tr_b16 a[8:9], v243 offset:24576
    ds_read_b64_tr_b16 a[10:11], v243 offset:25088
    v_mul_f32 v183, v159, v245
    v_exp_f32 v180, v180
    s_waitcnt lgkmcnt(6)
    v_mfma_f32_32x32x16_bf16 v[160:175], a[16:19], v[96:99], v[160:175]
    ds_read_b64_tr_b16 a[12:13], v243 offset:26624
    ds_read_b64_tr_b16 a[14:15], v243 offset:27136
    v_exp_f32 v181, v181
    v_exp_f32 v182, v182
    v_mfma_f32_32x32x16_bf16 v[160:175], a[20:23], v[100:103], v[160:175]
    ds_read_b64_tr_b16 a[16:17], v243 offset:28672
    ds_read_b64_tr_b16 a[18:19], v243 offset:29184
    v_exp_f32 v179, v179
    v_exp_f32 v183, v183
    v_mfma_f32_32x32x16_bf16 v[160:175], a[24:27], v[104:107], v[160:175]
    ds_read_b64_tr_b16 a[20:21], v243 offset:30720
    ds_read_b64_tr_b16 a[22:23], v243 offset:31232
    v_add_f32 v176, 1.0, v176
    v_add_f32 v180, 1.0, v180
    v_add_f32 v177, 1.0, v177
    v_add_f32 v181, 1.0, v181
    v_mfma_f32_32x32x16_bf16 v[160:175], a[28:31], v[108:111], v[160:175]
    ds_read_b64_tr_b16 a[24:25], v243 offset:32768
    ds_read_b64_tr_b16 a[26:27], v243 offset:33280
    v_add_f32 v178, 1.0, v178
    v_add_f32 v182, 1.0, v182
    v_add_f32 v179, 1.0, v179
    s_waitcnt lgkmcnt(6)
    v_mfma_f32_32x32x16_bf16 v[160:175], a[0:3], v[112:115], v[160:175]
    ds_read_b64_tr_b16 a[28:29], v243 offset:34816
    ds_read_b64_tr_b16 a[30:31], v243 offset:35328
    v_rcp_f32 v176, v176
    v_rcp_f32 v177, v177
    v_mfma_f32_32x32x16_bf16 v[160:175], a[4:7], v[116:119], v[160:175]
    s_waitcnt vmcnt(9)
    s_barrier
    ds_read_b64_tr_b16 a[0:1], v240 offset:0
    ds_read_b64_tr_b16 a[2:3], v240 offset:512
    s_add_u32 m0, s29, 73728
    s_add_u32 s46, s24, 640
    buffer_load_dwordx4 v246, s[8:11], s46 offen offset:0 lds
    v_mfma_f32_32x32x16_bf16 v[160:175], a[8:11], v[120:123], v[160:175]
    ds_read_b64_tr_b16 a[4:5], v240 offset:2048
    ds_read_b64_tr_b16 a[6:7], v240 offset:2560
    v_rcp_f32 v178, v178
    v_rcp_f32 v179, v179
    v_mfma_f32_32x32x16_bf16 v[160:175], a[12:15], v[124:127], v[160:175]
    ds_read_b64_tr_b16 a[8:9], v240 offset:4096
    ds_read_b64_tr_b16 a[10:11], v240 offset:4608
    v_add_f32 v183, 1.0, v183
    v_rcp_f32 v180, v180
    s_waitcnt lgkmcnt(6)
    v_mfma_f32_32x32x16_bf16 v[160:175], a[16:19], v[128:131], v[160:175]
    ds_read_b64_tr_b16 a[12:13], v240 offset:6144
    ds_read_b64_tr_b16 a[14:15], v240 offset:6656
    v_rcp_f32 v181, v181
    v_rcp_f32 v182, v182
    v_mfma_f32_32x32x16_bf16 v[160:175], a[20:23], v[132:135], v[160:175]
    ds_read_b64_tr_b16 a[16:17], v240 offset:8192
    ds_read_b64_tr_b16 a[18:19], v240 offset:8704
    buffer_load_dwordx4 v247, s[8:11], s46 offen offset:1024 lds
    v_mul_f32 v176, v176, v152
    v_rcp_f32 v183, v183
    v_mfma_f32_32x32x16_bf16 v[160:175], a[24:27], v[136:139], v[160:175]
    ds_read_b64_tr_b16 a[20:21], v240 offset:10240
    ds_read_b64_tr_b16 a[22:23], v240 offset:10752
    v_mul_f32 v180, v180, v156
    v_mul_f32 v177, v177, v153
    v_mul_f32 v181, v181, v157
    v_mul_f32 v178, v178, v154
    v_mfma_f32_32x32x16_bf16 v[160:175], a[28:31], v[140:143], v[160:175]
    ds_read_b64_tr_b16 a[24:25], v240 offset:12288
    ds_read_b64_tr_b16 a[26:27], v240 offset:12800
    v_mul_f32 v182, v182, v158
    v_mul_f32 v179, v179, v155
    v_mul_f32 v183, v183, v159
    v_cvt_pk_bf16_f32 v196, v176, v177
    v_cvt_pk_bf16_f32 v198, v180, v181
    v_cvt_pk_bf16_f32 v197, v178, v179
    v_cvt_pk_bf16_f32 v199, v182, v183
    s_waitcnt lgkmcnt(6)
    v_mfma_f32_32x32x16_bf16 v[144:159], a[0:3], v[0:3], 0
    ds_read_b64_tr_b16 a[28:29], v240 offset:14336
    ds_read_b64_tr_b16 a[30:31], v240 offset:14848
    buffer_load_dwordx4 v248, s[8:11], s46 offen offset:2048 lds
    v_subrev_u32 v242, 73728, v242
    v_subrev_u32 v243, 73728, v243
    v_mul_f32 v176, v160, v245
    v_mfma_f32_32x32x16_bf16 v[144:159], a[4:7], v[4:7], v[144:159]
    ds_read_b64_tr_b16 a[0:1], v240 offset:16384
    ds_read_b64_tr_b16 a[2:3], v240 offset:16896
    buffer_load_dwordx4 v249, s[8:11], s46 offen offset:3072 lds
    v_mul_f32 v180, v164, v245
    v_mul_f32 v177, v161, v245
    v_mul_f32 v181, v165, v245
    v_mfma_f32_32x32x16_bf16 v[144:159], a[8:11], v[8:11], v[144:159]
    ds_read_b64_tr_b16 a[4:5], v240 offset:18432
    ds_read_b64_tr_b16 a[6:7], v240 offset:18944
    v_mul_f32 v178, v162, v245
    v_mul_f32 v182, v166, v245
    v_mul_f32 v179, v163, v245
    v_mul_f32 v183, v167, v245
    v_mfma_f32_32x32x16_bf16 v[144:159], a[12:15], v[12:15], v[144:159]
    ds_read_b64_tr_b16 a[8:9], v240 offset:20480
    ds_read_b64_tr_b16 a[10:11], v240 offset:20992
    v_exp_f32 v176, v176
    s_waitcnt lgkmcnt(6)
    v_mfma_f32_32x32x16_bf16 v[144:159], a[16:19], v[16:19], v[144:159]
    ds_read_b64_tr_b16 a[12:13], v240 offset:22528
    ds_read_b64_tr_b16 a[14:15], v240 offset:23040
    v_exp_f32 v180, v180
    v_exp_f32 v177, v177
    v_mfma_f32_32x32x16_bf16 v[144:159], a[20:23], v[20:23], v[144:159]
    ds_read_b64_tr_b16 a[16:17], v240 offset:24576
    ds_read_b64_tr_b16 a[18:19], v240 offset:25088
    s_add_u32 m0, s30, 73728
    s_add_u32 s46, s25, 640
    buffer_load_dwordx4 v246, s[8:11], s46 offen offset:0 lds
    v_mfma_f32_32x32x16_bf16 v[144:159], a[24:27], v[24:27], v[144:159]
    ds_read_b64_tr_b16 a[20:21], v240 offset:26624
    ds_read_b64_tr_b16 a[22:23], v240 offset:27136
    v_exp_f32 v181, v181
    v_exp_f32 v178, v178
    v_mfma_f32_32x32x16_bf16 v[144:159], a[28:31], v[28:31], v[144:159]
    ds_read_b64_tr_b16 a[24:25], v240 offset:28672
    ds_read_b64_tr_b16 a[26:27], v240 offset:29184
    v_exp_f32 v182, v182
    s_waitcnt lgkmcnt(6)
    v_mfma_f32_32x32x16_bf16 v[144:159], a[0:3], v[32:35], v[144:159]
    ds_read_b64_tr_b16 a[28:29], v240 offset:30720
    ds_read_b64_tr_b16 a[30:31], v240 offset:31232
    v_exp_f32 v179, v179
    v_exp_f32 v183, v183
    v_mfma_f32_32x32x16_bf16 v[144:159], a[4:7], v[36:39], v[144:159]
    ds_read_b64_tr_b16 a[0:1], v240 offset:32768
    ds_read_b64_tr_b16 a[2:3], v240 offset:33280
    buffer_load_dwordx4 v247, s[8:11], s46 offen offset:1024 lds
    v_add_f32 v176, 1.0, v176
    v_add_f32 v180, 1.0, v180
    v_add_f32 v177, 1.0, v177
    v_mfma_f32_32x32x16_bf16 v[144:159], a[8:11], v[40:43], v[144:159]
    ds_read_b64_tr_b16 a[4:5], v240 offset:34816
    ds_read_b64_tr_b16 a[6:7], v240 offset:35328
    v_add_f32 v181, 1.0, v181
    v_add_f32 v178, 1.0, v178
    v_add_f32 v182, 1.0, v182
    v_add_f32 v179, 1.0, v179
    v_mfma_f32_32x32x16_bf16 v[144:159], a[12:15], v[44:47], v[144:159]
    s_waitcnt vmcnt(6)
    s_barrier
    ds_read_b64_tr_b16 a[8:9], v241 offset:0
    ds_read_b64_tr_b16 a[10:11], v241 offset:512
    v_add_f32 v183, 1.0, v183
    s_waitcnt lgkmcnt(6)
    v_mfma_f32_32x32x16_bf16 v[144:159], a[16:19], v[48:51], v[144:159]
    ds_read_b64_tr_b16 a[12:13], v241 offset:2048
    ds_read_b64_tr_b16 a[14:15], v241 offset:2560
    v_rcp_f32 v176, v176
    v_rcp_f32 v180, v180
    v_mfma_f32_32x32x16_bf16 v[144:159], a[20:23], v[52:55], v[144:159]
    ds_read_b64_tr_b16 a[16:17], v241 offset:4096
    ds_read_b64_tr_b16 a[18:19], v241 offset:4608
    buffer_load_dwordx4 v248, s[8:11], s46 offen offset:2048 lds
    v_rcp_f32 v177, v177
    v_mfma_f32_32x32x16_bf16 v[144:159], a[24:27], v[56:59], v[144:159]
    ds_read_b64_tr_b16 a[20:21], v241 offset:6144
    ds_read_b64_tr_b16 a[22:23], v241 offset:6656
    v_rcp_f32 v181, v181
    v_rcp_f32 v178, v178
    v_mfma_f32_32x32x16_bf16 v[144:159], a[28:31], v[60:63], v[144:159]
    ds_read_b64_tr_b16 a[24:25], v241 offset:8192
    ds_read_b64_tr_b16 a[26:27], v241 offset:8704
    v_rcp_f32 v182, v182
    s_waitcnt lgkmcnt(6)
    v_mfma_f32_32x32x16_bf16 v[144:159], a[0:3], v[64:67], v[144:159]
    ds_read_b64_tr_b16 a[28:29], v241 offset:10240
    ds_read_b64_tr_b16 a[30:31], v241 offset:10752
    v_rcp_f32 v179, v179
    v_rcp_f32 v183, v183
    v_mfma_f32_32x32x16_bf16 v[144:159], a[4:7], v[68:71], v[144:159]
    ds_read_b64_tr_b16 a[0:1], v241 offset:12288
    ds_read_b64_tr_b16 a[2:3], v241 offset:12800
    buffer_load_dwordx4 v249, s[8:11], s46 offen offset:3072 lds
    v_mul_f32 v176, v176, v160
    v_mul_f32 v180, v180, v164
    v_mul_f32 v177, v177, v161
    v_mfma_f32_32x32x16_bf16 v[144:159], a[8:11], v[72:75], v[144:159]
    ds_read_b64_tr_b16 a[4:5], v241 offset:14336
    ds_read_b64_tr_b16 a[6:7], v241 offset:14848
    v_mul_f32 v181, v181, v165
    v_mul_f32 v178, v178, v162
    v_mul_f32 v182, v182, v166
    v_mul_f32 v179, v179, v163
    v_mfma_f32_32x32x16_bf16 v[144:159], a[12:15], v[76:79], v[144:159]
    ds_read_b64_tr_b16 a[8:9], v241 offset:16384
    ds_read_b64_tr_b16 a[10:11], v241 offset:16896
    v_mul_f32 v183, v183, v167
    v_cvt_pk_bf16_f32 v200, v176, v177
    v_cvt_pk_bf16_f32 v202, v180, v181
    s_waitcnt lgkmcnt(6)
    v_mfma_f32_32x32x16_bf16 v[144:159], a[16:19], v[80:83], v[144:159]
    ds_read_b64_tr_b16 a[12:13], v241 offset:18432
    ds_read_b64_tr_b16 a[14:15], v241 offset:18944
    v_cvt_pk_bf16_f32 v201, v178, v179
    v_cvt_pk_bf16_f32 v203, v182, v183
    v_mul_f32 v176, v168, v245
    v_mul_f32 v180, v172, v245
    v_mfma_f32_32x32x16_bf16 v[144:159], a[20:23], v[84:87], v[144:159]
    ds_read_b64_tr_b16 a[16:17], v241 offset:20480
    ds_read_b64_tr_b16 a[18:19], v241 offset:20992
    s_add_u32 m0, s31, 73728
    s_add_u32 s46, s26, 640
    buffer_load_dwordx4 v246, s[8:11], s46 offen offset:0 lds
    v_mul_f32 v177, v169, v245
    v_mfma_f32_32x32x16_bf16 v[144:159], a[24:27], v[88:91], v[144:159]
    ds_read_b64_tr_b16 a[20:21], v241 offset:22528
    ds_read_b64_tr_b16 a[22:23], v241 offset:23040
    v_mul_f32 v181, v173, v245
    v_mul_f32 v178, v170, v245
    v_mul_f32 v182, v174, v245
    v_mul_f32 v179, v171, v245
    v_mfma_f32_32x32x16_bf16 v[144:159], a[28:31], v[92:95], v[144:159]
    ds_read_b64_tr_b16 a[24:25], v241 offset:24576
    ds_read_b64_tr_b16 a[26:27], v241 offset:25088
    v_mul_f32 v183, v175, v245
    v_exp_f32 v176, v176
    s_waitcnt lgkmcnt(6)
    v_mfma_f32_32x32x16_bf16 v[144:159], a[0:3], v[96:99], v[144:159]
    ds_read_b64_tr_b16 a[28:29], v241 offset:26624
    ds_read_b64_tr_b16 a[30:31], v241 offset:27136
    v_exp_f32 v180, v180
    v_exp_f32 v177, v177
    v_mfma_f32_32x32x16_bf16 v[144:159], a[4:7], v[100:103], v[144:159]
    ds_read_b64_tr_b16 a[0:1], v241 offset:28672
    ds_read_b64_tr_b16 a[2:3], v241 offset:29184
    s_add_u32 m0, s29, 110592
    s_add_u32 s46, s24, 2654848
    buffer_load_dwordx4 v246, s[8:11], s46 offen offset:0 lds
    v_mfma_f32_32x32x16_bf16 v[144:159], a[8:11], v[104:107], v[144:159]
    ds_read_b64_tr_b16 a[4:5], v241 offset:30720
    ds_read_b64_tr_b16 a[6:7], v241 offset:31232
    v_exp_f32 v181, v181
    v_exp_f32 v178, v178
    v_mfma_f32_32x32x16_bf16 v[144:159], a[12:15], v[108:111], v[144:159]
    ds_read_b64_tr_b16 a[8:9], v241 offset:32768
    ds_read_b64_tr_b16 a[10:11], v241 offset:33280
    v_exp_f32 v182, v182
    s_waitcnt lgkmcnt(6)
    v_mfma_f32_32x32x16_bf16 v[144:159], a[16:19], v[112:115], v[144:159]
    ds_read_b64_tr_b16 a[12:13], v241 offset:34816
    ds_read_b64_tr_b16 a[14:15], v241 offset:35328
    v_exp_f32 v179, v179
    v_exp_f32 v183, v183
    v_mfma_f32_32x32x16_bf16 v[144:159], a[20:23], v[116:119], v[144:159]
    ds_read_b64_tr_b16 a[16:17], v242 offset:0
    ds_read_b64_tr_b16 a[18:19], v242 offset:512
    buffer_load_dwordx4 v247, s[8:11], s46 offen offset:1024 lds
    v_add_f32 v176, 1.0, v176
    v_add_f32 v180, 1.0, v180
    v_add_f32 v177, 1.0, v177
    v_mfma_f32_32x32x16_bf16 v[144:159], a[24:27], v[120:123], v[144:159]
    ds_read_b64_tr_b16 a[20:21], v242 offset:2048
    ds_read_b64_tr_b16 a[22:23], v242 offset:2560
    v_add_f32 v181, 1.0, v181
    v_add_f32 v178, 1.0, v178
    v_add_f32 v182, 1.0, v182
    v_add_f32 v179, 1.0, v179
    v_mfma_f32_32x32x16_bf16 v[144:159], a[28:31], v[124:127], v[144:159]
    ds_read_b64_tr_b16 a[24:25], v242 offset:4096
    ds_read_b64_tr_b16 a[26:27], v242 offset:4608
    v_add_f32 v183, 1.0, v183
    v_rcp_f32 v176, v176
    s_waitcnt lgkmcnt(6)
    v_mfma_f32_32x32x16_bf16 v[144:159], a[0:3], v[128:131], v[144:159]
    ds_read_b64_tr_b16 a[28:29], v242 offset:6144
    ds_read_b64_tr_b16 a[30:31], v242 offset:6656
    v_rcp_f32 v180, v180
    v_rcp_f32 v177, v177
    v_mfma_f32_32x32x16_bf16 v[144:159], a[4:7], v[132:135], v[144:159]
    ds_read_b64_tr_b16 a[0:1], v242 offset:8192
    ds_read_b64_tr_b16 a[2:3], v242 offset:8704
    buffer_load_dwordx4 v248, s[8:11], s46 offen offset:2048 lds
    v_rcp_f32 v181, v181
    v_mfma_f32_32x32x16_bf16 v[144:159], a[8:11], v[136:139], v[144:159]
    ds_read_b64_tr_b16 a[4:5], v242 offset:10240
    ds_read_b64_tr_b16 a[6:7], v242 offset:10752
    v_rcp_f32 v178, v178
    v_rcp_f32 v182, v182
    v_mfma_f32_32x32x16_bf16 v[144:159], a[12:15], v[140:143], v[144:159]
    ds_read_b64_tr_b16 a[8:9], v242 offset:12288
    ds_read_b64_tr_b16 a[10:11], v242 offset:12800
    v_rcp_f32 v179, v179
    v_rcp_f32 v183, v183
    v_mul_f32 v176, v176, v168
    v_mul_f32 v180, v180, v172
    v_mul_f32 v177, v177, v169
    v_mul_f32 v181, v181, v173
    v_mul_f32 v178, v178, v170
    v_mul_f32 v182, v182, v174
    v_mul_f32 v179, v179, v171
    v_mul_f32 v183, v183, v175
    v_cvt_pk_bf16_f32 v204, v176, v177
    v_cvt_pk_bf16_f32 v206, v180, v181
    v_cvt_pk_bf16_f32 v205, v178, v179
    v_cvt_pk_bf16_f32 v207, v182, v183
    s_waitcnt lgkmcnt(6)
    v_mfma_f32_32x32x16_bf16 v[160:175], a[16:19], v[0:3], 0
    ds_read_b64_tr_b16 a[12:13], v242 offset:14336
    ds_read_b64_tr_b16 a[14:15], v242 offset:14848
    buffer_load_dwordx4 v249, s[8:11], s46 offen offset:3072 lds
    v_add_u32 v240, 73728, v240
    v_add_u32 v241, 73728, v241
    v_mul_f32 v176, v144, v245
    v_mfma_f32_32x32x16_bf16 v[160:175], a[20:23], v[4:7], v[160:175]
    ds_read_b64_tr_b16 a[16:17], v242 offset:16384
    ds_read_b64_tr_b16 a[18:19], v242 offset:16896
    s_add_u32 m0, s30, 110592
    s_add_u32 s46, s25, 2654848
    buffer_load_dwordx4 v246, s[8:11], s46 offen offset:0 lds
    v_mul_f32 v180, v148, v245
    v_mfma_f32_32x32x16_bf16 v[160:175], a[24:27], v[8:11], v[160:175]
    ds_read_b64_tr_b16 a[20:21], v242 offset:18432
    ds_read_b64_tr_b16 a[22:23], v242 offset:18944
    v_mul_f32 v177, v145, v245
    v_mul_f32 v181, v149, v245
    v_mul_f32 v178, v146, v245
    v_mul_f32 v182, v150, v245
    v_mfma_f32_32x32x16_bf16 v[160:175], a[28:31], v[12:15], v[160:175]
    ds_read_b64_tr_b16 a[24:25], v242 offset:20480
    ds_read_b64_tr_b16 a[26:27], v242 offset:20992
    v_mul_f32 v179, v147, v245
    v_exp_f32 v176, v176
    s_waitcnt lgkmcnt(6)
    v_mfma_f32_32x32x16_bf16 v[160:175], a[0:3], v[16:19], v[160:175]
    ds_read_b64_tr_b16 a[28:29], v242 offset:22528
    ds_read_b64_tr_b16 a[30:31], v242 offset:23040
    v_exp_f32 v177, v177
    v_exp_f32 v178, v178
    v_mfma_f32_32x32x16_bf16 v[160:175], a[4:7], v[20:23], v[160:175]
    ds_read_b64_tr_b16 a[0:1], v242 offset:24576
    ds_read_b64_tr_b16 a[2:3], v242 offset:25088
    buffer_load_dwordx4 v247, s[8:11], s46 offen offset:1024 lds
    v_mul_f32 v183, v151, v245
    v_exp_f32 v180, v180
    v_mfma_f32_32x32x16_bf16 v[160:175], a[8:11], v[24:27], v[160:175]
    ds_read_b64_tr_b16 a[4:5], v242 offset:26624
    ds_read_b64_tr_b16 a[6:7], v242 offset:27136
    v_exp_f32 v181, v181
    v_exp_f32 v182, v182
    v_mfma_f32_32x32x16_bf16 v[160:175], a[12:15], v[28:31], v[160:175]
    ds_read_b64_tr_b16 a[8:9], v242 offset:28672
    ds_read_b64_tr_b16 a[10:11], v242 offset:29184
    v_exp_f32 v179, v179
    v_add_f32 v176, 1.0, v176
    s_waitcnt lgkmcnt(6)
    v_mfma_f32_32x32x16_bf16 v[160:175], a[16:19], v[32:35], v[160:175]
    ds_read_b64_tr_b16 a[12:13], v242 offset:30720
    ds_read_b64_tr_b16 a[14:15], v242 offset:31232
    v_exp_f32 v183, v183
    v_add_f32 v180, 1.0, v180
    v_add_f32 v177, 1.0, v177
    v_mfma_f32_32x32x16_bf16 v[160:175], a[20:23], v[36:39], v[160:175]
    ds_read_b64_tr_b16 a[16:17], v242 offset:32768
    ds_read_b64_tr_b16 a[18:19], v242 offset:33280
    buffer_load_dwordx4 v248, s[8:11], s46 offen offset:2048 lds
    v_add_f32 v181, 1.0, v181
    v_add_f32 v178, 1.0, v178
    v_add_f32 v182, 1.0, v182
    v_mfma_f32_32x32x16_bf16 v[160:175], a[24:27], v[40:43], v[160:175]
    ds_read_b64_tr_b16 a[20:21], v242 offset:34816
    ds_read_b64_tr_b16 a[22:23], v242 offset:35328
    v_add_f32 v179, 1.0, v179
    v_add_f32 v183, 1.0, v183
    v_rcp_f32 v176, v176
    v_mfma_f32_32x32x16_bf16 v[160:175], a[28:31], v[44:47], v[160:175]
    ds_read_b64_tr_b16 a[24:25], v243 offset:0
    ds_read_b64_tr_b16 a[26:27], v243 offset:512
    v_rcp_f32 v180, v180
    s_waitcnt lgkmcnt(6)
    v_mfma_f32_32x32x16_bf16 v[160:175], a[0:3], v[48:51], v[160:175]
    ds_read_b64_tr_b16 a[28:29], v243 offset:2048
    ds_read_b64_tr_b16 a[30:31], v243 offset:2560
    v_rcp_f32 v177, v177
    v_rcp_f32 v181, v181
    v_mfma_f32_32x32x16_bf16 v[160:175], a[4:7], v[52:55], v[160:175]
    ds_read_b64_tr_b16 a[0:1], v243 offset:4096
    ds_read_b64_tr_b16 a[2:3], v243 offset:4608
    buffer_load_dwordx4 v249, s[8:11], s46 offen offset:3072 lds
    v_rcp_f32 v178, v178
    v_mfma_f32_32x32x16_bf16 v[160:175], a[8:11], v[56:59], v[160:175]
    ds_read_b64_tr_b16 a[4:5], v243 offset:6144
    ds_read_b64_tr_b16 a[6:7], v243 offset:6656
    v_rcp_f32 v182, v182
    v_rcp_f32 v179, v179
    v_mfma_f32_32x32x16_bf16 v[160:175], a[12:15], v[60:63], v[160:175]
    ds_read_b64_tr_b16 a[8:9], v243 offset:8192
    ds_read_b64_tr_b16 a[10:11], v243 offset:8704
    v_mul_f32 v176, v176, v144
    v_rcp_f32 v183, v183
    s_waitcnt lgkmcnt(6)
    v_mfma_f32_32x32x16_bf16 v[160:175], a[16:19], v[64:67], v[160:175]
    ds_read_b64_tr_b16 a[12:13], v243 offset:10240
    ds_read_b64_tr_b16 a[14:15], v243 offset:10752
    v_mul_f32 v180, v180, v148
    v_mul_f32 v177, v177, v145
    v_mul_f32 v181, v181, v149
    v_mul_f32 v178, v178, v146
    v_mfma_f32_32x32x16_bf16 v[160:175], a[20:23], v[68:71], v[160:175]
    ds_read_b64_tr_b16 a[16:17], v243 offset:12288
    ds_read_b64_tr_b16 a[18:19], v243 offset:12800
    s_add_u32 m0, s31, 110592
    s_add_u32 s46, s26, 2654848
    buffer_load_dwordx4 v246, s[8:11], s46 offen offset:0 lds
    v_mul_f32 v182, v182, v150
    v_mfma_f32_32x32x16_bf16 v[160:175], a[24:27], v[72:75], v[160:175]
    ds_read_b64_tr_b16 a[20:21], v243 offset:14336
    ds_read_b64_tr_b16 a[22:23], v243 offset:14848
    v_mul_f32 v179, v179, v147
    v_mul_f32 v183, v183, v151
    v_cvt_pk_bf16_f32 v208, v176, v177
    v_cvt_pk_bf16_f32 v210, v180, v181
    v_mfma_f32_32x32x16_bf16 v[160:175], a[28:31], v[76:79], v[160:175]
    ds_read_b64_tr_b16 a[24:25], v243 offset:16384
    ds_read_b64_tr_b16 a[26:27], v243 offset:16896
    v_cvt_pk_bf16_f32 v209, v178, v179
    v_cvt_pk_bf16_f32 v211, v182, v183
    v_mul_f32 v176, v152, v245
    s_waitcnt lgkmcnt(6)
    v_mfma_f32_32x32x16_bf16 v[160:175], a[0:3], v[80:83], v[160:175]
    ds_read_b64_tr_b16 a[28:29], v243 offset:18432
    ds_read_b64_tr_b16 a[30:31], v243 offset:18944
    v_mul_f32 v180, v156, v245
    v_mul_f32 v177, v153, v245
    v_mul_f32 v181, v157, v245
    v_mul_f32 v178, v154, v245
    v_mfma_f32_32x32x16_bf16 v[160:175], a[4:7], v[84:87], v[160:175]
    ds_read_b64_tr_b16 a[0:1], v243 offset:20480
    ds_read_b64_tr_b16 a[2:3], v243 offset:20992
    v_mul_f32 v182, v158, v245
    v_mul_f32 v179, v155, v245
    v_exp_f32 v176, v176
    v_mfma_f32_32x32x16_bf16 v[160:175], a[8:11], v[88:91], v[160:175]
    ds_read_b64_tr_b16 a[4:5], v243 offset:22528
    ds_read_b64_tr_b16 a[6:7], v243 offset:23040
    v_exp_f32 v177, v177
    v_exp_f32 v178, v178
    v_mfma_f32_32x32x16_bf16 v[160:175], a[12:15], v[92:95], v[160:175]
    ds_read_b64_tr_b16 a[8:9], v243 offset:24576
    ds_read_b64_tr_b16 a[10:11], v243 offset:25088
    v_mul_f32 v183, v159, v245
    v_exp_f32 v180, v180
    s_waitcnt lgkmcnt(6)
    v_mfma_f32_32x32x16_bf16 v[160:175], a[16:19], v[96:99], v[160:175]
    ds_read_b64_tr_b16 a[12:13], v243 offset:26624
    ds_read_b64_tr_b16 a[14:15], v243 offset:27136
    v_exp_f32 v181, v181
    v_exp_f32 v182, v182
    v_mfma_f32_32x32x16_bf16 v[160:175], a[20:23], v[100:103], v[160:175]
    ds_read_b64_tr_b16 a[16:17], v243 offset:28672
    ds_read_b64_tr_b16 a[18:19], v243 offset:29184
    v_exp_f32 v179, v179
    v_exp_f32 v183, v183
    v_mfma_f32_32x32x16_bf16 v[160:175], a[24:27], v[104:107], v[160:175]
    ds_read_b64_tr_b16 a[20:21], v243 offset:30720
    ds_read_b64_tr_b16 a[22:23], v243 offset:31232
    v_add_f32 v176, 1.0, v176
    v_add_f32 v180, 1.0, v180
    v_add_f32 v177, 1.0, v177
    v_add_f32 v181, 1.0, v181
    v_mfma_f32_32x32x16_bf16 v[160:175], a[28:31], v[108:111], v[160:175]
    ds_read_b64_tr_b16 a[24:25], v243 offset:32768
    ds_read_b64_tr_b16 a[26:27], v243 offset:33280
    v_add_f32 v178, 1.0, v178
    v_add_f32 v182, 1.0, v182
    v_add_f32 v179, 1.0, v179
    s_waitcnt lgkmcnt(6)
    v_mfma_f32_32x32x16_bf16 v[160:175], a[0:3], v[112:115], v[160:175]
    ds_read_b64_tr_b16 a[28:29], v243 offset:34816
    ds_read_b64_tr_b16 a[30:31], v243 offset:35328
    v_rcp_f32 v176, v176
    v_rcp_f32 v177, v177
    v_mfma_f32_32x32x16_bf16 v[160:175], a[4:7], v[116:119], v[160:175]
    s_waitcnt vmcnt(9)
    s_barrier
    ds_read_b64_tr_b16 a[0:1], v240 offset:0
    ds_read_b64_tr_b16 a[2:3], v240 offset:512
    s_add_u32 m0, s32, 0
    s_add_u32 s46, s27, 0
    buffer_load_dwordx4 v250, s[12:15], s46 offen offset:0 lds
    v_mfma_f32_32x32x16_bf16 v[160:175], a[8:11], v[120:123], v[160:175]
    ds_read_b64_tr_b16 a[4:5], v240 offset:2048
    ds_read_b64_tr_b16 a[6:7], v240 offset:2560
    v_rcp_f32 v178, v178
    v_rcp_f32 v179, v179
    v_mfma_f32_32x32x16_bf16 v[160:175], a[12:15], v[124:127], v[160:175]
    ds_read_b64_tr_b16 a[8:9], v240 offset:4096
    ds_read_b64_tr_b16 a[10:11], v240 offset:4608
    v_add_f32 v183, 1.0, v183
    v_rcp_f32 v180, v180
    s_waitcnt lgkmcnt(6)
    v_mfma_f32_32x32x16_bf16 v[160:175], a[16:19], v[128:131], v[160:175]
    ds_read_b64_tr_b16 a[12:13], v240 offset:6144
    ds_read_b64_tr_b16 a[14:15], v240 offset:6656
    v_rcp_f32 v181, v181
    v_rcp_f32 v182, v182
    v_mfma_f32_32x32x16_bf16 v[160:175], a[20:23], v[132:135], v[160:175]
    ds_read_b64_tr_b16 a[16:17], v240 offset:8192
    ds_read_b64_tr_b16 a[18:19], v240 offset:8704
    buffer_load_dwordx4 v251, s[12:15], s46 offen offset:1024 lds
    v_mul_f32 v176, v176, v152
    v_rcp_f32 v183, v183
    v_mfma_f32_32x32x16_bf16 v[160:175], a[24:27], v[136:139], v[160:175]
    ds_read_b64_tr_b16 a[20:21], v240 offset:10240
    ds_read_b64_tr_b16 a[22:23], v240 offset:10752
    v_mul_f32 v180, v180, v156
    v_mul_f32 v177, v177, v153
    v_mul_f32 v181, v181, v157
    v_mul_f32 v178, v178, v154
    v_mfma_f32_32x32x16_bf16 v[160:175], a[28:31], v[140:143], v[160:175]
    ds_read_b64_tr_b16 a[24:25], v240 offset:12288
    ds_read_b64_tr_b16 a[26:27], v240 offset:12800
    v_mul_f32 v182, v182, v158
    v_mul_f32 v179, v179, v155
    v_mul_f32 v183, v183, v159
    v_cvt_pk_bf16_f32 v212, v176, v177
    v_cvt_pk_bf16_f32 v214, v180, v181
    v_cvt_pk_bf16_f32 v213, v178, v179
    v_cvt_pk_bf16_f32 v215, v182, v183
    s_waitcnt lgkmcnt(6)
    v_mfma_f32_32x32x16_bf16 v[144:159], a[0:3], v[0:3], 0
    ds_read_b64_tr_b16 a[28:29], v240 offset:14336
    ds_read_b64_tr_b16 a[30:31], v240 offset:14848
    buffer_load_dwordx4 v252, s[12:15], s46 offen offset:2048 lds
    v_add_u32 v242, 73728, v242
    v_add_u32 v243, 73728, v243
    v_mul_f32 v176, v160, v245
    v_mfma_f32_32x32x16_bf16 v[144:159], a[4:7], v[4:7], v[144:159]
    ds_read_b64_tr_b16 a[0:1], v240 offset:16384
    ds_read_b64_tr_b16 a[2:3], v240 offset:16896
    buffer_load_dwordx4 v253, s[12:15], s46 offen offset:3072 lds
    v_mul_f32 v180, v164, v245
    v_mul_f32 v177, v161, v245
    v_mul_f32 v181, v165, v245
    v_mfma_f32_32x32x16_bf16 v[144:159], a[8:11], v[8:11], v[144:159]
    ds_read_b64_tr_b16 a[4:5], v240 offset:18432
    ds_read_b64_tr_b16 a[6:7], v240 offset:18944
    v_mul_f32 v178, v162, v245
    v_mul_f32 v182, v166, v245
    v_mul_f32 v179, v163, v245
    v_mul_f32 v183, v167, v245
    v_mfma_f32_32x32x16_bf16 v[144:159], a[12:15], v[12:15], v[144:159]
    ds_read_b64_tr_b16 a[8:9], v240 offset:20480
    ds_read_b64_tr_b16 a[10:11], v240 offset:20992
    v_exp_f32 v176, v176
    s_waitcnt lgkmcnt(6)
    v_mfma_f32_32x32x16_bf16 v[144:159], a[16:19], v[16:19], v[144:159]
    ds_read_b64_tr_b16 a[12:13], v240 offset:22528
    ds_read_b64_tr_b16 a[14:15], v240 offset:23040
    v_exp_f32 v180, v180
    v_exp_f32 v177, v177
    v_mfma_f32_32x32x16_bf16 v[144:159], a[20:23], v[20:23], v[144:159]
    ds_read_b64_tr_b16 a[16:17], v240 offset:24576
    ds_read_b64_tr_b16 a[18:19], v240 offset:25088
    s_add_u32 m0, s33, 0
    s_add_u32 s46, s28, 0
    buffer_load_dwordx4 v250, s[12:15], s46 offen offset:0 lds
    v_mfma_f32_32x32x16_bf16 v[144:159], a[24:27], v[24:27], v[144:159]
    ds_read_b64_tr_b16 a[20:21], v240 offset:26624
    ds_read_b64_tr_b16 a[22:23], v240 offset:27136
    v_exp_f32 v181, v181
    v_exp_f32 v178, v178
    v_mfma_f32_32x32x16_bf16 v[144:159], a[28:31], v[28:31], v[144:159]
    ds_read_b64_tr_b16 a[24:25], v240 offset:28672
    ds_read_b64_tr_b16 a[26:27], v240 offset:29184
    v_exp_f32 v182, v182
    s_waitcnt lgkmcnt(6)
    v_mfma_f32_32x32x16_bf16 v[144:159], a[0:3], v[32:35], v[144:159]
    ds_read_b64_tr_b16 a[28:29], v240 offset:30720
    ds_read_b64_tr_b16 a[30:31], v240 offset:31232
    v_exp_f32 v179, v179
    v_exp_f32 v183, v183
    v_mfma_f32_32x32x16_bf16 v[144:159], a[4:7], v[36:39], v[144:159]
    ds_read_b64_tr_b16 a[0:1], v240 offset:32768
    ds_read_b64_tr_b16 a[2:3], v240 offset:33280
    buffer_load_dwordx4 v251, s[12:15], s46 offen offset:1024 lds
    v_add_f32 v176, 1.0, v176
    v_add_f32 v180, 1.0, v180
    v_add_f32 v177, 1.0, v177
    v_mfma_f32_32x32x16_bf16 v[144:159], a[8:11], v[40:43], v[144:159]
    ds_read_b64_tr_b16 a[4:5], v240 offset:34816
    ds_read_b64_tr_b16 a[6:7], v240 offset:35328
    v_add_f32 v181, 1.0, v181
    v_add_f32 v178, 1.0, v178
    v_add_f32 v182, 1.0, v182
    v_add_f32 v179, 1.0, v179
    v_mfma_f32_32x32x16_bf16 v[144:159], a[12:15], v[44:47], v[144:159]
    s_waitcnt vmcnt(6)
    s_barrier
    ds_read_b64_tr_b16 a[8:9], v241 offset:0
    ds_read_b64_tr_b16 a[10:11], v241 offset:512
    v_add_f32 v183, 1.0, v183
    s_waitcnt lgkmcnt(6)
    v_mfma_f32_32x32x16_bf16 v[144:159], a[16:19], v[48:51], v[144:159]
    ds_read_b64_tr_b16 a[12:13], v241 offset:2048
    ds_read_b64_tr_b16 a[14:15], v241 offset:2560
    v_rcp_f32 v176, v176
    v_rcp_f32 v180, v180
    v_mfma_f32_32x32x16_bf16 v[144:159], a[20:23], v[52:55], v[144:159]
    ds_read_b64_tr_b16 a[16:17], v241 offset:4096
    ds_read_b64_tr_b16 a[18:19], v241 offset:4608
    s_add_u32 m0, s32, 24576
    s_add_u32 s46, s27, 221184
    buffer_load_dwordx4 v250, s[12:15], s46 offen offset:0 lds
    v_mfma_f32_32x32x16_bf16 v[144:159], a[24:27], v[56:59], v[144:159]
    ds_read_b64_tr_b16 a[20:21], v241 offset:6144
    ds_read_b64_tr_b16 a[22:23], v241 offset:6656
    v_rcp_f32 v177, v177
    v_rcp_f32 v181, v181
    v_mfma_f32_32x32x16_bf16 v[144:159], a[28:31], v[60:63], v[144:159]
    ds_read_b64_tr_b16 a[24:25], v241 offset:8192
    ds_read_b64_tr_b16 a[26:27], v241 offset:8704
    v_rcp_f32 v178, v178
    s_waitcnt lgkmcnt(6)
    v_mfma_f32_32x32x16_bf16 v[144:159], a[0:3], v[64:67], v[144:159]
    ds_read_b64_tr_b16 a[28:29], v241 offset:10240
    ds_read_b64_tr_b16 a[30:31], v241 offset:10752
    v_rcp_f32 v182, v182
    v_rcp_f32 v179, v179
    v_mfma_f32_32x32x16_bf16 v[144:159], a[4:7], v[68:71], v[144:159]
    ds_read_b64_tr_b16 a[0:1], v241 offset:12288
    ds_read_b64_tr_b16 a[2:3], v241 offset:12800
    buffer_load_dwordx4 v251, s[12:15], s46 offen offset:1024 lds
    v_mul_f32 v176, v176, v160
    v_rcp_f32 v183, v183
    v_mfma_f32_32x32x16_bf16 v[144:159], a[8:11], v[72:75], v[144:159]
    ds_read_b64_tr_b16 a[4:5], v241 offset:14336
    ds_read_b64_tr_b16 a[6:7], v241 offset:14848
    v_mul_f32 v180, v180, v164
    v_mul_f32 v177, v177, v161
    v_mul_f32 v181, v181, v165
    v_mul_f32 v178, v178, v162
    v_mfma_f32_32x32x16_bf16 v[144:159], a[12:15], v[76:79], v[144:159]
    ds_read_b64_tr_b16 a[8:9], v241 offset:16384
    ds_read_b64_tr_b16 a[10:11], v241 offset:16896
    v_mul_f32 v182, v182, v166
    v_mul_f32 v179, v179, v163
    v_mul_f32 v183, v183, v167
    s_waitcnt lgkmcnt(6)
    v_mfma_f32_32x32x16_bf16 v[144:159], a[16:19], v[80:83], v[144:159]
    ds_read_b64_tr_b16 a[12:13], v241 offset:18432
    ds_read_b64_tr_b16 a[14:15], v241 offset:18944
    v_cvt_pk_bf16_f32 v216, v176, v177
    v_cvt_pk_bf16_f32 v218, v180, v181
    v_cvt_pk_bf16_f32 v217, v178, v179
    v_cvt_pk_bf16_f32 v219, v182, v183
    v_mfma_f32_32x32x16_bf16 v[144:159], a[20:23], v[84:87], v[144:159]
    ds_read_b64_tr_b16 a[16:17], v241 offset:20480
    ds_read_b64_tr_b16 a[18:19], v241 offset:20992
    buffer_load_dwordx4 v252, s[12:15], s46 offen offset:2048 lds
    v_mul_f32 v176, v168, v245
    v_mul_f32 v180, v172, v245
    v_mul_f32 v177, v169, v245
    v_mfma_f32_32x32x16_bf16 v[144:159], a[24:27], v[88:91], v[144:159]
    ds_read_b64_tr_b16 a[20:21], v241 offset:22528
    ds_read_b64_tr_b16 a[22:23], v241 offset:23040
    v_mul_f32 v181, v173, v245
    v_mul_f32 v178, v170, v245
    v_mul_f32 v182, v174, v245
    v_mul_f32 v179, v171, v245
    v_mfma_f32_32x32x16_bf16 v[144:159], a[28:31], v[92:95], v[144:159]
    ds_read_b64_tr_b16 a[24:25], v241 offset:24576
    ds_read_b64_tr_b16 a[26:27], v241 offset:25088
    v_mul_f32 v183, v175, v245
    v_exp_f32 v176, v176
    s_waitcnt lgkmcnt(6)
    v_mfma_f32_32x32x16_bf16 v[144:159], a[0:3], v[96:99], v[144:159]
    ds_read_b64_tr_b16 a[28:29], v241 offset:26624
    ds_read_b64_tr_b16 a[30:31], v241 offset:27136
    v_exp_f32 v180, v180
    v_exp_f32 v177, v177
    v_mfma_f32_32x32x16_bf16 v[144:159], a[4:7], v[100:103], v[144:159]
    ds_read_b64_tr_b16 a[0:1], v241 offset:28672
    ds_read_b64_tr_b16 a[2:3], v241 offset:29184
    buffer_load_dwordx4 v253, s[12:15], s46 offen offset:3072 lds
    v_exp_f32 v181, v181
    v_mfma_f32_32x32x16_bf16 v[144:159], a[8:11], v[104:107], v[144:159]
    ds_read_b64_tr_b16 a[4:5], v241 offset:30720
    ds_read_b64_tr_b16 a[6:7], v241 offset:31232
    v_exp_f32 v178, v178
    v_exp_f32 v182, v182
    v_mfma_f32_32x32x16_bf16 v[144:159], a[12:15], v[108:111], v[144:159]
    ds_read_b64_tr_b16 a[8:9], v241 offset:32768
    ds_read_b64_tr_b16 a[10:11], v241 offset:33280
    v_exp_f32 v179, v179
    v_add_f32 v176, 1.0, v176
    s_waitcnt lgkmcnt(6)
    v_mfma_f32_32x32x16_bf16 v[144:159], a[16:19], v[112:115], v[144:159]
    ds_read_b64_tr_b16 a[12:13], v241 offset:34816
    ds_read_b64_tr_b16 a[14:15], v241 offset:35328
    v_exp_f32 v183, v183
    v_add_f32 v180, 1.0, v180
    v_add_f32 v177, 1.0, v177
    v_mfma_f32_32x32x16_bf16 v[144:159], a[20:23], v[116:119], v[144:159]
    ds_read_b64_tr_b16 a[16:17], v242 offset:0
    ds_read_b64_tr_b16 a[18:19], v242 offset:512
    s_add_u32 m0, s33, 24576
    s_add_u32 s46, s28, 221184
    buffer_load_dwordx4 v250, s[12:15], s46 offen offset:0 lds
    v_add_f32 v181, 1.0, v181
    v_mfma_f32_32x32x16_bf16 v[144:159], a[24:27], v[120:123], v[144:159]
    ds_read_b64_tr_b16 a[20:21], v242 offset:2048
    ds_read_b64_tr_b16 a[22:23], v242 offset:2560
    v_add_f32 v178, 1.0, v178
    v_add_f32 v182, 1.0, v182
    v_add_f32 v179, 1.0, v179
    v_add_f32 v183, 1.0, v183
    v_mfma_f32_32x32x16_bf16 v[144:159], a[28:31], v[124:127], v[144:159]
    ds_read_b64_tr_b16 a[24:25], v242 offset:4096
    ds_read_b64_tr_b16 a[26:27], v242 offset:4608
    v_rcp_f32 v176, v176
    s_waitcnt lgkmcnt(6)
    v_mfma_f32_32x32x16_bf16 v[144:159], a[0:3], v[128:131], v[144:159]
    ds_read_b64_tr_b16 a[28:29], v242 offset:6144
    ds_read_b64_tr_b16 a[30:31], v242 offset:6656
    v_rcp_f32 v180, v180
    v_rcp_f32 v177, v177
    v_mfma_f32_32x32x16_bf16 v[144:159], a[4:7], v[132:135], v[144:159]
    ds_read_b64_tr_b16 a[0:1], v242 offset:8192
    ds_read_b64_tr_b16 a[2:3], v242 offset:8704
    buffer_load_dwordx4 v251, s[12:15], s46 offen offset:1024 lds
    v_rcp_f32 v181, v181
    v_mfma_f32_32x32x16_bf16 v[144:159], a[8:11], v[136:139], v[144:159]
    ds_read_b64_tr_b16 a[4:5], v242 offset:10240
    ds_read_b64_tr_b16 a[6:7], v242 offset:10752
    v_rcp_f32 v178, v178
    v_rcp_f32 v182, v182
    v_mfma_f32_32x32x16_bf16 v[144:159], a[12:15], v[140:143], v[144:159]
    ds_read_b64_tr_b16 a[8:9], v242 offset:12288
    ds_read_b64_tr_b16 a[10:11], v242 offset:12800
    v_rcp_f32 v179, v179
    v_rcp_f32 v183, v183
    v_mul_f32 v176, v176, v168
    v_mul_f32 v180, v180, v172
    v_mul_f32 v177, v177, v169
    v_mul_f32 v181, v181, v173
    v_mul_f32 v178, v178, v170
    v_mul_f32 v182, v182, v174
    v_mul_f32 v179, v179, v171
    v_mul_f32 v183, v183, v175
    v_cvt_pk_bf16_f32 v220, v176, v177
    v_cvt_pk_bf16_f32 v222, v180, v181
    v_cvt_pk_bf16_f32 v221, v178, v179
    v_cvt_pk_bf16_f32 v223, v182, v183
    s_waitcnt lgkmcnt(6)
    v_mfma_f32_32x32x16_bf16 v[160:175], a[16:19], v[0:3], 0
    ds_read_b64_tr_b16 a[12:13], v242 offset:14336
    ds_read_b64_tr_b16 a[14:15], v242 offset:14848
    s_add_u32 m0, s32, 49152
    s_add_u32 s46, s27, 128
    buffer_load_dwordx4 v250, s[12:15], s46 offen offset:0 lds
    v_mul_f32 v176, v144, v245
    v_mfma_f32_32x32x16_bf16 v[160:175], a[20:23], v[4:7], v[160:175]
    ds_read_b64_tr_b16 a[16:17], v242 offset:16384
    ds_read_b64_tr_b16 a[18:19], v242 offset:16896
    buffer_load_dwordx4 v251, s[12:15], s46 offen offset:1024 lds
    v_xor_b32 v240, 64, v244
    v_mul_f32 v180, v148, v245
    v_mul_f32 v177, v145, v245
    v_mfma_f32_32x32x16_bf16 v[160:175], a[24:27], v[8:11], v[160:175]
    ds_read_b64_tr_b16 a[20:21], v242 offset:18432
    ds_read_b64_tr_b16 a[22:23], v242 offset:18944
    v_mul_f32 v181, v149, v245
    v_mul_f32 v178, v146, v245
    v_mul_f32 v182, v150, v245
    v_mul_f32 v179, v147, v245
    v_mfma_f32_32x32x16_bf16 v[160:175], a[28:31], v[12:15], v[160:175]
    ds_read_b64_tr_b16 a[24:25], v242 offset:20480
    ds_read_b64_tr_b16 a[26:27], v242 offset:20992
    v_mul_f32 v183, v151, v245
    v_exp_f32 v176, v176
    s_waitcnt lgkmcnt(6)
    v_mfma_f32_32x32x16_bf16 v[160:175], a[0:3], v[16:19], v[160:175]
    ds_read_b64_tr_b16 a[28:29], v242 offset:22528
    ds_read_b64_tr_b16 a[30:31], v242 offset:23040
    v_exp_f32 v180, v180
    v_exp_f32 v177, v177
    v_mfma_f32_32x32x16_bf16 v[160:175], a[4:7], v[20:23], v[160:175]
    ds_read_b64_tr_b16 a[0:1], v242 offset:24576
    ds_read_b64_tr_b16 a[2:3], v242 offset:25088
    buffer_load_dwordx4 v252, s[12:15], s46 offen offset:2048 lds
    v_exp_f32 v181, v181
    v_mfma_f32_32x32x16_bf16 v[160:175], a[8:11], v[24:27], v[160:175]
    ds_read_b64_tr_b16 a[4:5], v242 offset:26624
    ds_read_b64_tr_b16 a[6:7], v242 offset:27136
    v_exp_f32 v178, v178
    v_exp_f32 v182, v182
    v_mfma_f32_32x32x16_bf16 v[160:175], a[12:15], v[28:31], v[160:175]
    ds_read_b64_tr_b16 a[8:9], v242 offset:28672
    ds_read_b64_tr_b16 a[10:11], v242 offset:29184
    v_exp_f32 v179, v179
    v_add_f32 v176, 1.0, v176
    s_waitcnt lgkmcnt(6)
    v_mfma_f32_32x32x16_bf16 v[160:175], a[16:19], v[32:35], v[160:175]
    ds_read_b64_tr_b16 a[12:13], v242 offset:30720
    ds_read_b64_tr_b16 a[14:15], v242 offset:31232
    v_exp_f32 v183, v183
    v_add_f32 v180, 1.0, v180
    v_add_f32 v177, 1.0, v177
    v_mfma_f32_32x32x16_bf16 v[160:175], a[20:23], v[36:39], v[160:175]
    ds_read_b64_tr_b16 a[16:17], v242 offset:32768
    ds_read_b64_tr_b16 a[18:19], v242 offset:33280
    buffer_load_dwordx4 v253, s[12:15], s46 offen offset:3072 lds
    v_add_f32 v181, 1.0, v181
    v_add_f32 v178, 1.0, v178
    v_add_f32 v182, 1.0, v182
    v_mfma_f32_32x32x16_bf16 v[160:175], a[24:27], v[40:43], v[160:175]
    ds_read_b64_tr_b16 a[20:21], v242 offset:34816
    ds_read_b64_tr_b16 a[22:23], v242 offset:35328
    v_add_f32 v179, 1.0, v179
    v_add_f32 v183, 1.0, v183
    v_rcp_f32 v176, v176
    v_mfma_f32_32x32x16_bf16 v[160:175], a[28:31], v[44:47], v[160:175]
    ds_read_b64_tr_b16 a[24:25], v243 offset:0
    ds_read_b64_tr_b16 a[26:27], v243 offset:512
    v_rcp_f32 v180, v180
    s_waitcnt lgkmcnt(6)
    v_mfma_f32_32x32x16_bf16 v[160:175], a[0:3], v[48:51], v[160:175]
    ds_read_b64_tr_b16 a[28:29], v243 offset:2048
    ds_read_b64_tr_b16 a[30:31], v243 offset:2560
    v_rcp_f32 v177, v177
    v_rcp_f32 v181, v181
    v_mfma_f32_32x32x16_bf16 v[160:175], a[4:7], v[52:55], v[160:175]
    ds_read_b64_tr_b16 a[0:1], v243 offset:4096
    ds_read_b64_tr_b16 a[2:3], v243 offset:4608
    s_add_u32 m0, s33, 49152
    s_add_u32 s46, s28, 128
    buffer_load_dwordx4 v250, s[12:15], s46 offen offset:0 lds
    v_mfma_f32_32x32x16_bf16 v[160:175], a[8:11], v[56:59], v[160:175]
    ds_read_b64_tr_b16 a[4:5], v243 offset:6144
    ds_read_b64_tr_b16 a[6:7], v243 offset:6656
    v_rcp_f32 v178, v178
    v_rcp_f32 v182, v182
    v_mfma_f32_32x32x16_bf16 v[160:175], a[12:15], v[60:63], v[160:175]
    ds_read_b64_tr_b16 a[8:9], v243 offset:8192
    ds_read_b64_tr_b16 a[10:11], v243 offset:8704
    v_rcp_f32 v179, v179
    v_mul_f32 v176, v176, v144
    s_waitcnt lgkmcnt(6)
    v_mfma_f32_32x32x16_bf16 v[160:175], a[16:19], v[64:67], v[160:175]
    ds_read_b64_tr_b16 a[12:13], v243 offset:10240
    ds_read_b64_tr_b16 a[14:15], v243 offset:10752
    v_rcp_f32 v183, v183
    v_mul_f32 v180, v180, v148
    v_mul_f32 v177, v177, v145
    v_mfma_f32_32x32x16_bf16 v[160:175], a[20:23], v[68:71], v[160:175]
    ds_read_b64_tr_b16 a[16:17], v243 offset:12288
    ds_read_b64_tr_b16 a[18:19], v243 offset:12800
    buffer_load_dwordx4 v251, s[12:15], s46 offen offset:1024 lds
    v_mul_f32 v181, v181, v149
    v_mul_f32 v178, v178, v146
    v_mul_f32 v182, v182, v150
    v_mfma_f32_32x32x16_bf16 v[160:175], a[24:27], v[72:75], v[160:175]
    ds_read_b64_tr_b16 a[20:21], v243 offset:14336
    ds_read_b64_tr_b16 a[22:23], v243 offset:14848
    v_mul_f32 v179, v179, v147
    v_mul_f32 v183, v183, v151
    v_cvt_pk_bf16_f32 v224, v176, v177
    v_cvt_pk_bf16_f32 v226, v180, v181
    v_mfma_f32_32x32x16_bf16 v[160:175], a[28:31], v[76:79], v[160:175]
    ds_read_b64_tr_b16 a[24:25], v243 offset:16384
    ds_read_b64_tr_b16 a[26:27], v243 offset:16896
    v_cvt_pk_bf16_f32 v225, v178, v179
    v_cvt_pk_bf16_f32 v227, v182, v183
    v_mul_f32 v176, v152, v245
    s_waitcnt lgkmcnt(6)
    v_mfma_f32_32x32x16_bf16 v[160:175], a[0:3], v[80:83], v[160:175]
    ds_read_b64_tr_b16 a[28:29], v243 offset:18432
    ds_read_b64_tr_b16 a[30:31], v243 offset:18944
    v_mul_f32 v180, v156, v245
    v_mul_f32 v177, v153, v245
    v_mul_f32 v181, v157, v245
    v_mul_f32 v178, v154, v245
    v_mfma_f32_32x32x16_bf16 v[160:175], a[4:7], v[84:87], v[160:175]
    ds_read_b64_tr_b16 a[0:1], v243 offset:20480
    ds_read_b64_tr_b16 a[2:3], v243 offset:20992
    v_mul_f32 v182, v158, v245
    v_mul_f32 v179, v155, v245
    v_exp_f32 v176, v176
    v_mfma_f32_32x32x16_bf16 v[160:175], a[8:11], v[88:91], v[160:175]
    ds_read_b64_tr_b16 a[4:5], v243 offset:22528
    ds_read_b64_tr_b16 a[6:7], v243 offset:23040
    v_exp_f32 v177, v177
    v_exp_f32 v178, v178
    v_mfma_f32_32x32x16_bf16 v[160:175], a[12:15], v[92:95], v[160:175]
    ds_read_b64_tr_b16 a[8:9], v243 offset:24576
    ds_read_b64_tr_b16 a[10:11], v243 offset:25088
    v_mul_f32 v183, v159, v245
    v_exp_f32 v180, v180
    s_waitcnt lgkmcnt(6)
    v_mfma_f32_32x32x16_bf16 v[160:175], a[16:19], v[96:99], v[160:175]
    ds_read_b64_tr_b16 a[12:13], v243 offset:26624
    ds_read_b64_tr_b16 a[14:15], v243 offset:27136
    v_exp_f32 v181, v181
    v_exp_f32 v182, v182
    v_mfma_f32_32x32x16_bf16 v[160:175], a[20:23], v[100:103], v[160:175]
    ds_read_b64_tr_b16 a[16:17], v243 offset:28672
    ds_read_b64_tr_b16 a[18:19], v243 offset:29184
    v_exp_f32 v179, v179
    v_exp_f32 v183, v183
    v_mfma_f32_32x32x16_bf16 v[160:175], a[24:27], v[104:107], v[160:175]
    ds_read_b64_tr_b16 a[20:21], v243 offset:30720
    ds_read_b64_tr_b16 a[22:23], v243 offset:31232
    v_add_f32 v176, 1.0, v176
    v_add_f32 v180, 1.0, v180
    v_add_f32 v177, 1.0, v177
    v_add_f32 v181, 1.0, v181
    v_mfma_f32_32x32x16_bf16 v[160:175], a[28:31], v[108:111], v[160:175]
    ds_read_b64_tr_b16 a[24:25], v243 offset:32768
    ds_read_b64_tr_b16 a[26:27], v243 offset:33280
    v_add_f32 v178, 1.0, v178
    v_add_f32 v182, 1.0, v182
    v_add_f32 v179, 1.0, v179
    s_waitcnt lgkmcnt(6)
    v_mfma_f32_32x32x16_bf16 v[160:175], a[0:3], v[112:115], v[160:175]
    ds_read_b64_tr_b16 a[28:29], v243 offset:34816
    ds_read_b64_tr_b16 a[30:31], v243 offset:35328
    v_rcp_f32 v176, v176
    v_rcp_f32 v177, v177
    v_mfma_f32_32x32x16_bf16 v[160:175], a[4:7], v[116:119], v[160:175]
    s_waitcnt vmcnt(12)
    s_barrier
    ds_read_b64_tr_b16 a[0:1], v244 offset:0
    ds_read_b64_tr_b16 a[2:3], v244 offset:1024
    s_add_u32 m0, s32, 73728
    s_add_u32 s46, s27, 221312
    buffer_load_dwordx4 v250, s[12:15], s46 offen offset:0 lds
    v_mfma_f32_32x32x16_bf16 v[160:175], a[8:11], v[120:123], v[160:175]
    ds_read_b64_tr_b16 a[4:5], v244 offset:2048
    ds_read_b64_tr_b16 a[6:7], v244 offset:3072
    v_rcp_f32 v178, v178
    v_rcp_f32 v179, v179
    v_mfma_f32_32x32x16_bf16 v[160:175], a[12:15], v[124:127], v[160:175]
    ds_read_b64_tr_b16 a[8:9], v244 offset:4096
    ds_read_b64_tr_b16 a[10:11], v244 offset:5120
    v_add_f32 v183, 1.0, v183
    v_rcp_f32 v180, v180
    s_waitcnt lgkmcnt(6)
    v_mfma_f32_32x32x16_bf16 v[160:175], a[16:19], v[128:131], v[160:175]
    ds_read_b64_tr_b16 a[12:13], v244 offset:6144
    ds_read_b64_tr_b16 a[14:15], v244 offset:7168
    v_rcp_f32 v181, v181
    v_rcp_f32 v182, v182
    v_mfma_f32_32x32x16_bf16 v[160:175], a[20:23], v[132:135], v[160:175]
    ds_read_b64_tr_b16 a[16:17], v244 offset:8192
    ds_read_b64_tr_b16 a[18:19], v244 offset:9216
    buffer_load_dwordx4 v251, s[12:15], s46 offen offset:1024 lds
    v_mul_f32 v176, v176, v152
    v_rcp_f32 v183, v183
    v_mfma_f32_32x32x16_bf16 v[160:175], a[24:27], v[136:139], v[160:175]
    ds_read_b64_tr_b16 a[20:21], v244 offset:10240
    ds_read_b64_tr_b16 a[22:23], v244 offset:11264
    v_mul_f32 v180, v180, v156
    v_mul_f32 v177, v177, v153
    v_mul_f32 v181, v181, v157
    v_mul_f32 v178, v178, v154
    v_mfma_f32_32x32x16_bf16 v[160:175], a[28:31], v[140:143], v[160:175]
    ds_read_b64_tr_b16 a[24:25], v244 offset:12288
    ds_read_b64_tr_b16 a[26:27], v244 offset:13312
    v_mul_f32 v182, v182, v158
    v_mul_f32 v179, v179, v155
    v_mul_f32 v183, v183, v159
    v_cvt_pk_bf16_f32 v228, v176, v177
    v_cvt_pk_bf16_f32 v230, v180, v181
    v_cvt_pk_bf16_f32 v229, v178, v179
    v_cvt_pk_bf16_f32 v231, v182, v183
    s_waitcnt lgkmcnt(6)
    v_mfma_f32_32x32x16_bf16 v[144:159], a[0:3], a[32:35], 0
    ds_read_b64_tr_b16 a[28:29], v244 offset:14336
    ds_read_b64_tr_b16 a[30:31], v244 offset:15360
    buffer_load_dwordx4 v252, s[12:15], s46 offen offset:2048 lds
    v_mul_f32 v176, v160, v245
    v_mul_f32 v180, v164, v245
    v_mul_f32 v177, v161, v245
    v_mfma_f32_32x32x16_bf16 v[144:159], a[4:7], a[36:39], v[144:159]
    ds_read_b64_tr_b16 a[0:1], v244 offset:16384
    ds_read_b64_tr_b16 a[2:3], v244 offset:17408
    buffer_load_dwordx4 v253, s[12:15], s46 offen offset:3072 lds
    v_mul_f32 v181, v165, v245
    v_mul_f32 v178, v162, v245
    v_mul_f32 v182, v166, v245
    v_mfma_f32_32x32x16_bf16 v[144:159], a[8:11], a[40:43], v[144:159]
    ds_read_b64_tr_b16 a[4:5], v244 offset:18432
    ds_read_b64_tr_b16 a[6:7], v244 offset:19456
    v_mul_f32 v179, v163, v245
    v_mul_f32 v183, v167, v245
    v_exp_f32 v176, v176
    v_mfma_f32_32x32x16_bf16 v[144:159], a[12:15], a[44:47], v[144:159]
    ds_read_b64_tr_b16 a[8:9], v244 offset:20480
    ds_read_b64_tr_b16 a[10:11], v244 offset:21504
    v_exp_f32 v180, v180
    s_waitcnt lgkmcnt(6)
    v_mfma_f32_32x32x16_bf16 v[144:159], a[16:19], a[48:51], v[144:159]
    ds_read_b64_tr_b16 a[12:13], v244 offset:22528
    ds_read_b64_tr_b16 a[14:15], v244 offset:23552
    s_add_u32 m0, s33, 73728
    s_add_u32 s46, s28, 221312
    buffer_load_dwordx4 v250, s[12:15], s46 offen offset:0 lds
    v_mfma_f32_32x32x16_bf16 v[144:159], a[20:23], a[52:55], v[144:159]
    s_waitcnt vmcnt(11)
    s_barrier
    ds_read_b64_tr_b16 a[16:17], v244 offset:24576
    ds_read_b64_tr_b16 a[18:19], v244 offset:25600
    v_exp_f32 v177, v177
    v_mfma_f32_32x32x16_bf16 v[144:159], a[24:27], a[56:59], v[144:159]
    ds_read_b64_tr_b16 a[20:21], v244 offset:26624
    ds_read_b64_tr_b16 a[22:23], v244 offset:27648
    v_exp_f32 v181, v181
    v_exp_f32 v178, v178
    v_mfma_f32_32x32x16_bf16 v[144:159], a[28:31], a[60:63], v[144:159]
    ds_read_b64_tr_b16 a[24:25], v244 offset:28672
    ds_read_b64_tr_b16 a[26:27], v244 offset:29696
    buffer_load_dwordx4 v251, s[12:15], s46 offen offset:1024 lds
    v_exp_f32 v182, v182
    s_waitcnt lgkmcnt(6)
    v_mfma_f32_32x32x16_bf16 v[144:159], a[0:3], a[64:67], v[144:159]
    ds_read_b64_tr_b16 a[28:29], v244 offset:30720
    ds_read_b64_tr_b16 a[30:31], v244 offset:31744
    v_exp_f32 v179, v179
    v_exp_f32 v183, v183
    v_mfma_f32_32x32x16_bf16 v[144:159], a[4:7], a[68:71], v[144:159]
    ds_read_b64_tr_b16 a[0:1], v244 offset:32768
    ds_read_b64_tr_b16 a[2:3], v244 offset:33792
    v_add_f32 v176, 1.0, v176
    v_add_f32 v180, 1.0, v180
    v_add_f32 v177, 1.0, v177
    v_add_f32 v181, 1.0, v181
    v_mfma_f32_32x32x16_bf16 v[144:159], a[8:11], v[184:187], v[144:159]
    ds_read_b64_tr_b16 a[4:5], v244 offset:34816
    ds_read_b64_tr_b16 a[6:7], v244 offset:35840
    s_add_u32 m0, s32, 98304
    s_add_u32 s46, s27, 256
    buffer_load_dwordx4 v250, s[12:15], s46 offen offset:0 lds
    v_add_f32 v178, 1.0, v178
    v_mfma_f32_32x32x16_bf16 v[144:159], a[12:15], v[188:191], v[144:159]
    ds_read_b64_tr_b16 a[8:9], v244 offset:36864
    ds_read_b64_tr_b16 a[10:11], v244 offset:37888
    v_add_f32 v182, 1.0, v182
    v_add_f32 v179, 1.0, v179
    v_add_f32 v183, 1.0, v183
    s_waitcnt lgkmcnt(6)
    v_mfma_f32_32x32x16_bf16 v[144:159], a[16:19], v[192:195], v[144:159]
    ds_read_b64_tr_b16 a[12:13], v244 offset:38912
    ds_read_b64_tr_b16 a[14:15], v244 offset:39936
    v_rcp_f32 v176, v176
    v_rcp_f32 v180, v180
    v_mfma_f32_32x32x16_bf16 v[144:159], a[20:23], v[196:199], v[144:159]
    ds_read_b64_tr_b16 a[16:17], v244 offset:40960
    ds_read_b64_tr_b16 a[18:19], v244 offset:41984
    buffer_load_dwordx4 v251, s[12:15], s46 offen offset:1024 lds
    v_rcp_f32 v177, v177
    v_mfma_f32_32x32x16_bf16 v[144:159], a[24:27], v[200:203], v[144:159]
    ds_read_b64_tr_b16 a[20:21], v244 offset:43008
    ds_read_b64_tr_b16 a[22:23], v244 offset:44032
    v_rcp_f32 v181, v181
    v_rcp_f32 v178, v178
    v_mfma_f32_32x32x16_bf16 v[144:159], a[28:31], v[204:207], v[144:159]
    ds_read_b64_tr_b16 a[24:25], v244 offset:45056
    ds_read_b64_tr_b16 a[26:27], v244 offset:46080
    v_rcp_f32 v182, v182
    s_waitcnt lgkmcnt(6)
    v_mfma_f32_32x32x16_bf16 v[144:159], a[0:3], v[208:211], v[144:159]
    ds_read_b64_tr_b16 a[28:29], v244 offset:47104
    ds_read_b64_tr_b16 a[30:31], v244 offset:48128
    buffer_load_dwordx4 v252, s[12:15], s46 offen offset:2048 lds
    v_rcp_f32 v179, v179
    v_mul_f32 v176, v176, v160
    v_mfma_f32_32x32x16_bf16 v[144:159], a[4:7], v[212:215], v[144:159]
    ds_read_b64_tr_b16 a[0:1], v240 offset:0
    ds_read_b64_tr_b16 a[2:3], v240 offset:1024
    v_rcp_f32 v183, v183
    v_mul_f32 v180, v180, v164
    v_mul_f32 v177, v177, v161
    v_mfma_f32_32x32x16_bf16 v[144:159], a[8:11], v[216:219], v[144:159]
    ds_read_b64_tr_b16 a[4:5], v240 offset:2048
    ds_read_b64_tr_b16 a[6:7], v240 offset:3072
    v_mul_f32 v181, v181, v165
    v_mul_f32 v178, v178, v162
    v_mul_f32 v182, v182, v166
    v_mul_f32 v179, v179, v163
    v_mfma_f32_32x32x16_bf16 v[144:159], a[12:15], v[220:223], v[144:159]
    ds_read_b64_tr_b16 a[8:9], v240 offset:4096
    ds_read_b64_tr_b16 a[10:11], v240 offset:5120
    buffer_load_dwordx4 v253, s[12:15], s46 offen offset:3072 lds
    v_mul_f32 v183, v183, v167
    v_cvt_pk_bf16_f32 v232, v176, v177
    s_waitcnt lgkmcnt(6)
    v_mfma_f32_32x32x16_bf16 v[144:159], a[16:19], v[224:227], v[144:159]
    ds_read_b64_tr_b16 a[12:13], v240 offset:6144
    ds_read_b64_tr_b16 a[14:15], v240 offset:7168
    v_cvt_pk_bf16_f32 v234, v180, v181
    v_cvt_pk_bf16_f32 v233, v178, v179
    v_cvt_pk_bf16_f32 v235, v182, v183
    v_mul_f32 v176, v168, v245
    v_mfma_f32_32x32x16_bf16 v[144:159], a[20:23], v[228:231], v[144:159]
    ds_read_b64_tr_b16 a[16:17], v240 offset:8192
    ds_read_b64_tr_b16 a[18:19], v240 offset:9216
    v_mul_f32 v180, v172, v245
    v_mul_f32 v177, v169, v245
    v_mul_f32 v181, v173, v245
    v_mul_f32 v178, v170, v245
    v_mul_f32 v182, v174, v245
    v_mul_f32 v179, v171, v245
    v_mul_f32 v183, v175, v245
    v_exp_f32 v176, v176
    v_exp_f32 v180, v180
    v_exp_f32 v177, v177
    v_exp_f32 v181, v181
    v_exp_f32 v178, v178
    v_exp_f32 v182, v182
    v_exp_f32 v179, v179
    v_exp_f32 v183, v183
    v_add_f32 v176, 1.0, v176
    v_add_f32 v180, 1.0, v180
    v_add_f32 v177, 1.0, v177
    v_add_f32 v181, 1.0, v181
    v_add_f32 v178, 1.0, v178
    v_add_f32 v182, 1.0, v182
    v_add_f32 v179, 1.0, v179
    v_add_f32 v183, 1.0, v183
    v_rcp_f32 v176, v176
    v_rcp_f32 v180, v180
    v_rcp_f32 v177, v177
    v_rcp_f32 v181, v181
    v_rcp_f32 v178, v178
    v_rcp_f32 v182, v182
    v_rcp_f32 v179, v179
    v_rcp_f32 v183, v183
    v_mul_f32 v176, v176, v168
    v_mul_f32 v180, v180, v172
    v_mul_f32 v177, v177, v169
    v_mul_f32 v181, v181, v173
    v_mul_f32 v178, v178, v170
    v_mul_f32 v182, v182, v174
    v_mul_f32 v179, v179, v171
    v_mul_f32 v183, v183, v175
    v_cvt_pk_bf16_f32 v236, v176, v177
    v_cvt_pk_bf16_f32 v238, v180, v181
    v_cvt_pk_bf16_f32 v237, v178, v179
    v_cvt_pk_bf16_f32 v239, v182, v183
    v_mfma_f32_32x32x16_bf16 v[144:159], a[24:27], v[232:235], v[144:159]
    ds_read_b64_tr_b16 a[20:21], v240 offset:10240
    ds_read_b64_tr_b16 a[22:23], v240 offset:11264
    s_add_u32 m0, s33, 98304
    s_add_u32 s46, s28, 256
    buffer_load_dwordx4 v250, s[12:15], s46 offen offset:0 lds
    v_mfma_f32_32x32x16_bf16 v[144:159], a[28:31], v[236:239], v[144:159]
    ds_read_b64_tr_b16 a[24:25], v240 offset:12288
    ds_read_b64_tr_b16 a[26:27], v240 offset:13312
    s_waitcnt lgkmcnt(6)
    v_mfma_f32_32x32x16_bf16 v[160:175], a[0:3], a[32:35], 0
    ds_read_b64_tr_b16 a[28:29], v240 offset:14336
    ds_read_b64_tr_b16 a[30:31], v240 offset:15360
    v_add_u32 v244, 49152, v244
    v_mfma_f32_32x32x16_bf16 v[160:175], a[4:7], a[36:39], v[160:175]
    ds_read_b64_tr_b16 a[0:1], v240 offset:16384
    ds_read_b64_tr_b16 a[2:3], v240 offset:17408
    buffer_load_dwordx4 v251, s[12:15], s46 offen offset:1024 lds
    v_mfma_f32_32x32x16_bf16 v[160:175], a[8:11], a[40:43], v[160:175]
    ds_read_b64_tr_b16 a[4:5], v240 offset:18432
    ds_read_b64_tr_b16 a[6:7], v240 offset:19456
    v_mfma_f32_32x32x16_bf16 v[160:175], a[12:15], a[44:47], v[160:175]
    ds_read_b64_tr_b16 a[8:9], v240 offset:20480
    ds_read_b64_tr_b16 a[10:11], v240 offset:21504
    v_cvt_pk_bf16_f32 v176, v144, v145
    v_cvt_pk_bf16_f32 v177, v146, v147
    v_cvt_pk_bf16_f32 v178, v148, v149
    s_waitcnt lgkmcnt(6)
    v_mfma_f32_32x32x16_bf16 v[160:175], a[16:19], a[48:51], v[160:175]
    ds_read_b64_tr_b16 a[12:13], v240 offset:22528
    ds_read_b64_tr_b16 a[14:15], v240 offset:23552
    s_add_u32 m0, s32, 122880
    s_add_u32 s46, s27, 221440
    buffer_load_dwordx4 v250, s[12:15], s46 offen offset:0 lds
    v_cvt_pk_bf16_f32 v179, v150, v151
    v_mfma_f32_32x32x16_bf16 v[160:175], a[20:23], a[52:55], v[160:175]
    ds_read_b64_tr_b16 a[16:17], v240 offset:24576
    ds_read_b64_tr_b16 a[18:19], v240 offset:25600
    v_cvt_pk_bf16_f32 v180, v152, v153
    v_cvt_pk_bf16_f32 v181, v154, v155
    v_cvt_pk_bf16_f32 v182, v156, v157
    v_cvt_pk_bf16_f32 v183, v158, v159
    v_mfma_f32_32x32x16_bf16 v[160:175], a[24:27], a[56:59], v[160:175]
    ds_read_b64_tr_b16 a[20:21], v240 offset:26624
    ds_read_b64_tr_b16 a[22:23], v240 offset:27648
    v_mfma_f32_32x32x16_bf16 v[160:175], a[28:31], a[60:63], v[160:175]
    ds_read_b64_tr_b16 a[24:25], v240 offset:28672
    ds_read_b64_tr_b16 a[26:27], v240 offset:29696
    s_add_u32 s48, s34, 0
    buffer_store_dwordx4 v[176:179], v254, s[16:19], s48 offen offset:0 sc1
    s_waitcnt lgkmcnt(6)
    v_mfma_f32_32x32x16_bf16 v[160:175], a[0:3], a[64:67], v[160:175]
    ds_read_b64_tr_b16 a[28:29], v240 offset:30720
    ds_read_b64_tr_b16 a[30:31], v240 offset:31744
    v_mfma_f32_32x32x16_bf16 v[160:175], a[4:7], a[68:71], v[160:175]
    ds_read_b64_tr_b16 a[0:1], v240 offset:32768
    ds_read_b64_tr_b16 a[2:3], v240 offset:33792
    v_mfma_f32_32x32x16_bf16 v[160:175], a[8:11], v[184:187], v[160:175]
    ds_read_b64_tr_b16 a[4:5], v240 offset:34816
    ds_read_b64_tr_b16 a[6:7], v240 offset:35840
    buffer_store_dwordx4 v[180:183], v254, s[16:19], s48 offen offset:1024 sc1
    v_mfma_f32_32x32x16_bf16 v[160:175], a[12:15], v[188:191], v[160:175]
    ds_read_b64_tr_b16 a[8:9], v240 offset:36864
    ds_read_b64_tr_b16 a[10:11], v240 offset:37888
    s_waitcnt lgkmcnt(6)
    v_mfma_f32_32x32x16_bf16 v[160:175], a[16:19], v[192:195], v[160:175]
    ds_read_b64_tr_b16 a[12:13], v240 offset:38912
    ds_read_b64_tr_b16 a[14:15], v240 offset:39936
    v_mfma_f32_32x32x16_bf16 v[160:175], a[20:23], v[196:199], v[160:175]
    ds_read_b64_tr_b16 a[16:17], v240 offset:40960
    ds_read_b64_tr_b16 a[18:19], v240 offset:41984
    buffer_load_dwordx4 v251, s[12:15], s46 offen offset:1024 lds
    v_mfma_f32_32x32x16_bf16 v[160:175], a[24:27], v[200:203], v[160:175]
    ds_read_b64_tr_b16 a[20:21], v240 offset:43008
    ds_read_b64_tr_b16 a[22:23], v240 offset:44032
    v_mfma_f32_32x32x16_bf16 v[160:175], a[28:31], v[204:207], v[160:175]
    ds_read_b64_tr_b16 a[24:25], v240 offset:45056
    ds_read_b64_tr_b16 a[26:27], v240 offset:46080
    s_waitcnt lgkmcnt(6)
    v_mfma_f32_32x32x16_bf16 v[160:175], a[0:3], v[208:211], v[160:175]
    ds_read_b64_tr_b16 a[28:29], v240 offset:47104
    ds_read_b64_tr_b16 a[30:31], v240 offset:48128
    buffer_load_dwordx4 v252, s[12:15], s46 offen offset:2048 lds
    v_mfma_f32_32x32x16_bf16 v[160:175], a[4:7], v[212:215], v[160:175]
    s_waitcnt vmcnt(17)
    s_barrier
    ds_read_b64_tr_b16 a[0:1], v244 offset:0
    ds_read_b64_tr_b16 a[2:3], v244 offset:1024
    v_mfma_f32_32x32x16_bf16 v[160:175], a[8:11], v[216:219], v[160:175]
    ds_read_b64_tr_b16 a[4:5], v244 offset:2048
    ds_read_b64_tr_b16 a[6:7], v244 offset:3072
    v_mfma_f32_32x32x16_bf16 v[160:175], a[12:15], v[220:223], v[160:175]
    ds_read_b64_tr_b16 a[8:9], v244 offset:4096
    ds_read_b64_tr_b16 a[10:11], v244 offset:5120
    buffer_load_dwordx4 v253, s[12:15], s46 offen offset:3072 lds
    s_waitcnt lgkmcnt(6)
    v_mfma_f32_32x32x16_bf16 v[160:175], a[16:19], v[224:227], v[160:175]
    ds_read_b64_tr_b16 a[12:13], v244 offset:6144
    ds_read_b64_tr_b16 a[14:15], v244 offset:7168
    v_mfma_f32_32x32x16_bf16 v[160:175], a[20:23], v[228:231], v[160:175]
    ds_read_b64_tr_b16 a[16:17], v244 offset:8192
    ds_read_b64_tr_b16 a[18:19], v244 offset:9216
    v_mfma_f32_32x32x16_bf16 v[160:175], a[24:27], v[232:235], v[160:175]
    ds_read_b64_tr_b16 a[20:21], v244 offset:10240
    ds_read_b64_tr_b16 a[22:23], v244 offset:11264
    s_add_u32 m0, s33, 122880
    s_add_u32 s46, s28, 221440
    buffer_load_dwordx4 v250, s[12:15], s46 offen offset:0 lds
    v_mfma_f32_32x32x16_bf16 v[160:175], a[28:31], v[236:239], v[160:175]
    ds_read_b64_tr_b16 a[24:25], v244 offset:12288
    ds_read_b64_tr_b16 a[26:27], v244 offset:13312
    s_waitcnt lgkmcnt(6)
    v_mfma_f32_32x32x16_bf16 v[144:159], a[0:3], a[32:35], 0
    ds_read_b64_tr_b16 a[28:29], v244 offset:14336
    ds_read_b64_tr_b16 a[30:31], v244 offset:15360
    v_add_u32 v240, 49152, v240
    v_mfma_f32_32x32x16_bf16 v[144:159], a[4:7], a[36:39], v[144:159]
    ds_read_b64_tr_b16 a[0:1], v244 offset:16384
    ds_read_b64_tr_b16 a[2:3], v244 offset:17408
    buffer_load_dwordx4 v251, s[12:15], s46 offen offset:1024 lds
    v_mfma_f32_32x32x16_bf16 v[144:159], a[8:11], a[40:43], v[144:159]
    ds_read_b64_tr_b16 a[4:5], v244 offset:18432
    ds_read_b64_tr_b16 a[6:7], v244 offset:19456
    v_mfma_f32_32x32x16_bf16 v[144:159], a[12:15], a[44:47], v[144:159]
    ds_read_b64_tr_b16 a[8:9], v244 offset:20480
    ds_read_b64_tr_b16 a[10:11], v244 offset:21504
    v_cvt_pk_bf16_f32 v176, v160, v161
    v_cvt_pk_bf16_f32 v177, v162, v163
    v_cvt_pk_bf16_f32 v178, v164, v165
    s_waitcnt lgkmcnt(6)
    v_mfma_f32_32x32x16_bf16 v[144:159], a[16:19], a[48:51], v[144:159]
    ds_read_b64_tr_b16 a[12:13], v244 offset:22528
    ds_read_b64_tr_b16 a[14:15], v244 offset:23552
    s_add_u32 m0, s32, 0
    s_add_u32 s46, s27, 384
    buffer_load_dwordx4 v250, s[12:15], s46 offen offset:0 lds
    v_cvt_pk_bf16_f32 v179, v166, v167
    v_mfma_f32_32x32x16_bf16 v[144:159], a[20:23], a[52:55], v[144:159]
    s_waitcnt vmcnt(15)
    s_barrier
    ds_read_b64_tr_b16 a[16:17], v244 offset:24576
    ds_read_b64_tr_b16 a[18:19], v244 offset:25600
    v_cvt_pk_bf16_f32 v180, v168, v169
    v_cvt_pk_bf16_f32 v181, v170, v171
    v_mfma_f32_32x32x16_bf16 v[144:159], a[24:27], a[56:59], v[144:159]
    ds_read_b64_tr_b16 a[20:21], v244 offset:26624
    ds_read_b64_tr_b16 a[22:23], v244 offset:27648
    v_cvt_pk_bf16_f32 v182, v172, v173
    v_cvt_pk_bf16_f32 v183, v174, v175
    v_lshrrev_b32 v1, 4, v254
    v_mfma_f32_32x32x16_bf16 v[144:159], a[28:31], a[60:63], v[144:159]
    ds_read_b64_tr_b16 a[24:25], v244 offset:28672
    ds_read_b64_tr_b16 a[26:27], v244 offset:29696
    s_add_u32 s48, s34, 24576
    buffer_store_dwordx4 v[176:179], v254, s[16:19], s48 offen offset:0 sc1
    s_waitcnt lgkmcnt(6)
    v_mfma_f32_32x32x16_bf16 v[144:159], a[0:3], a[64:67], v[144:159]
    ds_read_b64_tr_b16 a[28:29], v244 offset:30720
    ds_read_b64_tr_b16 a[30:31], v244 offset:31744
    v_and_b32 v2, 31, v1
    v_lshrrev_b32 v3, 5, v1
    v_bfe_u32 v4, v2, 2, 1
    v_mfma_f32_32x32x16_bf16 v[144:159], a[4:7], a[68:71], v[144:159]
    ds_read_b64_tr_b16 a[0:1], v244 offset:32768
    ds_read_b64_tr_b16 a[2:3], v244 offset:33792
    v_lshlrev_b32 v4, 3, v4
    v_bfe_u32 v5, v2, 3, 1
    v_lshl_add_u32 v4, v5, 2, v4
    v_mfma_f32_32x32x16_bf16 v[144:159], a[8:11], v[184:187], v[144:159]
    ds_read_b64_tr_b16 a[4:5], v244 offset:34816
    ds_read_b64_tr_b16 a[6:7], v244 offset:35840
    buffer_store_dwordx4 v[180:183], v254, s[16:19], s48 offen offset:1024 sc1
    v_and_b32 v5, 3, v2
    v_add_u32 v4, v4, v5
    v_mfma_f32_32x32x16_bf16 v[144:159], a[12:15], v[188:191], v[144:159]
    ds_read_b64_tr_b16 a[8:9], v244 offset:36864
    ds_read_b64_tr_b16 a[10:11], v244 offset:37888
    v_lshlrev_b32 v5, 2, v3
    v_sub_u32 v4, v4, v5
    s_waitcnt lgkmcnt(6)
    v_mfma_f32_32x32x16_bf16 v[144:159], a[16:19], v[192:195], v[144:159]
    ds_read_b64_tr_b16 a[12:13], v244 offset:38912
    ds_read_b64_tr_b16 a[14:15], v244 offset:39936
    v_cmp_gt_u32 vcc, 16, v2
    v_mov_b32 v5, 99
    s_nop 0
    v_cndmask_b32 v4, v5, v4, vcc
    v_mfma_f32_32x32x16_bf16 v[144:159], a[20:23], v[196:199], v[144:159]
    ds_read_b64_tr_b16 a[16:17], v244 offset:40960
    ds_read_b64_tr_b16 a[18:19], v244 offset:41984
    buffer_load_dwordx4 v251, s[12:15], s46 offen offset:1024 lds
    v_mov_b32 v6, 0x3f80
    v_mov_b32 v7, 0x3f800000
    v_mfma_f32_32x32x16_bf16 v[144:159], a[24:27], v[200:203], v[144:159]
    ds_read_b64_tr_b16 a[20:21], v244 offset:43008
    ds_read_b64_tr_b16 a[22:23], v244 offset:44032
    v_cmp_eq_u32 vcc, 0, v4
    s_nop 1
    v_cndmask_b32 v8, 0, v6, vcc
    v_mfma_f32_32x32x16_bf16 v[144:159], a[28:31], v[204:207], v[144:159]
    ds_read_b64_tr_b16 a[24:25], v244 offset:45056
    ds_read_b64_tr_b16 a[26:27], v244 offset:46080
    v_cmp_eq_u32 vcc, 1, v4
    s_nop 1
    v_cndmask_b32 v5, 0, v7, vcc
    s_waitcnt lgkmcnt(6)
    v_mfma_f32_32x32x16_bf16 v[144:159], a[0:3], v[208:211], v[144:159]
    ds_read_b64_tr_b16 a[28:29], v244 offset:47104
    ds_read_b64_tr_b16 a[30:31], v244 offset:48128
    buffer_load_dwordx4 v252, s[12:15], s46 offen offset:2048 lds
    v_or_b32 v8, v8, v5
    v_cmp_eq_u32 vcc, 2, v4
    s_nop 1
    v_cndmask_b32 v9, 0, v6, vcc
    v_mfma_f32_32x32x16_bf16 v[144:159], a[4:7], v[212:215], v[144:159]
    ds_read_b64_tr_b16 a[0:1], v240 offset:0
    ds_read_b64_tr_b16 a[2:3], v240 offset:1024
    v_cmp_eq_u32 vcc, 3, v4
    s_nop 1
    v_cndmask_b32 v5, 0, v7, vcc
    v_mfma_f32_32x32x16_bf16 v[144:159], a[8:11], v[216:219], v[144:159]
    ds_read_b64_tr_b16 a[4:5], v240 offset:2048
    ds_read_b64_tr_b16 a[6:7], v240 offset:3072
    v_or_b32 v9, v9, v5
    v_cmp_eq_u32 vcc, 8, v4
    s_nop 1
    v_cndmask_b32 v10, 0, v6, vcc
    v_mfma_f32_32x32x16_bf16 v[144:159], a[12:15], v[220:223], v[144:159]
    ds_read_b64_tr_b16 a[8:9], v240 offset:4096
    ds_read_b64_tr_b16 a[10:11], v240 offset:5120
    buffer_load_dwordx4 v253, s[12:15], s46 offen offset:3072 lds
    v_cmp_eq_u32 vcc, 9, v4
    s_nop 1
    v_cndmask_b32 v5, 0, v7, vcc
    s_waitcnt lgkmcnt(6)
    v_mfma_f32_32x32x16_bf16 v[144:159], a[16:19], v[224:227], v[144:159]
    ds_read_b64_tr_b16 a[12:13], v240 offset:6144
    ds_read_b64_tr_b16 a[14:15], v240 offset:7168
    v_or_b32 v10, v10, v5
    v_cmp_eq_u32 vcc, 10, v4
    s_nop 1
    v_cndmask_b32 v11, 0, v6, vcc
    v_mfma_f32_32x32x16_bf16 v[144:159], a[20:23], v[228:231], v[144:159]
    ds_read_b64_tr_b16 a[16:17], v240 offset:8192
    ds_read_b64_tr_b16 a[18:19], v240 offset:9216
    v_cmp_eq_u32 vcc, 11, v4
    s_nop 1
    v_cndmask_b32 v5, 0, v7, vcc
    v_mfma_f32_32x32x16_bf16 v[144:159], a[24:27], v[232:235], v[144:159]
    ds_read_b64_tr_b16 a[20:21], v240 offset:10240
    ds_read_b64_tr_b16 a[22:23], v240 offset:11264
    s_add_u32 m0, s33, 0
    s_add_u32 s46, s28, 384
    buffer_load_dwordx4 v250, s[12:15], s46 offen offset:0 lds
    v_mfma_f32_32x32x16_bf16 v[144:159], a[28:31], v[236:239], v[144:159]
    ds_read_b64_tr_b16 a[24:25], v240 offset:12288
    ds_read_b64_tr_b16 a[26:27], v240 offset:13312
    v_or_b32 v11, v11, v5
    v_mul_u32_u24 v12, 1152, v2
    s_waitcnt lgkmcnt(6)
    v_mfma_f32_32x32x16_bf16 v[160:175], a[0:3], a[32:35], 0
    ds_read_b64_tr_b16 a[28:29], v240 offset:14336
    ds_read_b64_tr_b16 a[30:31], v240 offset:15360
    v_add_u32 v244, 49152, v244
    v_mfma_f32_32x32x16_bf16 v[160:175], a[4:7], a[36:39], v[160:175]
    ds_read_b64_tr_b16 a[0:1], v240 offset:16384
    ds_read_b64_tr_b16 a[2:3], v240 offset:17408
    buffer_load_dwordx4 v251, s[12:15], s46 offen offset:1024 lds
    v_mfma_f32_32x32x16_bf16 v[160:175], a[8:11], a[40:43], v[160:175]
    ds_read_b64_tr_b16 a[4:5], v240 offset:18432
    ds_read_b64_tr_b16 a[6:7], v240 offset:19456
    v_mfma_f32_32x32x16_bf16 v[160:175], a[12:15], a[44:47], v[160:175]
    ds_read_b64_tr_b16 a[8:9], v240 offset:20480
    ds_read_b64_tr_b16 a[10:11], v240 offset:21504
    v_cvt_pk_bf16_f32 v176, v144, v145
    v_cvt_pk_bf16_f32 v177, v146, v147
    v_cvt_pk_bf16_f32 v178, v148, v149
    s_waitcnt lgkmcnt(6)
    v_mfma_f32_32x32x16_bf16 v[160:175], a[16:19], a[48:51], v[160:175]
    ds_read_b64_tr_b16 a[12:13], v240 offset:22528
    ds_read_b64_tr_b16 a[14:15], v240 offset:23552
    s_add_u32 m0, s32, 24576
    s_add_u32 s46, s27, 221568
    buffer_load_dwordx4 v250, s[12:15], s46 offen offset:0 lds
    v_cvt_pk_bf16_f32 v179, v150, v151
    v_mfma_f32_32x32x16_bf16 v[160:175], a[20:23], a[52:55], v[160:175]
    ds_read_b64_tr_b16 a[16:17], v240 offset:24576
    ds_read_b64_tr_b16 a[18:19], v240 offset:25600
    v_cvt_pk_bf16_f32 v180, v152, v153
    v_cvt_pk_bf16_f32 v181, v154, v155
    v_cvt_pk_bf16_f32 v182, v156, v157
    v_cvt_pk_bf16_f32 v183, v158, v159
    v_mfma_f32_32x32x16_bf16 v[160:175], a[24:27], a[56:59], v[160:175]
    ds_read_b64_tr_b16 a[20:21], v240 offset:26624
    ds_read_b64_tr_b16 a[22:23], v240 offset:27648
    v_lshlrev_b32 v15, 4, v3
    v_add_u32 v12, v12, v15
    v_lshrrev_b32 v4, 2, v1
    v_mfma_f32_32x32x16_bf16 v[160:175], a[28:31], a[60:63], v[160:175]
    ds_read_b64_tr_b16 a[24:25], v240 offset:28672
    ds_read_b64_tr_b16 a[26:27], v240 offset:29696
    s_add_u32 s48, s34, 49152
    buffer_store_dwordx4 v[176:179], v254, s[16:19], s48 offen offset:0 sc1
    s_waitcnt lgkmcnt(6)
    v_mfma_f32_32x32x16_bf16 v[160:175], a[0:3], a[64:67], v[160:175]
    ds_read_b64_tr_b16 a[28:29], v240 offset:30720
    ds_read_b64_tr_b16 a[30:31], v240 offset:31744
    v_lshlrev_b32 v4, 12, v4
    v_and_b32 v5, 3, v1
    v_lshl_add_u32 v13, v5, 4, v4
    v_mfma_f32_32x32x16_bf16 v[160:175], a[4:7], a[68:71], v[160:175]
    ds_read_b64_tr_b16 a[0:1], v240 offset:32768
    ds_read_b64_tr_b16 a[2:3], v240 offset:33792
    v_bfe_u32 v4, v1, 2, 2
    v_lshl_add_u32 v4, v3, 3, v4
    v_lshlrev_b32 v4, 6, v4
    v_mfma_f32_32x32x16_bf16 v[160:175], a[8:11], v[184:187], v[160:175]
    ds_read_b64_tr_b16 a[4:5], v240 offset:34816
    ds_read_b64_tr_b16 a[6:7], v240 offset:35840
    buffer_store_dwordx4 v[180:183], v254, s[16:19], s48 offen offset:1024 sc1
    v_bfe_u32 v6, v1, 4, 1
    v_lshl_add_u32 v4, v6, 5, v4
    v_mfma_f32_32x32x16_bf16 v[160:175], a[12:15], v[188:191], v[160:175]
    ds_read_b64_tr_b16 a[8:9], v240 offset:36864
    ds_read_b64_tr_b16 a[10:11], v240 offset:37888
    v_lshl_add_u32 v4, v5, 3, v4
    s_lshl_b32 s54, s22, 12
    s_waitcnt lgkmcnt(6)
    v_mfma_f32_32x32x16_bf16 v[160:175], a[16:19], v[192:195], v[160:175]
    ds_read_b64_tr_b16 a[12:13], v240 offset:38912
    ds_read_b64_tr_b16 a[14:15], v240 offset:39936
    v_add_u32 v14, s54, v4
    v_lshlrev_b32 v16, 4, v1
    v_accvgpr_read_b32 v17, a72
    v_mfma_f32_32x32x16_bf16 v[160:175], a[20:23], v[196:199], v[160:175]
    ds_read_b64_tr_b16 a[16:17], v240 offset:40960
    ds_read_b64_tr_b16 a[18:19], v240 offset:41984
    buffer_load_dwordx4 v251, s[12:15], s46 offen offset:1024 lds
    v_accvgpr_read_b32 v18, a73
    s_lshl_b32 s41, s20, 2
    v_mfma_f32_32x32x16_bf16 v[160:175], a[24:27], v[200:203], v[160:175]
    ds_read_b64_tr_b16 a[20:21], v240 offset:43008
    ds_read_b64_tr_b16 a[22:23], v240 offset:44032
    s_add_u32 s41, s41, s22
    s_lshl_b32 s40, s41, 5
    s_mul_i32 s42, s20, 4608
    v_mfma_f32_32x32x16_bf16 v[160:175], a[28:31], v[204:207], v[160:175]
    ds_read_b64_tr_b16 a[24:25], v240 offset:45056
    ds_read_b64_tr_b16 a[26:27], v240 offset:46080
    s_add_u32 s42, s42, 33619968
    v_lshlrev_b32 v2, 7, v1
    s_waitcnt lgkmcnt(6)
    v_mfma_f32_32x32x16_bf16 v[160:175], a[0:3], v[208:211], v[160:175]
    ds_read_b64_tr_b16 a[28:29], v240 offset:47104
    ds_read_b64_tr_b16 a[30:31], v240 offset:48128
    buffer_load_dwordx4 v252, s[12:15], s46 offen offset:2048 lds
    v_add_u32 v143, s42, v2
    v_add_u32 v142, 1536, v143
    v_mfma_f32_32x32x16_bf16 v[160:175], a[4:7], v[212:215], v[160:175]
    s_waitcnt vmcnt(21)
    s_barrier
    ds_read_b64_tr_b16 a[0:1], v244 offset:0
    ds_read_b64_tr_b16 a[2:3], v244 offset:1024
    v_subrev_u32 v2, 12, v1
    v_mfma_f32_32x32x16_bf16 v[160:175], a[8:11], v[216:219], v[160:175]
    ds_read_b64_tr_b16 a[4:5], v244 offset:2048
    ds_read_b64_tr_b16 a[6:7], v244 offset:3072
    v_mul_u32_u24 v3, 86, v2
    v_lshrrev_b32 v3, 8, v3
    v_mul_u32_u24 v4, 3, v3
    v_mfma_f32_32x32x16_bf16 v[160:175], a[12:15], v[220:223], v[160:175]
    ds_read_b64_tr_b16 a[8:9], v244 offset:4096
    ds_read_b64_tr_b16 a[10:11], v244 offset:5120
    buffer_load_dwordx4 v253, s[12:15], s46 offen offset:3072 lds
    v_sub_u32 v4, v2, v4
    s_waitcnt lgkmcnt(6)
    v_mfma_f32_32x32x16_bf16 v[160:175], a[16:19], v[224:227], v[160:175]
    ds_read_b64_tr_b16 a[12:13], v244 offset:6144
    ds_read_b64_tr_b16 a[14:15], v244 offset:7168
    v_mul_u32_u24 v3, 192, v3
    s_lshl_b32 s42, s21, 4
    v_add_u32 v3, s42, v3
    v_mfma_f32_32x32x16_bf16 v[160:175], a[20:23], v[228:231], v[160:175]
    ds_read_b64_tr_b16 a[16:17], v244 offset:8192
    ds_read_b64_tr_b16 a[18:19], v244 offset:9216
    v_mul_u32_u24 v3, 7282, v3
    v_lshrrev_b32 v3, 16, v3
    v_add_u32 v3, v3, v4
    v_mfma_f32_32x32x16_bf16 v[160:175], a[24:27], v[232:235], v[160:175]
    ds_read_b64_tr_b16 a[20:21], v244 offset:10240
    ds_read_b64_tr_b16 a[22:23], v244 offset:11264
    s_add_u32 m0, s33, 24576
    s_add_u32 s46, s28, 221568
    buffer_load_dwordx4 v250, s[12:15], s46 offen offset:0 lds
    v_mfma_f32_32x32x16_bf16 v[160:175], a[28:31], v[236:239], v[160:175]
    ds_read_b64_tr_b16 a[24:25], v244 offset:12288
    ds_read_b64_tr_b16 a[26:27], v244 offset:13312
    v_min_u32 v3, 63, v3
    v_lshlrev_b32 v3, 7, v3
    s_waitcnt lgkmcnt(6)
    v_mfma_f32_32x32x16_bf16 v[144:159], a[0:3], a[32:35], 0
    ds_read_b64_tr_b16 a[28:29], v244 offset:14336
    ds_read_b64_tr_b16 a[30:31], v244 offset:15360
    v_add_u32 v240, 49152, v240
    v_mfma_f32_32x32x16_bf16 v[144:159], a[4:7], a[36:39], v[144:159]
    ds_read_b64_tr_b16 a[0:1], v244 offset:16384
    ds_read_b64_tr_b16 a[2:3], v244 offset:17408
    buffer_load_dwordx4 v251, s[12:15], s46 offen offset:1024 lds
    v_mfma_f32_32x32x16_bf16 v[144:159], a[8:11], a[40:43], v[144:159]
    ds_read_b64_tr_b16 a[4:5], v244 offset:18432
    ds_read_b64_tr_b16 a[6:7], v244 offset:19456
    v_mfma_f32_32x32x16_bf16 v[144:159], a[12:15], a[44:47], v[144:159]
    ds_read_b64_tr_b16 a[8:9], v244 offset:20480
    ds_read_b64_tr_b16 a[10:11], v244 offset:21504
    v_cvt_pk_bf16_f32 v176, v160, v161
    v_cvt_pk_bf16_f32 v177, v162, v163
    v_cvt_pk_bf16_f32 v178, v164, v165
    s_waitcnt lgkmcnt(6)
    v_mfma_f32_32x32x16_bf16 v[144:159], a[16:19], a[48:51], v[144:159]
    ds_read_b64_tr_b16 a[12:13], v244 offset:22528
    ds_read_b64_tr_b16 a[14:15], v244 offset:23552
    s_add_u32 m0, s32, 49152
    s_add_u32 s46, s27, 512
    buffer_load_dwordx4 v250, s[12:15], s46 offen offset:0 lds
    v_cvt_pk_bf16_f32 v179, v166, v167
    v_mfma_f32_32x32x16_bf16 v[144:159], a[20:23], a[52:55], v[144:159]
    s_waitcnt vmcnt(17)
    s_barrier
    ds_read_b64_tr_b16 a[16:17], v244 offset:24576
    ds_read_b64_tr_b16 a[18:19], v244 offset:25600
    v_cvt_pk_bf16_f32 v180, v168, v169
    v_cvt_pk_bf16_f32 v181, v170, v171
    v_mfma_f32_32x32x16_bf16 v[144:159], a[24:27], a[56:59], v[144:159]
    ds_read_b64_tr_b16 a[20:21], v244 offset:26624
    ds_read_b64_tr_b16 a[22:23], v244 offset:27648
    v_cvt_pk_bf16_f32 v182, v172, v173
    v_cvt_pk_bf16_f32 v183, v174, v175
    v_add_u32 v3, 33587200, v3
    v_mfma_f32_32x32x16_bf16 v[144:159], a[28:31], a[60:63], v[144:159]
    ds_read_b64_tr_b16 a[24:25], v244 offset:28672
    ds_read_b64_tr_b16 a[26:27], v244 offset:29696
    s_add_u32 s48, s34, 73728
    buffer_store_dwordx4 v[176:179], v254, s[16:19], s48 offen offset:0 sc1
    s_waitcnt lgkmcnt(6)
    v_mfma_f32_32x32x16_bf16 v[144:159], a[0:3], a[64:67], v[144:159]
    ds_read_b64_tr_b16 a[28:29], v244 offset:30720
    ds_read_b64_tr_b16 a[30:31], v244 offset:31744
    v_cmp_gt_u32 vcc, 12, v1
    s_nop 1
    v_cndmask_b32 v142, v3, v142, vcc
    v_mfma_f32_32x32x16_bf16 v[144:159], a[4:7], a[68:71], v[144:159]
    ds_read_b64_tr_b16 a[0:1], v244 offset:32768
    ds_read_b64_tr_b16 a[2:3], v244 offset:33792
    v_mfma_f32_32x32x16_bf16 v[144:159], a[8:11], v[184:187], v[144:159]
    ds_read_b64_tr_b16 a[4:5], v244 offset:34816
    ds_read_b64_tr_b16 a[6:7], v244 offset:35840
    buffer_store_dwordx4 v[180:183], v254, s[16:19], s48 offen offset:1024 sc1
    v_mfma_f32_32x32x16_bf16 v[144:159], a[12:15], v[188:191], v[144:159]
    ds_read_b64_tr_b16 a[8:9], v244 offset:36864
    ds_read_b64_tr_b16 a[10:11], v244 offset:37888
    s_waitcnt lgkmcnt(6)
    v_mfma_f32_32x32x16_bf16 v[144:159], a[16:19], v[192:195], v[144:159]
    ds_read_b64_tr_b16 a[12:13], v244 offset:38912
    ds_read_b64_tr_b16 a[14:15], v244 offset:39936
    v_mfma_f32_32x32x16_bf16 v[144:159], a[20:23], v[196:199], v[144:159]
    ds_read_b64_tr_b16 a[16:17], v244 offset:40960
    ds_read_b64_tr_b16 a[18:19], v244 offset:41984
    buffer_load_dwordx4 v251, s[12:15], s46 offen offset:1024 lds
    v_mfma_f32_32x32x16_bf16 v[144:159], a[24:27], v[200:203], v[144:159]
    ds_read_b64_tr_b16 a[20:21], v244 offset:43008
    ds_read_b64_tr_b16 a[22:23], v244 offset:44032
    v_mfma_f32_32x32x16_bf16 v[144:159], a[28:31], v[204:207], v[144:159]
    ds_read_b64_tr_b16 a[24:25], v244 offset:45056
    ds_read_b64_tr_b16 a[26:27], v244 offset:46080
    s_waitcnt lgkmcnt(6)
    v_mfma_f32_32x32x16_bf16 v[144:159], a[0:3], v[208:211], v[144:159]
    ds_read_b64_tr_b16 a[28:29], v244 offset:47104
    ds_read_b64_tr_b16 a[30:31], v244 offset:48128
    buffer_load_dwordx4 v252, s[12:15], s46 offen offset:2048 lds
    v_mfma_f32_32x32x16_bf16 v[144:159], a[4:7], v[212:215], v[144:159]
    ds_read_b64_tr_b16 a[0:1], v240 offset:0
    ds_read_b64_tr_b16 a[2:3], v240 offset:1024
    v_mfma_f32_32x32x16_bf16 v[144:159], a[8:11], v[216:219], v[144:159]
    ds_read_b64_tr_b16 a[4:5], v240 offset:2048
    ds_read_b64_tr_b16 a[6:7], v240 offset:3072
    v_mfma_f32_32x32x16_bf16 v[144:159], a[12:15], v[220:223], v[144:159]
    ds_read_b64_tr_b16 a[8:9], v240 offset:4096
    ds_read_b64_tr_b16 a[10:11], v240 offset:5120
    buffer_load_dwordx4 v253, s[12:15], s46 offen offset:3072 lds
    s_waitcnt lgkmcnt(6)
    v_mfma_f32_32x32x16_bf16 v[144:159], a[16:19], v[224:227], v[144:159]
    ds_read_b64_tr_b16 a[12:13], v240 offset:6144
    ds_read_b64_tr_b16 a[14:15], v240 offset:7168
    v_mfma_f32_32x32x16_bf16 v[144:159], a[20:23], v[228:231], v[144:159]
    ds_read_b64_tr_b16 a[16:17], v240 offset:8192
    ds_read_b64_tr_b16 a[18:19], v240 offset:9216
    v_mfma_f32_32x32x16_bf16 v[144:159], a[24:27], v[232:235], v[144:159]
    ds_read_b64_tr_b16 a[20:21], v240 offset:10240
    ds_read_b64_tr_b16 a[22:23], v240 offset:11264
    s_add_u32 m0, s33, 49152
    s_add_u32 s46, s28, 512
    buffer_load_dwordx4 v250, s[12:15], s46 offen offset:0 lds
    v_mfma_f32_32x32x16_bf16 v[144:159], a[28:31], v[236:239], v[144:159]
    ds_read_b64_tr_b16 a[24:25], v240 offset:12288
    ds_read_b64_tr_b16 a[26:27], v240 offset:13312
    s_waitcnt lgkmcnt(6)
    v_mfma_f32_32x32x16_bf16 v[160:175], a[0:3], a[32:35], 0
    ds_read_b64_tr_b16 a[28:29], v240 offset:14336
    ds_read_b64_tr_b16 a[30:31], v240 offset:15360
    v_subrev_u32 v244, 98304, v244
    v_mfma_f32_32x32x16_bf16 v[160:175], a[4:7], a[36:39], v[160:175]
    ds_read_b64_tr_b16 a[0:1], v240 offset:16384
    ds_read_b64_tr_b16 a[2:3], v240 offset:17408
    buffer_load_dwordx4 v251, s[12:15], s46 offen offset:1024 lds
    v_mfma_f32_32x32x16_bf16 v[160:175], a[8:11], a[40:43], v[160:175]
    ds_read_b64_tr_b16 a[4:5], v240 offset:18432
    ds_read_b64_tr_b16 a[6:7], v240 offset:19456
    v_mfma_f32_32x32x16_bf16 v[160:175], a[12:15], a[44:47], v[160:175]
    ds_read_b64_tr_b16 a[8:9], v240 offset:20480
    ds_read_b64_tr_b16 a[10:11], v240 offset:21504
    v_cvt_pk_bf16_f32 v176, v144, v145
    v_cvt_pk_bf16_f32 v177, v146, v147
    v_cvt_pk_bf16_f32 v178, v148, v149
    s_waitcnt lgkmcnt(6)
    v_mfma_f32_32x32x16_bf16 v[160:175], a[16:19], a[48:51], v[160:175]
    ds_read_b64_tr_b16 a[12:13], v240 offset:22528
    ds_read_b64_tr_b16 a[14:15], v240 offset:23552
    s_add_u32 m0, s32, 73728
    s_add_u32 s46, s27, 221696
    buffer_load_dwordx4 v250, s[12:15], s46 offen offset:0 lds
    v_cvt_pk_bf16_f32 v179, v150, v151
    v_mfma_f32_32x32x16_bf16 v[160:175], a[20:23], a[52:55], v[160:175]
    ds_read_b64_tr_b16 a[16:17], v240 offset:24576
    ds_read_b64_tr_b16 a[18:19], v240 offset:25600
    v_cvt_pk_bf16_f32 v180, v152, v153
    v_cvt_pk_bf16_f32 v181, v154, v155
    v_cvt_pk_bf16_f32 v182, v156, v157
    v_cvt_pk_bf16_f32 v183, v158, v159
    v_mfma_f32_32x32x16_bf16 v[160:175], a[24:27], a[56:59], v[160:175]
    ds_read_b64_tr_b16 a[20:21], v240 offset:26624
    ds_read_b64_tr_b16 a[22:23], v240 offset:27648
    v_mfma_f32_32x32x16_bf16 v[160:175], a[28:31], a[60:63], v[160:175]
    ds_read_b64_tr_b16 a[24:25], v240 offset:28672
    ds_read_b64_tr_b16 a[26:27], v240 offset:29696
    s_add_u32 s48, s34, 98304
    buffer_store_dwordx4 v[176:179], v254, s[16:19], s48 offen offset:0 sc1
    s_waitcnt lgkmcnt(6)
    v_mfma_f32_32x32x16_bf16 v[160:175], a[0:3], a[64:67], v[160:175]
    ds_read_b64_tr_b16 a[28:29], v240 offset:30720
    ds_read_b64_tr_b16 a[30:31], v240 offset:31744
    v_mfma_f32_32x32x16_bf16 v[160:175], a[4:7], a[68:71], v[160:175]
    ds_read_b64_tr_b16 a[0:1], v240 offset:32768
    ds_read_b64_tr_b16 a[2:3], v240 offset:33792
    v_mfma_f32_32x32x16_bf16 v[160:175], a[8:11], v[184:187], v[160:175]
    ds_read_b64_tr_b16 a[4:5], v240 offset:34816
    ds_read_b64_tr_b16 a[6:7], v240 offset:35840
    buffer_store_dwordx4 v[180:183], v254, s[16:19], s48 offen offset:1024 sc1
    v_mfma_f32_32x32x16_bf16 v[160:175], a[12:15], v[188:191], v[160:175]
    ds_read_b64_tr_b16 a[8:9], v240 offset:36864
    ds_read_b64_tr_b16 a[10:11], v240 offset:37888
    s_waitcnt lgkmcnt(6)
    v_mfma_f32_32x32x16_bf16 v[160:175], a[16:19], v[192:195], v[160:175]
    ds_read_b64_tr_b16 a[12:13], v240 offset:38912
    ds_read_b64_tr_b16 a[14:15], v240 offset:39936
    v_mfma_f32_32x32x16_bf16 v[160:175], a[20:23], v[196:199], v[160:175]
    ds_read_b64_tr_b16 a[16:17], v240 offset:40960
    ds_read_b64_tr_b16 a[18:19], v240 offset:41984
    buffer_load_dwordx4 v251, s[12:15], s46 offen offset:1024 lds
    v_mfma_f32_32x32x16_bf16 v[160:175], a[24:27], v[200:203], v[160:175]
    ds_read_b64_tr_b16 a[20:21], v240 offset:43008
    ds_read_b64_tr_b16 a[22:23], v240 offset:44032
    v_mfma_f32_32x32x16_bf16 v[160:175], a[28:31], v[204:207], v[160:175]
    ds_read_b64_tr_b16 a[24:25], v240 offset:45056
    ds_read_b64_tr_b16 a[26:27], v240 offset:46080
    s_waitcnt lgkmcnt(6)
    v_mfma_f32_32x32x16_bf16 v[160:175], a[0:3], v[208:211], v[160:175]
    ds_read_b64_tr_b16 a[28:29], v240 offset:47104
    ds_read_b64_tr_b16 a[30:31], v240 offset:48128
    buffer_load_dwordx4 v252, s[12:15], s46 offen offset:2048 lds
    v_mfma_f32_32x32x16_bf16 v[160:175], a[4:7], v[212:215], v[160:175]
    s_waitcnt vmcnt(21)
    s_barrier
    ds_read_b64_tr_b16 a[0:1], v244 offset:0
    ds_read_b64_tr_b16 a[2:3], v244 offset:1024
    v_mfma_f32_32x32x16_bf16 v[160:175], a[8:11], v[216:219], v[160:175]
    ds_read_b64_tr_b16 a[4:5], v244 offset:2048
    ds_read_b64_tr_b16 a[6:7], v244 offset:3072
    v_mfma_f32_32x32x16_bf16 v[160:175], a[12:15], v[220:223], v[160:175]
    ds_read_b64_tr_b16 a[8:9], v244 offset:4096
    ds_read_b64_tr_b16 a[10:11], v244 offset:5120
    buffer_load_dwordx4 v253, s[12:15], s46 offen offset:3072 lds
    s_waitcnt lgkmcnt(6)
    v_mfma_f32_32x32x16_bf16 v[160:175], a[16:19], v[224:227], v[160:175]
    ds_read_b64_tr_b16 a[12:13], v244 offset:6144
    ds_read_b64_tr_b16 a[14:15], v244 offset:7168
    v_mfma_f32_32x32x16_bf16 v[160:175], a[20:23], v[228:231], v[160:175]
    ds_read_b64_tr_b16 a[16:17], v244 offset:8192
    ds_read_b64_tr_b16 a[18:19], v244 offset:9216
    v_mfma_f32_32x32x16_bf16 v[160:175], a[24:27], v[232:235], v[160:175]
    ds_read_b64_tr_b16 a[20:21], v244 offset:10240
    ds_read_b64_tr_b16 a[22:23], v244 offset:11264
    s_add_u32 m0, s33, 73728
    s_add_u32 s46, s28, 221696
    buffer_load_dwordx4 v250, s[12:15], s46 offen offset:0 lds
    v_mfma_f32_32x32x16_bf16 v[160:175], a[28:31], v[236:239], v[160:175]
    ds_read_b64_tr_b16 a[24:25], v244 offset:12288
    ds_read_b64_tr_b16 a[26:27], v244 offset:13312
    s_waitcnt lgkmcnt(6)
    v_mfma_f32_32x32x16_bf16 v[144:159], a[0:3], a[32:35], 0
    ds_read_b64_tr_b16 a[28:29], v244 offset:14336
    ds_read_b64_tr_b16 a[30:31], v244 offset:15360
    v_subrev_u32 v240, 98304, v240
    v_mfma_f32_32x32x16_bf16 v[144:159], a[4:7], a[36:39], v[144:159]
    ds_read_b64_tr_b16 a[0:1], v244 offset:16384
    ds_read_b64_tr_b16 a[2:3], v244 offset:17408
    buffer_load_dwordx4 v251, s[12:15], s46 offen offset:1024 lds
    v_mfma_f32_32x32x16_bf16 v[144:159], a[8:11], a[40:43], v[144:159]
    ds_read_b64_tr_b16 a[4:5], v244 offset:18432
    ds_read_b64_tr_b16 a[6:7], v244 offset:19456
    v_mfma_f32_32x32x16_bf16 v[144:159], a[12:15], a[44:47], v[144:159]
    ds_read_b64_tr_b16 a[8:9], v244 offset:20480
    ds_read_b64_tr_b16 a[10:11], v244 offset:21504
    v_cvt_pk_bf16_f32 v176, v160, v161
    v_cvt_pk_bf16_f32 v177, v162, v163
    v_cvt_pk_bf16_f32 v178, v164, v165
    s_waitcnt lgkmcnt(6)
    v_mfma_f32_32x32x16_bf16 v[144:159], a[16:19], a[48:51], v[144:159]
    ds_read_b64_tr_b16 a[12:13], v244 offset:22528
    ds_read_b64_tr_b16 a[14:15], v244 offset:23552
    s_add_u32 m0, s32, 98304
    s_add_u32 s46, s27, 640
    buffer_load_dwordx4 v250, s[12:15], s46 offen offset:0 lds
    v_cvt_pk_bf16_f32 v179, v166, v167
    v_mfma_f32_32x32x16_bf16 v[144:159], a[20:23], a[52:55], v[144:159]
    s_waitcnt vmcnt(17)
    s_barrier
    ds_read_b64_tr_b16 a[16:17], v244 offset:24576
    ds_read_b64_tr_b16 a[18:19], v244 offset:25600
    v_cvt_pk_bf16_f32 v180, v168, v169
    v_cvt_pk_bf16_f32 v181, v170, v171
    v_mfma_f32_32x32x16_bf16 v[144:159], a[24:27], a[56:59], v[144:159]
    ds_read_b64_tr_b16 a[20:21], v244 offset:26624
    ds_read_b64_tr_b16 a[22:23], v244 offset:27648
    v_cvt_pk_bf16_f32 v182, v172, v173
    v_cvt_pk_bf16_f32 v183, v174, v175
    v_mfma_f32_32x32x16_bf16 v[144:159], a[28:31], a[60:63], v[144:159]
    ds_read_b64_tr_b16 a[24:25], v244 offset:28672
    ds_read_b64_tr_b16 a[26:27], v244 offset:29696
    s_add_u32 s48, s34, 122880
    buffer_store_dwordx4 v[176:179], v254, s[16:19], s48 offen offset:0 sc1
    s_waitcnt lgkmcnt(6)
    v_mfma_f32_32x32x16_bf16 v[144:159], a[0:3], a[64:67], v[144:159]
    ds_read_b64_tr_b16 a[28:29], v244 offset:30720
    ds_read_b64_tr_b16 a[30:31], v244 offset:31744
    v_mfma_f32_32x32x16_bf16 v[144:159], a[4:7], a[68:71], v[144:159]
    ds_read_b64_tr_b16 a[0:1], v244 offset:32768
    ds_read_b64_tr_b16 a[2:3], v244 offset:33792
    v_mfma_f32_32x32x16_bf16 v[144:159], a[8:11], v[184:187], v[144:159]
    ds_read_b64_tr_b16 a[4:5], v244 offset:34816
    ds_read_b64_tr_b16 a[6:7], v244 offset:35840
    buffer_store_dwordx4 v[180:183], v254, s[16:19], s48 offen offset:1024 sc1
    v_mfma_f32_32x32x16_bf16 v[144:159], a[12:15], v[188:191], v[144:159]
    ds_read_b64_tr_b16 a[8:9], v244 offset:36864
    ds_read_b64_tr_b16 a[10:11], v244 offset:37888
    s_waitcnt lgkmcnt(6)
    v_mfma_f32_32x32x16_bf16 v[144:159], a[16:19], v[192:195], v[144:159]
    ds_read_b64_tr_b16 a[12:13], v244 offset:38912
    ds_read_b64_tr_b16 a[14:15], v244 offset:39936
    v_mfma_f32_32x32x16_bf16 v[144:159], a[20:23], v[196:199], v[144:159]
    ds_read_b64_tr_b16 a[16:17], v244 offset:40960
    ds_read_b64_tr_b16 a[18:19], v244 offset:41984
    buffer_load_dwordx4 v251, s[12:15], s46 offen offset:1024 lds
    v_mfma_f32_32x32x16_bf16 v[144:159], a[24:27], v[200:203], v[144:159]
    ds_read_b64_tr_b16 a[20:21], v244 offset:43008
    ds_read_b64_tr_b16 a[22:23], v244 offset:44032
    v_mfma_f32_32x32x16_bf16 v[144:159], a[28:31], v[204:207], v[144:159]
    ds_read_b64_tr_b16 a[24:25], v244 offset:45056
    ds_read_b64_tr_b16 a[26:27], v244 offset:46080
    s_waitcnt lgkmcnt(6)
    v_mfma_f32_32x32x16_bf16 v[144:159], a[0:3], v[208:211], v[144:159]
    ds_read_b64_tr_b16 a[28:29], v244 offset:47104
    ds_read_b64_tr_b16 a[30:31], v244 offset:48128
    buffer_load_dwordx4 v252, s[12:15], s46 offen offset:2048 lds
    v_mfma_f32_32x32x16_bf16 v[144:159], a[4:7], v[212:215], v[144:159]
    ds_read_b64_tr_b16 a[0:1], v240 offset:0
    ds_read_b64_tr_b16 a[2:3], v240 offset:1024
    v_mfma_f32_32x32x16_bf16 v[144:159], a[8:11], v[216:219], v[144:159]
    ds_read_b64_tr_b16 a[4:5], v240 offset:2048
    ds_read_b64_tr_b16 a[6:7], v240 offset:3072
    v_mfma_f32_32x32x16_bf16 v[144:159], a[12:15], v[220:223], v[144:159]
    ds_read_b64_tr_b16 a[8:9], v240 offset:4096
    ds_read_b64_tr_b16 a[10:11], v240 offset:5120
    buffer_load_dwordx4 v253, s[12:15], s46 offen offset:3072 lds
    s_waitcnt lgkmcnt(6)
    v_mfma_f32_32x32x16_bf16 v[144:159], a[16:19], v[224:227], v[144:159]
    ds_read_b64_tr_b16 a[12:13], v240 offset:6144
    ds_read_b64_tr_b16 a[14:15], v240 offset:7168
    v_mfma_f32_32x32x16_bf16 v[144:159], a[20:23], v[228:231], v[144:159]
    ds_read_b64_tr_b16 a[16:17], v240 offset:8192
    ds_read_b64_tr_b16 a[18:19], v240 offset:9216
    v_mfma_f32_32x32x16_bf16 v[144:159], a[24:27], v[232:235], v[144:159]
    ds_read_b64_tr_b16 a[20:21], v240 offset:10240
    ds_read_b64_tr_b16 a[22:23], v240 offset:11264
    s_add_u32 m0, s33, 98304
    s_add_u32 s46, s28, 640
    buffer_load_dwordx4 v250, s[12:15], s46 offen offset:0 lds
    v_mfma_f32_32x32x16_bf16 v[144:159], a[28:31], v[236:239], v[144:159]
    ds_read_b64_tr_b16 a[24:25], v240 offset:12288
    ds_read_b64_tr_b16 a[26:27], v240 offset:13312
    s_waitcnt lgkmcnt(6)
    v_mfma_f32_32x32x16_bf16 v[160:175], a[0:3], a[32:35], 0
    ds_read_b64_tr_b16 a[28:29], v240 offset:14336
    ds_read_b64_tr_b16 a[30:31], v240 offset:15360
    v_add_u32 v244, 49152, v244
    v_mfma_f32_32x32x16_bf16 v[160:175], a[4:7], a[36:39], v[160:175]
    ds_read_b64_tr_b16 a[0:1], v240 offset:16384
    ds_read_b64_tr_b16 a[2:3], v240 offset:17408
    buffer_load_dwordx4 v251, s[12:15], s46 offen offset:1024 lds
    v_mfma_f32_32x32x16_bf16 v[160:175], a[8:11], a[40:43], v[160:175]
    ds_read_b64_tr_b16 a[4:5], v240 offset:18432
    ds_read_b64_tr_b16 a[6:7], v240 offset:19456
    v_mfma_f32_32x32x16_bf16 v[160:175], a[12:15], a[44:47], v[160:175]
    ds_read_b64_tr_b16 a[8:9], v240 offset:20480
    ds_read_b64_tr_b16 a[10:11], v240 offset:21504
    v_cvt_pk_bf16_f32 v176, v144, v145
    v_cvt_pk_bf16_f32 v177, v146, v147
    v_cvt_pk_bf16_f32 v178, v148, v149
    s_waitcnt lgkmcnt(6)
    v_mfma_f32_32x32x16_bf16 v[160:175], a[16:19], a[48:51], v[160:175]
    ds_read_b64_tr_b16 a[12:13], v240 offset:22528
    ds_read_b64_tr_b16 a[14:15], v240 offset:23552
    s_add_u32 m0, s32, 122880
    s_add_u32 s46, s27, 221824
    buffer_load_dwordx4 v250, s[12:15], s46 offen offset:0 lds
    v_cvt_pk_bf16_f32 v179, v150, v151
    v_mfma_f32_32x32x16_bf16 v[160:175], a[20:23], a[52:55], v[160:175]
    ds_read_b64_tr_b16 a[16:17], v240 offset:24576
    ds_read_b64_tr_b16 a[18:19], v240 offset:25600
    v_cvt_pk_bf16_f32 v180, v152, v153
    v_cvt_pk_bf16_f32 v181, v154, v155
    v_cvt_pk_bf16_f32 v182, v156, v157
    v_cvt_pk_bf16_f32 v183, v158, v159
    v_mfma_f32_32x32x16_bf16 v[160:175], a[24:27], a[56:59], v[160:175]
    ds_read_b64_tr_b16 a[20:21], v240 offset:26624
    ds_read_b64_tr_b16 a[22:23], v240 offset:27648
    v_mfma_f32_32x32x16_bf16 v[160:175], a[28:31], a[60:63], v[160:175]
    ds_read_b64_tr_b16 a[24:25], v240 offset:28672
    ds_read_b64_tr_b16 a[26:27], v240 offset:29696
    s_add_u32 s48, s34, 147456
    buffer_store_dwordx4 v[176:179], v254, s[16:19], s48 offen offset:0 sc1
    s_waitcnt lgkmcnt(6)
    v_mfma_f32_32x32x16_bf16 v[160:175], a[0:3], a[64:67], v[160:175]
    ds_read_b64_tr_b16 a[28:29], v240 offset:30720
    ds_read_b64_tr_b16 a[30:31], v240 offset:31744
    v_mfma_f32_32x32x16_bf16 v[160:175], a[4:7], a[68:71], v[160:175]
    ds_read_b64_tr_b16 a[0:1], v240 offset:32768
    ds_read_b64_tr_b16 a[2:3], v240 offset:33792
    v_mfma_f32_32x32x16_bf16 v[160:175], a[8:11], v[184:187], v[160:175]
    ds_read_b64_tr_b16 a[4:5], v240 offset:34816
    ds_read_b64_tr_b16 a[6:7], v240 offset:35840
    buffer_store_dwordx4 v[180:183], v254, s[16:19], s48 offen offset:1024 sc1
    v_mfma_f32_32x32x16_bf16 v[160:175], a[12:15], v[188:191], v[160:175]
    ds_read_b64_tr_b16 a[8:9], v240 offset:36864
    ds_read_b64_tr_b16 a[10:11], v240 offset:37888
    s_waitcnt lgkmcnt(6)
    v_mfma_f32_32x32x16_bf16 v[160:175], a[16:19], v[192:195], v[160:175]
    ds_read_b64_tr_b16 a[12:13], v240 offset:38912
    ds_read_b64_tr_b16 a[14:15], v240 offset:39936
    v_mfma_f32_32x32x16_bf16 v[160:175], a[20:23], v[196:199], v[160:175]
    ds_read_b64_tr_b16 a[16:17], v240 offset:40960
    ds_read_b64_tr_b16 a[18:19], v240 offset:41984
    buffer_load_dwordx4 v251, s[12:15], s46 offen offset:1024 lds
    v_mfma_f32_32x32x16_bf16 v[160:175], a[24:27], v[200:203], v[160:175]
    ds_read_b64_tr_b16 a[20:21], v240 offset:43008
    ds_read_b64_tr_b16 a[22:23], v240 offset:44032
    v_mfma_f32_32x32x16_bf16 v[160:175], a[28:31], v[204:207], v[160:175]
    ds_read_b64_tr_b16 a[24:25], v240 offset:45056
    ds_read_b64_tr_b16 a[26:27], v240 offset:46080
    s_waitcnt lgkmcnt(6)
    v_mfma_f32_32x32x16_bf16 v[160:175], a[0:3], v[208:211], v[160:175]
    ds_read_b64_tr_b16 a[28:29], v240 offset:47104
    ds_read_b64_tr_b16 a[30:31], v240 offset:48128
    buffer_load_dwordx4 v252, s[12:15], s46 offen offset:2048 lds
    v_mfma_f32_32x32x16_bf16 v[160:175], a[4:7], v[212:215], v[160:175]
    s_waitcnt vmcnt(21)
    s_barrier
    ds_read_b64_tr_b16 a[0:1], v244 offset:0
    ds_read_b64_tr_b16 a[2:3], v244 offset:1024
    v_mfma_f32_32x32x16_bf16 v[160:175], a[8:11], v[216:219], v[160:175]
    ds_read_b64_tr_b16 a[4:5], v244 offset:2048
    ds_read_b64_tr_b16 a[6:7], v244 offset:3072
    v_mfma_f32_32x32x16_bf16 v[160:175], a[12:15], v[220:223], v[160:175]
    ds_read_b64_tr_b16 a[8:9], v244 offset:4096
    ds_read_b64_tr_b16 a[10:11], v244 offset:5120
    buffer_load_dwordx4 v253, s[12:15], s46 offen offset:3072 lds
    s_waitcnt lgkmcnt(6)
    v_mfma_f32_32x32x16_bf16 v[160:175], a[16:19], v[224:227], v[160:175]
    ds_read_b64_tr_b16 a[12:13], v244 offset:6144
    ds_read_b64_tr_b16 a[14:15], v244 offset:7168
    v_mfma_f32_32x32x16_bf16 v[160:175], a[20:23], v[228:231], v[160:175]
    ds_read_b64_tr_b16 a[16:17], v244 offset:8192
    ds_read_b64_tr_b16 a[18:19], v244 offset:9216
    v_mfma_f32_32x32x16_bf16 v[160:175], a[24:27], v[232:235], v[160:175]
    ds_read_b64_tr_b16 a[20:21], v244 offset:10240
    ds_read_b64_tr_b16 a[22:23], v244 offset:11264
    s_add_u32 m0, s33, 122880
    s_add_u32 s46, s28, 221824
    buffer_load_dwordx4 v250, s[12:15], s46 offen offset:0 lds
    v_mfma_f32_32x32x16_bf16 v[160:175], a[28:31], v[236:239], v[160:175]
    ds_read_b64_tr_b16 a[24:25], v244 offset:12288
    ds_read_b64_tr_b16 a[26:27], v244 offset:13312
    s_waitcnt lgkmcnt(6)
    v_mfma_f32_32x32x16_bf16 v[144:159], a[0:3], a[32:35], 0
    ds_read_b64_tr_b16 a[28:29], v244 offset:14336
    ds_read_b64_tr_b16 a[30:31], v244 offset:15360
    v_add_u32 v240, 49152, v240
    v_mfma_f32_32x32x16_bf16 v[144:159], a[4:7], a[36:39], v[144:159]
    ds_read_b64_tr_b16 a[0:1], v244 offset:16384
    ds_read_b64_tr_b16 a[2:3], v244 offset:17408
    buffer_load_dwordx4 v251, s[12:15], s46 offen offset:1024 lds
    v_mfma_f32_32x32x16_bf16 v[144:159], a[8:11], a[40:43], v[144:159]
    ds_read_b64_tr_b16 a[4:5], v244 offset:18432
    ds_read_b64_tr_b16 a[6:7], v244 offset:19456
    v_mfma_f32_32x32x16_bf16 v[144:159], a[12:15], a[44:47], v[144:159]
    ds_read_b64_tr_b16 a[8:9], v244 offset:20480
    ds_read_b64_tr_b16 a[10:11], v244 offset:21504
    v_cvt_pk_bf16_f32 v176, v160, v161
    v_cvt_pk_bf16_f32 v177, v162, v163
    v_cvt_pk_bf16_f32 v178, v164, v165
    s_waitcnt lgkmcnt(6)
    v_mfma_f32_32x32x16_bf16 v[144:159], a[16:19], a[48:51], v[144:159]
    ds_read_b64_tr_b16 a[12:13], v244 offset:22528
    ds_read_b64_tr_b16 a[14:15], v244 offset:23552
    s_add_u32 m0, s32, 0
    s_add_u32 s46, s27, 768
    buffer_load_dwordx4 v250, s[12:15], s46 offen offset:0 lds
    v_cvt_pk_bf16_f32 v179, v166, v167
    v_mfma_f32_32x32x16_bf16 v[144:159], a[20:23], a[52:55], v[144:159]
    s_waitcnt vmcnt(17)
    s_barrier
    ds_read_b64_tr_b16 a[16:17], v244 offset:24576
    ds_read_b64_tr_b16 a[18:19], v244 offset:25600
    v_cvt_pk_bf16_f32 v180, v168, v169
    v_cvt_pk_bf16_f32 v181, v170, v171
    v_mfma_f32_32x32x16_bf16 v[144:159], a[24:27], a[56:59], v[144:159]
    ds_read_b64_tr_b16 a[20:21], v244 offset:26624
    ds_read_b64_tr_b16 a[22:23], v244 offset:27648
    v_cvt_pk_bf16_f32 v182, v172, v173
    v_cvt_pk_bf16_f32 v183, v174, v175
    v_mfma_f32_32x32x16_bf16 v[144:159], a[28:31], a[60:63], v[144:159]
    ds_read_b64_tr_b16 a[24:25], v244 offset:28672
    ds_read_b64_tr_b16 a[26:27], v244 offset:29696
    s_add_u32 s48, s34, 172032
    buffer_store_dwordx4 v[176:179], v254, s[16:19], s48 offen offset:0 sc1
    s_waitcnt lgkmcnt(6)
    v_mfma_f32_32x32x16_bf16 v[144:159], a[0:3], a[64:67], v[144:159]
    ds_read_b64_tr_b16 a[28:29], v244 offset:30720
    ds_read_b64_tr_b16 a[30:31], v244 offset:31744
    v_mfma_f32_32x32x16_bf16 v[144:159], a[4:7], a[68:71], v[144:159]
    ds_read_b64_tr_b16 a[0:1], v244 offset:32768
    ds_read_b64_tr_b16 a[2:3], v244 offset:33792
    v_mfma_f32_32x32x16_bf16 v[144:159], a[8:11], v[184:187], v[144:159]
    ds_read_b64_tr_b16 a[4:5], v244 offset:34816
    ds_read_b64_tr_b16 a[6:7], v244 offset:35840
    buffer_store_dwordx4 v[180:183], v254, s[16:19], s48 offen offset:1024 sc1
    v_mfma_f32_32x32x16_bf16 v[144:159], a[12:15], v[188:191], v[144:159]
    ds_read_b64_tr_b16 a[8:9], v244 offset:36864
    ds_read_b64_tr_b16 a[10:11], v244 offset:37888
    s_waitcnt lgkmcnt(6)
    v_mfma_f32_32x32x16_bf16 v[144:159], a[16:19], v[192:195], v[144:159]
    ds_read_b64_tr_b16 a[12:13], v244 offset:38912
    ds_read_b64_tr_b16 a[14:15], v244 offset:39936
    v_mfma_f32_32x32x16_bf16 v[144:159], a[20:23], v[196:199], v[144:159]
    ds_read_b64_tr_b16 a[16:17], v244 offset:40960
    ds_read_b64_tr_b16 a[18:19], v244 offset:41984
    buffer_load_dwordx4 v251, s[12:15], s46 offen offset:1024 lds
    v_mfma_f32_32x32x16_bf16 v[144:159], a[24:27], v[200:203], v[144:159]
    ds_read_b64_tr_b16 a[20:21], v244 offset:43008
    ds_read_b64_tr_b16 a[22:23], v244 offset:44032
    v_mfma_f32_32x32x16_bf16 v[144:159], a[28:31], v[204:207], v[144:159]
    ds_read_b64_tr_b16 a[24:25], v244 offset:45056
    ds_read_b64_tr_b16 a[26:27], v244 offset:46080
    s_waitcnt lgkmcnt(6)
    v_mfma_f32_32x32x16_bf16 v[144:159], a[0:3], v[208:211], v[144:159]
    ds_read_b64_tr_b16 a[28:29], v244 offset:47104
    ds_read_b64_tr_b16 a[30:31], v244 offset:48128
    buffer_load_dwordx4 v252, s[12:15], s46 offen offset:2048 lds
    v_mfma_f32_32x32x16_bf16 v[144:159], a[4:7], v[212:215], v[144:159]
    ds_read_b64_tr_b16 a[0:1], v240 offset:0
    ds_read_b64_tr_b16 a[2:3], v240 offset:1024
    v_mfma_f32_32x32x16_bf16 v[144:159], a[8:11], v[216:219], v[144:159]
    ds_read_b64_tr_b16 a[4:5], v240 offset:2048
    ds_read_b64_tr_b16 a[6:7], v240 offset:3072
    v_mfma_f32_32x32x16_bf16 v[144:159], a[12:15], v[220:223], v[144:159]
    ds_read_b64_tr_b16 a[8:9], v240 offset:4096
    ds_read_b64_tr_b16 a[10:11], v240 offset:5120
    buffer_load_dwordx4 v253, s[12:15], s46 offen offset:3072 lds
    s_waitcnt lgkmcnt(6)
    v_mfma_f32_32x32x16_bf16 v[144:159], a[16:19], v[224:227], v[144:159]
    ds_read_b64_tr_b16 a[12:13], v240 offset:6144
    ds_read_b64_tr_b16 a[14:15], v240 offset:7168
    v_mfma_f32_32x32x16_bf16 v[144:159], a[20:23], v[228:231], v[144:159]
    ds_read_b64_tr_b16 a[16:17], v240 offset:8192
    ds_read_b64_tr_b16 a[18:19], v240 offset:9216
    v_mfma_f32_32x32x16_bf16 v[144:159], a[24:27], v[232:235], v[144:159]
    ds_read_b64_tr_b16 a[20:21], v240 offset:10240
    ds_read_b64_tr_b16 a[22:23], v240 offset:11264
    s_add_u32 m0, s33, 0
    s_add_u32 s46, s28, 768
    buffer_load_dwordx4 v250, s[12:15], s46 offen offset:0 lds
    v_mfma_f32_32x32x16_bf16 v[144:159], a[28:31], v[236:239], v[144:159]
    ds_read_b64_tr_b16 a[24:25], v240 offset:12288
    ds_read_b64_tr_b16 a[26:27], v240 offset:13312
    s_waitcnt lgkmcnt(6)
    v_mfma_f32_32x32x16_bf16 v[160:175], a[0:3], a[32:35], 0
    ds_read_b64_tr_b16 a[28:29], v240 offset:14336
    ds_read_b64_tr_b16 a[30:31], v240 offset:15360
    v_add_u32 v244, 49152, v244
    v_mfma_f32_32x32x16_bf16 v[160:175], a[4:7], a[36:39], v[160:175]
    ds_read_b64_tr_b16 a[0:1], v240 offset:16384
    ds_read_b64_tr_b16 a[2:3], v240 offset:17408
    buffer_load_dwordx4 v251, s[12:15], s46 offen offset:1024 lds
    v_mfma_f32_32x32x16_bf16 v[160:175], a[8:11], a[40:43], v[160:175]
    ds_read_b64_tr_b16 a[4:5], v240 offset:18432
    ds_read_b64_tr_b16 a[6:7], v240 offset:19456
    v_mfma_f32_32x32x16_bf16 v[160:175], a[12:15], a[44:47], v[160:175]
    ds_read_b64_tr_b16 a[8:9], v240 offset:20480
    ds_read_b64_tr_b16 a[10:11], v240 offset:21504
    v_cvt_pk_bf16_f32 v176, v144, v145
    v_cvt_pk_bf16_f32 v177, v146, v147
    v_cvt_pk_bf16_f32 v178, v148, v149
    s_waitcnt lgkmcnt(6)
    v_mfma_f32_32x32x16_bf16 v[160:175], a[16:19], a[48:51], v[160:175]
    ds_read_b64_tr_b16 a[12:13], v240 offset:22528
    ds_read_b64_tr_b16 a[14:15], v240 offset:23552
    s_add_u32 m0, s32, 24576
    s_add_u32 s46, s27, 221952
    buffer_load_dwordx4 v250, s[12:15], s46 offen offset:0 lds
    v_cvt_pk_bf16_f32 v179, v150, v151
    v_mfma_f32_32x32x16_bf16 v[160:175], a[20:23], a[52:55], v[160:175]
    ds_read_b64_tr_b16 a[16:17], v240 offset:24576
    ds_read_b64_tr_b16 a[18:19], v240 offset:25600
    v_cvt_pk_bf16_f32 v180, v152, v153
    v_cvt_pk_bf16_f32 v181, v154, v155
    v_cvt_pk_bf16_f32 v182, v156, v157
    v_cvt_pk_bf16_f32 v183, v158, v159
    v_mfma_f32_32x32x16_bf16 v[160:175], a[24:27], a[56:59], v[160:175]
    ds_read_b64_tr_b16 a[20:21], v240 offset:26624
    ds_read_b64_tr_b16 a[22:23], v240 offset:27648
    v_mfma_f32_32x32x16_bf16 v[160:175], a[28:31], a[60:63], v[160:175]
    ds_read_b64_tr_b16 a[24:25], v240 offset:28672
    ds_read_b64_tr_b16 a[26:27], v240 offset:29696
    s_add_u32 s48, s34, 196608
    buffer_store_dwordx4 v[176:179], v254, s[16:19], s48 offen offset:0 sc1
    s_waitcnt lgkmcnt(6)
    v_mfma_f32_32x32x16_bf16 v[160:175], a[0:3], a[64:67], v[160:175]
    ds_read_b64_tr_b16 a[28:29], v240 offset:30720
    ds_read_b64_tr_b16 a[30:31], v240 offset:31744
    v_mfma_f32_32x32x16_bf16 v[160:175], a[4:7], a[68:71], v[160:175]
    ds_read_b64_tr_b16 a[0:1], v240 offset:32768
    ds_read_b64_tr_b16 a[2:3], v240 offset:33792
    v_mfma_f32_32x32x16_bf16 v[160:175], a[8:11], v[184:187], v[160:175]
    ds_read_b64_tr_b16 a[4:5], v240 offset:34816
    ds_read_b64_tr_b16 a[6:7], v240 offset:35840
    buffer_store_dwordx4 v[180:183], v254, s[16:19], s48 offen offset:1024 sc1
    v_mfma_f32_32x32x16_bf16 v[160:175], a[12:15], v[188:191], v[160:175]
    ds_read_b64_tr_b16 a[8:9], v240 offset:36864
    ds_read_b64_tr_b16 a[10:11], v240 offset:37888
    s_waitcnt lgkmcnt(6)
    v_mfma_f32_32x32x16_bf16 v[160:175], a[16:19], v[192:195], v[160:175]
    ds_read_b64_tr_b16 a[12:13], v240 offset:38912
    ds_read_b64_tr_b16 a[14:15], v240 offset:39936
    v_mfma_f32_32x32x16_bf16 v[160:175], a[20:23], v[196:199], v[160:175]
    ds_read_b64_tr_b16 a[16:17], v240 offset:40960
    ds_read_b64_tr_b16 a[18:19], v240 offset:41984
    buffer_load_dwordx4 v251, s[12:15], s46 offen offset:1024 lds
    v_mfma_f32_32x32x16_bf16 v[160:175], a[24:27], v[200:203], v[160:175]
    ds_read_b64_tr_b16 a[20:21], v240 offset:43008
    ds_read_b64_tr_b16 a[22:23], v240 offset:44032
    v_mfma_f32_32x32x16_bf16 v[160:175], a[28:31], v[204:207], v[160:175]
    ds_read_b64_tr_b16 a[24:25], v240 offset:45056
    ds_read_b64_tr_b16 a[26:27], v240 offset:46080
    s_waitcnt lgkmcnt(6)
    v_mfma_f32_32x32x16_bf16 v[160:175], a[0:3], v[208:211], v[160:175]
    ds_read_b64_tr_b16 a[28:29], v240 offset:47104
    ds_read_b64_tr_b16 a[30:31], v240 offset:48128
    buffer_load_dwordx4 v252, s[12:15], s46 offen offset:2048 lds
    v_mfma_f32_32x32x16_bf16 v[160:175], a[4:7], v[212:215], v[160:175]
    s_waitcnt vmcnt(21)
    s_barrier
    ds_read_b64_tr_b16 a[0:1], v244 offset:0
    ds_read_b64_tr_b16 a[2:3], v244 offset:1024
    s_mul_i32 s36, s20, 36
    v_mfma_f32_32x32x16_bf16 v[160:175], a[8:11], v[216:219], v[160:175]
    ds_read_b64_tr_b16 a[4:5], v244 offset:2048
    ds_read_b64_tr_b16 a[6:7], v244 offset:3072
    s_add_u32 s36, s36, s21
    s_lshl_b32 s36, s36, 7
    s_add_u32 s36, s36, 33619968
    v_mfma_f32_32x32x16_bf16 v[160:175], a[12:15], v[220:223], v[160:175]
    ds_read_b64_tr_b16 a[8:9], v244 offset:4096
    ds_read_b64_tr_b16 a[10:11], v244 offset:5120
    buffer_load_dwordx4 v253, s[12:15], s46 offen offset:3072 lds
    s_waitcnt lgkmcnt(6)
    v_mfma_f32_32x32x16_bf16 v[160:175], a[16:19], v[224:227], v[160:175]
    ds_read_b64_tr_b16 a[12:13], v244 offset:6144
    ds_read_b64_tr_b16 a[14:15], v244 offset:7168
    s_mov_b64 exec, 1
    buffer_store_dword v255, off, s[16:19], s36 sc1
    s_mov_b64 exec, -1
    v_mfma_f32_32x32x16_bf16 v[160:175], a[20:23], v[228:231], v[160:175]
    ds_read_b64_tr_b16 a[16:17], v244 offset:8192
    ds_read_b64_tr_b16 a[18:19], v244 offset:9216
    v_mfma_f32_32x32x16_bf16 v[160:175], a[24:27], v[232:235], v[160:175]
    ds_read_b64_tr_b16 a[20:21], v244 offset:10240
    ds_read_b64_tr_b16 a[22:23], v244 offset:11264
    s_add_u32 m0, s33, 24576
    s_add_u32 s46, s28, 221952
    buffer_load_dwordx4 v250, s[12:15], s46 offen offset:0 lds
    v_mfma_f32_32x32x16_bf16 v[160:175], a[28:31], v[236:239], v[160:175]
    ds_read_b64_tr_b16 a[24:25], v244 offset:12288
    ds_read_b64_tr_b16 a[26:27], v244 offset:13312
    s_waitcnt lgkmcnt(6)
    v_mfma_f32_32x32x16_bf16 v[144:159], a[0:3], a[32:35], 0
    ds_read_b64_tr_b16 a[28:29], v244 offset:14336
    ds_read_b64_tr_b16 a[30:31], v244 offset:15360
    v_add_u32 v240, 49152, v240
    v_mfma_f32_32x32x16_bf16 v[144:159], a[4:7], a[36:39], v[144:159]
    ds_read_b64_tr_b16 a[0:1], v244 offset:16384
    ds_read_b64_tr_b16 a[2:3], v244 offset:17408
    buffer_load_dwordx4 v251, s[12:15], s46 offen offset:1024 lds
    v_mfma_f32_32x32x16_bf16 v[144:159], a[8:11], a[40:43], v[144:159]
    ds_read_b64_tr_b16 a[4:5], v244 offset:18432
    ds_read_b64_tr_b16 a[6:7], v244 offset:19456
    v_mfma_f32_32x32x16_bf16 v[144:159], a[12:15], a[44:47], v[144:159]
    ds_read_b64_tr_b16 a[8:9], v244 offset:20480
    ds_read_b64_tr_b16 a[10:11], v244 offset:21504
    v_cvt_pk_bf16_f32 v176, v160, v161
    v_cvt_pk_bf16_f32 v177, v162, v163
    v_cvt_pk_bf16_f32 v178, v164, v165
    s_waitcnt lgkmcnt(6)
    v_mfma_f32_32x32x16_bf16 v[144:159], a[16:19], a[48:51], v[144:159]
    ds_read_b64_tr_b16 a[12:13], v244 offset:22528
    ds_read_b64_tr_b16 a[14:15], v244 offset:23552
    s_add_u32 m0, s32, 49152
    s_add_u32 s46, s27, 896
    buffer_load_dwordx4 v250, s[12:15], s46 offen offset:0 lds
    v_cvt_pk_bf16_f32 v179, v166, v167
    v_mfma_f32_32x32x16_bf16 v[144:159], a[20:23], a[52:55], v[144:159]
    s_waitcnt vmcnt(18)
    s_barrier
    ds_read_b64_tr_b16 a[16:17], v244 offset:24576
    ds_read_b64_tr_b16 a[18:19], v244 offset:25600
    v_cvt_pk_bf16_f32 v180, v168, v169
    v_cvt_pk_bf16_f32 v181, v170, v171
    v_mfma_f32_32x32x16_bf16 v[144:159], a[24:27], a[56:59], v[144:159]
    ds_read_b64_tr_b16 a[20:21], v244 offset:26624
    ds_read_b64_tr_b16 a[22:23], v244 offset:27648
    v_cvt_pk_bf16_f32 v182, v172, v173
    v_cvt_pk_bf16_f32 v183, v174, v175
    v_mfma_f32_32x32x16_bf16 v[144:159], a[28:31], a[60:63], v[144:159]
    ds_read_b64_tr_b16 a[24:25], v244 offset:28672
    ds_read_b64_tr_b16 a[26:27], v244 offset:29696
    s_add_u32 s48, s34, 221184
    buffer_store_dwordx4 v[176:179], v254, s[16:19], s48 offen offset:0 sc1
    s_waitcnt lgkmcnt(6)
    v_mfma_f32_32x32x16_bf16 v[144:159], a[0:3], a[64:67], v[144:159]
    ds_read_b64_tr_b16 a[28:29], v244 offset:30720
    ds_read_b64_tr_b16 a[30:31], v244 offset:31744
    v_mfma_f32_32x32x16_bf16 v[144:159], a[4:7], a[68:71], v[144:159]
    ds_read_b64_tr_b16 a[0:1], v244 offset:32768
    ds_read_b64_tr_b16 a[2:3], v244 offset:33792
    v_mfma_f32_32x32x16_bf16 v[144:159], a[8:11], v[184:187], v[144:159]
    ds_read_b64_tr_b16 a[4:5], v244 offset:34816
    ds_read_b64_tr_b16 a[6:7], v244 offset:35840
    buffer_store_dwordx4 v[180:183], v254, s[16:19], s48 offen offset:1024 sc1
    v_mfma_f32_32x32x16_bf16 v[144:159], a[12:15], v[188:191], v[144:159]
    ds_read_b64_tr_b16 a[8:9], v244 offset:36864
    ds_read_b64_tr_b16 a[10:11], v244 offset:37888
    s_waitcnt lgkmcnt(6)
    v_mfma_f32_32x32x16_bf16 v[144:159], a[16:19], v[192:195], v[144:159]
    ds_read_b64_tr_b16 a[12:13], v244 offset:38912
    ds_read_b64_tr_b16 a[14:15], v244 offset:39936
    v_mfma_f32_32x32x16_bf16 v[144:159], a[20:23], v[196:199], v[144:159]
    ds_read_b64_tr_b16 a[16:17], v244 offset:40960
    ds_read_b64_tr_b16 a[18:19], v244 offset:41984
    buffer_load_dwordx4 v251, s[12:15], s46 offen offset:1024 lds
    v_mfma_f32_32x32x16_bf16 v[144:159], a[24:27], v[200:203], v[144:159]
    ds_read_b64_tr_b16 a[20:21], v244 offset:43008
    ds_read_b64_tr_b16 a[22:23], v244 offset:44032
    v_mfma_f32_32x32x16_bf16 v[144:159], a[28:31], v[204:207], v[144:159]
    ds_read_b64_tr_b16 a[24:25], v244 offset:45056
    ds_read_b64_tr_b16 a[26:27], v244 offset:46080
    s_waitcnt lgkmcnt(6)
    v_mfma_f32_32x32x16_bf16 v[144:159], a[0:3], v[208:211], v[144:159]
    ds_read_b64_tr_b16 a[28:29], v244 offset:47104
    ds_read_b64_tr_b16 a[30:31], v244 offset:48128
    buffer_load_dwordx4 v252, s[12:15], s46 offen offset:2048 lds
    v_mfma_f32_32x32x16_bf16 v[144:159], a[4:7], v[212:215], v[144:159]
    ds_read_b64_tr_b16 a[0:1], v240 offset:0
    ds_read_b64_tr_b16 a[2:3], v240 offset:1024
    v_mfma_f32_32x32x16_bf16 v[144:159], a[8:11], v[216:219], v[144:159]
    ds_read_b64_tr_b16 a[4:5], v240 offset:2048
    ds_read_b64_tr_b16 a[6:7], v240 offset:3072
    v_mfma_f32_32x32x16_bf16 v[144:159], a[12:15], v[220:223], v[144:159]
    ds_read_b64_tr_b16 a[8:9], v240 offset:4096
    ds_read_b64_tr_b16 a[10:11], v240 offset:5120
    buffer_load_dwordx4 v253, s[12:15], s46 offen offset:3072 lds
    s_waitcnt lgkmcnt(6)
    v_mfma_f32_32x32x16_bf16 v[144:159], a[16:19], v[224:227], v[144:159]
    ds_read_b64_tr_b16 a[12:13], v240 offset:6144
    ds_read_b64_tr_b16 a[14:15], v240 offset:7168
    v_mfma_f32_32x32x16_bf16 v[144:159], a[20:23], v[228:231], v[144:159]
    ds_read_b64_tr_b16 a[16:17], v240 offset:8192
    ds_read_b64_tr_b16 a[18:19], v240 offset:9216
    v_mfma_f32_32x32x16_bf16 v[144:159], a[24:27], v[232:235], v[144:159]
    ds_read_b64_tr_b16 a[20:21], v240 offset:10240
    ds_read_b64_tr_b16 a[22:23], v240 offset:11264
    s_add_u32 m0, s33, 49152
    s_add_u32 s46, s28, 896
    buffer_load_dwordx4 v250, s[12:15], s46 offen offset:0 lds
    v_mfma_f32_32x32x16_bf16 v[144:159], a[28:31], v[236:239], v[144:159]
    ds_read_b64_tr_b16 a[24:25], v240 offset:12288
    ds_read_b64_tr_b16 a[26:27], v240 offset:13312
    s_waitcnt lgkmcnt(6)
    v_mfma_f32_32x32x16_bf16 v[160:175], a[0:3], a[32:35], 0
    ds_read_b64_tr_b16 a[28:29], v240 offset:14336
    ds_read_b64_tr_b16 a[30:31], v240 offset:15360
    v_subrev_u32 v244, 98304, v244
    v_mfma_f32_32x32x16_bf16 v[160:175], a[4:7], a[36:39], v[160:175]
    ds_read_b64_tr_b16 a[0:1], v240 offset:16384
    ds_read_b64_tr_b16 a[2:3], v240 offset:17408
    buffer_load_dwordx4 v251, s[12:15], s46 offen offset:1024 lds
    v_mfma_f32_32x32x16_bf16 v[160:175], a[8:11], a[40:43], v[160:175]
    ds_read_b64_tr_b16 a[4:5], v240 offset:18432
    ds_read_b64_tr_b16 a[6:7], v240 offset:19456
    v_mfma_f32_32x32x16_bf16 v[160:175], a[12:15], a[44:47], v[160:175]
    ds_read_b64_tr_b16 a[8:9], v240 offset:20480
    ds_read_b64_tr_b16 a[10:11], v240 offset:21504
    v_cvt_pk_bf16_f32 v176, v144, v145
    v_cvt_pk_bf16_f32 v177, v146, v147
    v_cvt_pk_bf16_f32 v178, v148, v149
    s_waitcnt lgkmcnt(6)
    v_mfma_f32_32x32x16_bf16 v[160:175], a[16:19], a[48:51], v[160:175]
    ds_read_b64_tr_b16 a[12:13], v240 offset:22528
    ds_read_b64_tr_b16 a[14:15], v240 offset:23552
    s_add_u32 m0, s32, 73728
    s_add_u32 s46, s27, 222080
    buffer_load_dwordx4 v250, s[12:15], s46 offen offset:0 lds
    v_cvt_pk_bf16_f32 v179, v150, v151
    v_mfma_f32_32x32x16_bf16 v[160:175], a[20:23], a[52:55], v[160:175]
    ds_read_b64_tr_b16 a[16:17], v240 offset:24576
    ds_read_b64_tr_b16 a[18:19], v240 offset:25600
    v_cvt_pk_bf16_f32 v180, v152, v153
    v_cvt_pk_bf16_f32 v181, v154, v155
    v_cvt_pk_bf16_f32 v182, v156, v157
    v_cvt_pk_bf16_f32 v183, v158, v159
    v_mfma_f32_32x32x16_bf16 v[160:175], a[24:27], a[56:59], v[160:175]
    ds_read_b64_tr_b16 a[20:21], v240 offset:26624
    ds_read_b64_tr_b16 a[22:23], v240 offset:27648
    v_mfma_f32_32x32x16_bf16 v[160:175], a[28:31], a[60:63], v[160:175]
    ds_read_b64_tr_b16 a[24:25], v240 offset:28672
    ds_read_b64_tr_b16 a[26:27], v240 offset:29696
    s_add_u32 s48, s34, 245760
    buffer_store_dwordx4 v[176:179], v254, s[16:19], s48 offen offset:0 sc1
    s_waitcnt lgkmcnt(6)
    v_mfma_f32_32x32x16_bf16 v[160:175], a[0:3], a[64:67], v[160:175]
    ds_read_b64_tr_b16 a[28:29], v240 offset:30720
    ds_read_b64_tr_b16 a[30:31], v240 offset:31744
    v_mfma_f32_32x32x16_bf16 v[160:175], a[4:7], a[68:71], v[160:175]
    ds_read_b64_tr_b16 a[0:1], v240 offset:32768
    ds_read_b64_tr_b16 a[2:3], v240 offset:33792
    v_mfma_f32_32x32x16_bf16 v[160:175], a[8:11], v[184:187], v[160:175]
    ds_read_b64_tr_b16 a[4:5], v240 offset:34816
    ds_read_b64_tr_b16 a[6:7], v240 offset:35840
    buffer_store_dwordx4 v[180:183], v254, s[16:19], s48 offen offset:1024 sc1
    v_mfma_f32_32x32x16_bf16 v[160:175], a[12:15], v[188:191], v[160:175]
    ds_read_b64_tr_b16 a[8:9], v240 offset:36864
    ds_read_b64_tr_b16 a[10:11], v240 offset:37888
    s_waitcnt lgkmcnt(6)
    v_mfma_f32_32x32x16_bf16 v[160:175], a[16:19], v[192:195], v[160:175]
    ds_read_b64_tr_b16 a[12:13], v240 offset:38912
    ds_read_b64_tr_b16 a[14:15], v240 offset:39936
    v_mfma_f32_32x32x16_bf16 v[160:175], a[20:23], v[196:199], v[160:175]
    ds_read_b64_tr_b16 a[16:17], v240 offset:40960
    ds_read_b64_tr_b16 a[18:19], v240 offset:41984
    buffer_load_dwordx4 v251, s[12:15], s46 offen offset:1024 lds
    v_mfma_f32_32x32x16_bf16 v[160:175], a[24:27], v[200:203], v[160:175]
    ds_read_b64_tr_b16 a[20:21], v240 offset:43008
    ds_read_b64_tr_b16 a[22:23], v240 offset:44032
    v_mfma_f32_32x32x16_bf16 v[160:175], a[28:31], v[204:207], v[160:175]
    ds_read_b64_tr_b16 a[24:25], v240 offset:45056
    ds_read_b64_tr_b16 a[26:27], v240 offset:46080
    s_waitcnt lgkmcnt(6)
    v_mfma_f32_32x32x16_bf16 v[160:175], a[0:3], v[208:211], v[160:175]
    ds_read_b64_tr_b16 a[28:29], v240 offset:47104
    ds_read_b64_tr_b16 a[30:31], v240 offset:48128
    buffer_load_dwordx4 v252, s[12:15], s46 offen offset:2048 lds
    v_mfma_f32_32x32x16_bf16 v[160:175], a[4:7], v[212:215], v[160:175]
    s_waitcnt vmcnt(22)
    s_barrier
    ds_read_b64_tr_b16 a[0:1], v244 offset:0
    ds_read_b64_tr_b16 a[2:3], v244 offset:1024
    v_mfma_f32_32x32x16_bf16 v[160:175], a[8:11], v[216:219], v[160:175]
    ds_read_b64_tr_b16 a[4:5], v244 offset:2048
    ds_read_b64_tr_b16 a[6:7], v244 offset:3072
    v_mfma_f32_32x32x16_bf16 v[160:175], a[12:15], v[220:223], v[160:175]
    ds_read_b64_tr_b16 a[8:9], v244 offset:4096
    ds_read_b64_tr_b16 a[10:11], v244 offset:5120
    buffer_load_dwordx4 v253, s[12:15], s46 offen offset:3072 lds
    s_waitcnt lgkmcnt(6)
    v_mfma_f32_32x32x16_bf16 v[160:175], a[16:19], v[224:227], v[160:175]
    ds_read_b64_tr_b16 a[12:13], v244 offset:6144
    ds_read_b64_tr_b16 a[14:15], v244 offset:7168
    v_mfma_f32_32x32x16_bf16 v[160:175], a[20:23], v[228:231], v[160:175]
    ds_read_b64_tr_b16 a[16:17], v244 offset:8192
    ds_read_b64_tr_b16 a[18:19], v244 offset:9216
    v_mfma_f32_32x32x16_bf16 v[160:175], a[24:27], v[232:235], v[160:175]
    ds_read_b64_tr_b16 a[20:21], v244 offset:10240
    ds_read_b64_tr_b16 a[22:23], v244 offset:11264
    s_add_u32 m0, s33, 73728
    s_add_u32 s46, s28, 222080
    buffer_load_dwordx4 v250, s[12:15], s46 offen offset:0 lds
    v_mfma_f32_32x32x16_bf16 v[160:175], a[28:31], v[236:239], v[160:175]
    ds_read_b64_tr_b16 a[24:25], v244 offset:12288
    ds_read_b64_tr_b16 a[26:27], v244 offset:13312
    s_waitcnt lgkmcnt(6)
    v_mfma_f32_32x32x16_bf16 v[144:159], a[0:3], a[32:35], 0
    ds_read_b64_tr_b16 a[28:29], v244 offset:14336
    ds_read_b64_tr_b16 a[30:31], v244 offset:15360
    v_subrev_u32 v240, 98304, v240
    v_mfma_f32_32x32x16_bf16 v[144:159], a[4:7], a[36:39], v[144:159]
    ds_read_b64_tr_b16 a[0:1], v244 offset:16384
    ds_read_b64_tr_b16 a[2:3], v244 offset:17408
    buffer_load_dwordx4 v251, s[12:15], s46 offen offset:1024 lds
    v_mfma_f32_32x32x16_bf16 v[144:159], a[8:11], a[40:43], v[144:159]
    ds_read_b64_tr_b16 a[4:5], v244 offset:18432
    ds_read_b64_tr_b16 a[6:7], v244 offset:19456
    v_mfma_f32_32x32x16_bf16 v[144:159], a[12:15], a[44:47], v[144:159]
    ds_read_b64_tr_b16 a[8:9], v244 offset:20480
    ds_read_b64_tr_b16 a[10:11], v244 offset:21504
    v_cvt_pk_bf16_f32 v176, v160, v161
    v_cvt_pk_bf16_f32 v177, v162, v163
    v_cvt_pk_bf16_f32 v178, v164, v165
    s_waitcnt lgkmcnt(6)
    v_mfma_f32_32x32x16_bf16 v[144:159], a[16:19], a[48:51], v[144:159]
    ds_read_b64_tr_b16 a[12:13], v244 offset:22528
    ds_read_b64_tr_b16 a[14:15], v244 offset:23552
    s_add_u32 m0, s32, 98304
    s_add_u32 s46, s27, 1024
    buffer_load_dwordx4 v250, s[12:15], s46 offen offset:0 lds
    v_cvt_pk_bf16_f32 v179, v166, v167
    v_mfma_f32_32x32x16_bf16 v[144:159], a[20:23], a[52:55], v[144:159]
    s_waitcnt vmcnt(17)
    s_barrier
    ds_read_b64_tr_b16 a[16:17], v244 offset:24576
    ds_read_b64_tr_b16 a[18:19], v244 offset:25600
    v_cvt_pk_bf16_f32 v180, v168, v169
    v_cvt_pk_bf16_f32 v181, v170, v171
    v_mfma_f32_32x32x16_bf16 v[144:159], a[24:27], a[56:59], v[144:159]
    ds_read_b64_tr_b16 a[20:21], v244 offset:26624
    ds_read_b64_tr_b16 a[22:23], v244 offset:27648
    v_cvt_pk_bf16_f32 v182, v172, v173
    v_cvt_pk_bf16_f32 v183, v174, v175
    v_mfma_f32_32x32x16_bf16 v[144:159], a[28:31], a[60:63], v[144:159]
    ds_read_b64_tr_b16 a[24:25], v244 offset:28672
    ds_read_b64_tr_b16 a[26:27], v244 offset:29696
    s_add_u32 s48, s34, 270336
    buffer_store_dwordx4 v[176:179], v254, s[16:19], s48 offen offset:0 sc1
    s_waitcnt lgkmcnt(6)
    v_mfma_f32_32x32x16_bf16 v[144:159], a[0:3], a[64:67], v[144:159]
    ds_read_b64_tr_b16 a[28:29], v244 offset:30720
    ds_read_b64_tr_b16 a[30:31], v244 offset:31744
    v_mfma_f32_32x32x16_bf16 v[144:159], a[4:7], a[68:71], v[144:159]
    ds_read_b64_tr_b16 a[0:1], v244 offset:32768
    ds_read_b64_tr_b16 a[2:3], v244 offset:33792
    v_mfma_f32_32x32x16_bf16 v[144:159], a[8:11], v[184:187], v[144:159]
    ds_read_b64_tr_b16 a[4:5], v244 offset:34816
    ds_read_b64_tr_b16 a[6:7], v244 offset:35840
    buffer_store_dwordx4 v[180:183], v254, s[16:19], s48 offen offset:1024 sc1
    v_mfma_f32_32x32x16_bf16 v[144:159], a[12:15], v[188:191], v[144:159]
    ds_read_b64_tr_b16 a[8:9], v244 offset:36864
    ds_read_b64_tr_b16 a[10:11], v244 offset:37888
    s_waitcnt lgkmcnt(6)
    v_mfma_f32_32x32x16_bf16 v[144:159], a[16:19], v[192:195], v[144:159]
    ds_read_b64_tr_b16 a[12:13], v244 offset:38912
    ds_read_b64_tr_b16 a[14:15], v244 offset:39936
    v_mfma_f32_32x32x16_bf16 v[144:159], a[20:23], v[196:199], v[144:159]
    ds_read_b64_tr_b16 a[16:17], v244 offset:40960
    ds_read_b64_tr_b16 a[18:19], v244 offset:41984
    buffer_load_dwordx4 v251, s[12:15], s46 offen offset:1024 lds
    v_mfma_f32_32x32x16_bf16 v[144:159], a[24:27], v[200:203], v[144:159]
    ds_read_b64_tr_b16 a[20:21], v244 offset:43008
    ds_read_b64_tr_b16 a[22:23], v244 offset:44032
    v_mfma_f32_32x32x16_bf16 v[144:159], a[28:31], v[204:207], v[144:159]
    ds_read_b64_tr_b16 a[24:25], v244 offset:45056
    ds_read_b64_tr_b16 a[26:27], v244 offset:46080
    s_waitcnt lgkmcnt(6)
    v_mfma_f32_32x32x16_bf16 v[144:159], a[0:3], v[208:211], v[144:159]
    ds_read_b64_tr_b16 a[28:29], v244 offset:47104
    ds_read_b64_tr_b16 a[30:31], v244 offset:48128
    buffer_load_dwordx4 v252, s[12:15], s46 offen offset:2048 lds
    v_mfma_f32_32x32x16_bf16 v[144:159], a[4:7], v[212:215], v[144:159]
    ds_read_b64_tr_b16 a[0:1], v240 offset:0
    ds_read_b64_tr_b16 a[2:3], v240 offset:1024
    v_mfma_f32_32x32x16_bf16 v[144:159], a[8:11], v[216:219], v[144:159]
    ds_read_b64_tr_b16 a[4:5], v240 offset:2048
    ds_read_b64_tr_b16 a[6:7], v240 offset:3072
    v_mfma_f32_32x32x16_bf16 v[144:159], a[12:15], v[220:223], v[144:159]
    ds_read_b64_tr_b16 a[8:9], v240 offset:4096
    ds_read_b64_tr_b16 a[10:11], v240 offset:5120
    buffer_load_dwordx4 v253, s[12:15], s46 offen offset:3072 lds
    s_waitcnt lgkmcnt(6)
    v_mfma_f32_32x32x16_bf16 v[144:159], a[16:19], v[224:227], v[144:159]
    ds_read_b64_tr_b16 a[12:13], v240 offset:6144
    ds_read_b64_tr_b16 a[14:15], v240 offset:7168
    v_mfma_f32_32x32x16_bf16 v[144:159], a[20:23], v[228:231], v[144:159]
    ds_read_b64_tr_b16 a[16:17], v240 offset:8192
    ds_read_b64_tr_b16 a[18:19], v240 offset:9216
    v_mfma_f32_32x32x16_bf16 v[144:159], a[24:27], v[232:235], v[144:159]
    ds_read_b64_tr_b16 a[20:21], v240 offset:10240
    ds_read_b64_tr_b16 a[22:23], v240 offset:11264
    s_add_u32 m0, s33, 98304
    s_add_u32 s46, s28, 1024
    buffer_load_dwordx4 v250, s[12:15], s46 offen offset:0 lds
    v_mfma_f32_32x32x16_bf16 v[144:159], a[28:31], v[236:239], v[144:159]
    ds_read_b64_tr_b16 a[24:25], v240 offset:12288
    ds_read_b64_tr_b16 a[26:27], v240 offset:13312
    s_waitcnt lgkmcnt(6)
    v_mfma_f32_32x32x16_bf16 v[160:175], a[0:3], a[32:35], 0
    ds_read_b64_tr_b16 a[28:29], v240 offset:14336
    ds_read_b64_tr_b16 a[30:31], v240 offset:15360
    v_add_u32 v244, 49152, v244
    v_mfma_f32_32x32x16_bf16 v[160:175], a[4:7], a[36:39], v[160:175]
    ds_read_b64_tr_b16 a[0:1], v240 offset:16384
    ds_read_b64_tr_b16 a[2:3], v240 offset:17408
    buffer_load_dwordx4 v251, s[12:15], s46 offen offset:1024 lds
    s_mov_b32 exec_lo, 0xfff
    s_mov_b32 exec_hi, 0
    buffer_load_dword v141, v143, s[16:19], 0 offen sc1
    s_mov_b64 exec, -1
    v_mfma_f32_32x32x16_bf16 v[160:175], a[8:11], a[40:43], v[160:175]
    ds_read_b64_tr_b16 a[4:5], v240 offset:18432
    ds_read_b64_tr_b16 a[6:7], v240 offset:19456
    v_mfma_f32_32x32x16_bf16 v[160:175], a[12:15], a[44:47], v[160:175]
    ds_read_b64_tr_b16 a[8:9], v240 offset:20480
    ds_read_b64_tr_b16 a[10:11], v240 offset:21504
    v_cvt_pk_bf16_f32 v176, v144, v145
    v_cvt_pk_bf16_f32 v177, v146, v147
    v_cvt_pk_bf16_f32 v178, v148, v149
    s_waitcnt lgkmcnt(6)
    v_mfma_f32_32x32x16_bf16 v[160:175], a[16:19], a[48:51], v[160:175]
    ds_read_b64_tr_b16 a[12:13], v240 offset:22528
    ds_read_b64_tr_b16 a[14:15], v240 offset:23552
    s_add_u32 m0, s32, 122880
    s_add_u32 s46, s27, 222208
    buffer_load_dwordx4 v250, s[12:15], s46 offen offset:0 lds
    v_cvt_pk_bf16_f32 v179, v150, v151
    v_mfma_f32_32x32x16_bf16 v[160:175], a[20:23], a[52:55], v[160:175]
    ds_read_b64_tr_b16 a[16:17], v240 offset:24576
    ds_read_b64_tr_b16 a[18:19], v240 offset:25600
    v_cvt_pk_bf16_f32 v180, v152, v153
    v_cvt_pk_bf16_f32 v181, v154, v155
    v_cvt_pk_bf16_f32 v182, v156, v157
    v_cvt_pk_bf16_f32 v183, v158, v159
    v_mfma_f32_32x32x16_bf16 v[160:175], a[24:27], a[56:59], v[160:175]
    ds_read_b64_tr_b16 a[20:21], v240 offset:26624
    ds_read_b64_tr_b16 a[22:23], v240 offset:27648
    v_mfma_f32_32x32x16_bf16 v[160:175], a[28:31], a[60:63], v[160:175]
    ds_read_b64_tr_b16 a[24:25], v240 offset:28672
    ds_read_b64_tr_b16 a[26:27], v240 offset:29696
    s_add_u32 s48, s34, 294912
    buffer_store_dwordx4 v[176:179], v254, s[16:19], s48 offen offset:0 sc1
    s_waitcnt lgkmcnt(6)
    v_mfma_f32_32x32x16_bf16 v[160:175], a[0:3], a[64:67], v[160:175]
    ds_read_b64_tr_b16 a[28:29], v240 offset:30720
    ds_read_b64_tr_b16 a[30:31], v240 offset:31744
    v_mfma_f32_32x32x16_bf16 v[160:175], a[4:7], a[68:71], v[160:175]
    ds_read_b64_tr_b16 a[0:1], v240 offset:32768
    ds_read_b64_tr_b16 a[2:3], v240 offset:33792
    v_mfma_f32_32x32x16_bf16 v[160:175], a[8:11], v[184:187], v[160:175]
    ds_read_b64_tr_b16 a[4:5], v240 offset:34816
    ds_read_b64_tr_b16 a[6:7], v240 offset:35840
    buffer_store_dwordx4 v[180:183], v254, s[16:19], s48 offen offset:1024 sc1
    v_mfma_f32_32x32x16_bf16 v[160:175], a[12:15], v[188:191], v[160:175]
    ds_read_b64_tr_b16 a[8:9], v240 offset:36864
    ds_read_b64_tr_b16 a[10:11], v240 offset:37888
    s_waitcnt lgkmcnt(6)
    v_mfma_f32_32x32x16_bf16 v[160:175], a[16:19], v[192:195], v[160:175]
    ds_read_b64_tr_b16 a[12:13], v240 offset:38912
    ds_read_b64_tr_b16 a[14:15], v240 offset:39936
    v_mfma_f32_32x32x16_bf16 v[160:175], a[20:23], v[196:199], v[160:175]
    ds_read_b64_tr_b16 a[16:17], v240 offset:40960
    ds_read_b64_tr_b16 a[18:19], v240 offset:41984
    buffer_load_dwordx4 v251, s[12:15], s46 offen offset:1024 lds
    v_mfma_f32_32x32x16_bf16 v[160:175], a[24:27], v[200:203], v[160:175]
    ds_read_b64_tr_b16 a[20:21], v240 offset:43008
    ds_read_b64_tr_b16 a[22:23], v240 offset:44032
    v_mfma_f32_32x32x16_bf16 v[160:175], a[28:31], v[204:207], v[160:175]
    ds_read_b64_tr_b16 a[24:25], v240 offset:45056
    ds_read_b64_tr_b16 a[26:27], v240 offset:46080
    s_waitcnt lgkmcnt(6)
    v_mfma_f32_32x32x16_bf16 v[160:175], a[0:3], v[208:211], v[160:175]
    ds_read_b64_tr_b16 a[28:29], v240 offset:47104
    ds_read_b64_tr_b16 a[30:31], v240 offset:48128
    buffer_load_dwordx4 v252, s[12:15], s46 offen offset:2048 lds
    v_mfma_f32_32x32x16_bf16 v[160:175], a[4:7], v[212:215], v[160:175]
    s_waitcnt vmcnt(22)
    s_barrier
    ds_read_b64_tr_b16 a[0:1], v244 offset:0
    ds_read_b64_tr_b16 a[2:3], v244 offset:1024
    v_mfma_f32_32x32x16_bf16 v[160:175], a[8:11], v[216:219], v[160:175]
    ds_read_b64_tr_b16 a[4:5], v244 offset:2048
    ds_read_b64_tr_b16 a[6:7], v244 offset:3072
    v_mfma_f32_32x32x16_bf16 v[160:175], a[12:15], v[220:223], v[160:175]
    ds_read_b64_tr_b16 a[8:9], v244 offset:4096
    ds_read_b64_tr_b16 a[10:11], v244 offset:5120
    buffer_load_dwordx4 v253, s[12:15], s46 offen offset:3072 lds
    s_waitcnt lgkmcnt(6)
    v_mfma_f32_32x32x16_bf16 v[160:175], a[16:19], v[224:227], v[160:175]
    ds_read_b64_tr_b16 a[12:13], v244 offset:6144
    ds_read_b64_tr_b16 a[14:15], v244 offset:7168
    v_mfma_f32_32x32x16_bf16 v[160:175], a[20:23], v[228:231], v[160:175]
    ds_read_b64_tr_b16 a[16:17], v244 offset:8192
    ds_read_b64_tr_b16 a[18:19], v244 offset:9216
    v_mfma_f32_32x32x16_bf16 v[160:175], a[24:27], v[232:235], v[160:175]
    ds_read_b64_tr_b16 a[20:21], v244 offset:10240
    ds_read_b64_tr_b16 a[22:23], v244 offset:11264
    s_add_u32 m0, s33, 122880
    s_add_u32 s46, s28, 222208
    buffer_load_dwordx4 v250, s[12:15], s46 offen offset:0 lds
    v_mfma_f32_32x32x16_bf16 v[160:175], a[28:31], v[236:239], v[160:175]
    ds_read_b64_tr_b16 a[24:25], v244 offset:12288
    ds_read_b64_tr_b16 a[26:27], v244 offset:13312
    s_waitcnt lgkmcnt(6)
    v_mfma_f32_32x32x16_bf16 v[144:159], a[0:3], a[32:35], 0
    ds_read_b64_tr_b16 a[28:29], v244 offset:14336
    ds_read_b64_tr_b16 a[30:31], v244 offset:15360
    v_add_u32 v240, 49152, v240
    v_mfma_f32_32x32x16_bf16 v[144:159], a[4:7], a[36:39], v[144:159]
    ds_read_b64_tr_b16 a[0:1], v244 offset:16384
    ds_read_b64_tr_b16 a[2:3], v244 offset:17408
    buffer_load_dwordx4 v251, s[12:15], s46 offen offset:1024 lds
    s_waitcnt vmcnt(8)
    v_cmp_ne_u32 vcc, s23, v141
    s_nop 4
    s_and_b32 s42, vcc_lo, 0xfff
    s_cmp_eq_u32 s42, 0
    s_cbranch_scc1 Lok_2
    s_mov_b32 s42, 0
    s_mov_b32 s43, 0
    s_mov_b32 exec_lo, 0xfff
    s_mov_b32 exec_hi, 0x0
Lpoll_3:
    buffer_load_dword v2, v143, s[16:19], s42 offen sc1
    s_waitcnt vmcnt(0)
    v_cmp_ne_u32 vcc, s23, v2
    s_add_u32 s43, s43, 1
    s_cmp_ge_u32 s43, 0x200000
    s_cbranch_scc1 Lpolld_4
    s_nop 1
    s_cbranch_vccnz Lpoll_3
Lpolld_4:
    s_mov_b64 exec, -1
Lok_2:
    v_mfma_f32_32x32x16_bf16 v[144:159], a[8:11], a[40:43], v[144:159]
    ds_read_b64_tr_b16 a[4:5], v244 offset:18432
    ds_read_b64_tr_b16 a[6:7], v244 offset:19456
    v_mfma_f32_32x32x16_bf16 v[144:159], a[12:15], a[44:47], v[144:159]
    ds_read_b64_tr_b16 a[8:9], v244 offset:20480
    ds_read_b64_tr_b16 a[10:11], v244 offset:21504
    v_cvt_pk_bf16_f32 v176, v160, v161
    v_cvt_pk_bf16_f32 v177, v162, v163
    v_cvt_pk_bf16_f32 v178, v164, v165
    s_waitcnt lgkmcnt(6)
    v_mfma_f32_32x32x16_bf16 v[144:159], a[16:19], a[48:51], v[144:159]
    ds_read_b64_tr_b16 a[12:13], v244 offset:22528
    ds_read_b64_tr_b16 a[14:15], v244 offset:23552
    s_mov_b32 s38, s21
    s_lshl_b32 s54, s38, 5
    s_mul_i32 s55, s40, 1152
    s_add_u32 s44, s55, s54
    buffer_load_dwordx4 v[20:23], v12, s[4:7], s44 offen
    v_mfma_f32_32x32x16_bf16 v[144:159], a[20:23], a[52:55], v[144:159]
    s_barrier
    ds_read_b64_tr_b16 a[16:17], v244 offset:24576
    ds_read_b64_tr_b16 a[18:19], v244 offset:25600
    s_mul_i32 s36, s20, 36
    v_cvt_pk_bf16_f32 v179, v166, v167
    v_mfma_f32_32x32x16_bf16 v[144:159], a[24:27], a[56:59], v[144:159]
    ds_read_b64_tr_b16 a[20:21], v244 offset:26624
    ds_read_b64_tr_b16 a[22:23], v244 offset:27648
    s_add_u32 s36, s36, s21
    s_lshl_b32 s36, s36, 7
    s_add_u32 s36, s36, 33621504
    v_cvt_pk_bf16_f32 v180, v168, v169
    v_mfma_f32_32x32x16_bf16 v[144:159], a[28:31], a[60:63], v[144:159]
    ds_read_b64_tr_b16 a[24:25], v244 offset:28672
    ds_read_b64_tr_b16 a[26:27], v244 offset:29696
    buffer_load_dwordx4 v[24:27], v15, s[60:63], s54 offen
    v_cvt_pk_bf16_f32 v181, v170, v171
    v_cvt_pk_bf16_f32 v182, v172, v173
    s_waitcnt lgkmcnt(6)
    v_mfma_f32_32x32x16_bf16 v[144:159], a[0:3], a[64:67], v[144:159]
    ds_read_b64_tr_b16 a[28:29], v244 offset:30720
    ds_read_b64_tr_b16 a[30:31], v244 offset:31744
    s_mov_b64 exec, 1
    buffer_store_dword v255, off, s[16:19], s36 sc1
    s_mov_b64 exec, -1
    v_cvt_pk_bf16_f32 v183, v174, v175
    v_mfma_f32_32x32x16_bf16 v[144:159], a[4:7], a[68:71], v[144:159]
    ds_read_b64_tr_b16 a[0:1], v244 offset:32768
    ds_read_b64_tr_b16 a[2:3], v244 offset:33792
    v_mfma_f32_32x32x16_bf16 v[144:159], a[8:11], v[184:187], v[144:159]
    ds_read_b64_tr_b16 a[4:5], v244 offset:34816
    ds_read_b64_tr_b16 a[6:7], v244 offset:35840
    s_add_u32 s48, s34, 319488
    buffer_store_dwordx4 v[176:179], v254, s[16:19], s48 offen offset:0 sc1
    v_mfma_f32_32x32x16_bf16 v[144:159], a[12:15], v[188:191], v[144:159]
    ds_read_b64_tr_b16 a[8:9], v244 offset:36864
    ds_read_b64_tr_b16 a[10:11], v244 offset:37888
    s_waitcnt lgkmcnt(6)
    v_mfma_f32_32x32x16_bf16 v[144:159], a[16:19], v[192:195], v[144:159]
    ds_read_b64_tr_b16 a[12:13], v244 offset:38912
    ds_read_b64_tr_b16 a[14:15], v244 offset:39936
    v_mfma_f32_32x32x16_bf16 v[144:159], a[20:23], v[196:199], v[144:159]
    ds_read_b64_tr_b16 a[16:17], v244 offset:40960
    ds_read_b64_tr_b16 a[18:19], v244 offset:41984
    buffer_store_dwordx4 v[180:183], v254, s[16:19], s48 offen offset:1024 sc1
    v_mfma_f32_32x32x16_bf16 v[144:159], a[24:27], v[200:203], v[144:159]
    ds_read_b64_tr_b16 a[20:21], v244 offset:43008
    ds_read_b64_tr_b16 a[22:23], v244 offset:44032
    v_mfma_f32_32x32x16_bf16 v[144:159], a[28:31], v[204:207], v[144:159]
    ds_read_b64_tr_b16 a[24:25], v244 offset:45056
    ds_read_b64_tr_b16 a[26:27], v244 offset:46080
    s_waitcnt lgkmcnt(6)
    v_mfma_f32_32x32x16_bf16 v[144:159], a[0:3], v[208:211], v[144:159]
    ds_read_b64_tr_b16 a[28:29], v244 offset:47104
    ds_read_b64_tr_b16 a[30:31], v244 offset:48128
    s_lshr_b32 s54, s38, 1
    s_mul_i32 s55, s41, 18
    s_add_u32 s55, s55, s54
    s_mul_i32 s55, s55, 24576
    s_and_b32 s54, s38, 1
    s_lshl_b32 s54, s54, 10
    s_add_u32 s55, s55, s54
    s_add_u32 s55, s55, 5242880
    buffer_load_dwordx4 a[100:103], v16, s[16:19], s55 offen offset:0 sc1
    v_mfma_f32_32x32x16_bf16 v[144:159], a[4:7], v[212:215], v[144:159]
    ds_read_b64_tr_b16 a[0:1], v240 offset:0
    ds_read_b64_tr_b16 a[2:3], v240 offset:1024
    v_mfma_f32_32x32x16_bf16 v[144:159], a[8:11], v[216:219], v[144:159]
    ds_read_b64_tr_b16 a[4:5], v240 offset:2048
    ds_read_b64_tr_b16 a[6:7], v240 offset:3072
    v_mfma_f32_32x32x16_bf16 v[144:159], a[12:15], v[220:223], v[144:159]
    ds_read_b64_tr_b16 a[8:9], v240 offset:4096
    ds_read_b64_tr_b16 a[10:11], v240 offset:5120
    buffer_load_dwordx4 a[104:107], v16, s[16:19], s55 offen offset:2048 sc1
    s_waitcnt lgkmcnt(6)
    v_mfma_f32_32x32x16_bf16 v[144:159], a[16:19], v[224:227], v[144:159]
    ds_read_b64_tr_b16 a[12:13], v240 offset:6144
    ds_read_b64_tr_b16 a[14:15], v240 offset:7168
    v_mfma_f32_32x32x16_bf16 v[144:159], a[20:23], v[228:231], v[144:159]
    ds_read_b64_tr_b16 a[16:17], v240 offset:8192
    ds_read_b64_tr_b16 a[18:19], v240 offset:9216
    v_mfma_f32_32x32x16_bf16 v[144:159], a[24:27], v[232:235], v[144:159]
    ds_read_b64_tr_b16 a[20:21], v240 offset:10240
    ds_read_b64_tr_b16 a[22:23], v240 offset:11264
    s_add_u32 s55, s55, 4096
    buffer_load_dwordx4 a[108:111], v16, s[16:19], s55 offen offset:0 sc1
    v_mfma_f32_32x32x16_bf16 v[144:159], a[28:31], v[236:239], v[144:159]
    ds_read_b64_tr_b16 a[24:25], v240 offset:12288
    ds_read_b64_tr_b16 a[26:27], v240 offset:13312
    s_waitcnt lgkmcnt(6)
    v_mfma_f32_32x32x16_bf16 v[160:175], a[0:3], a[32:35], 0
    ds_read_b64_tr_b16 a[28:29], v240 offset:14336
    ds_read_b64_tr_b16 a[30:31], v240 offset:15360
    v_add_u32 v244, 49152, v244
    v_mfma_f32_32x32x16_bf16 v[160:175], a[4:7], a[36:39], v[160:175]
    ds_read_b64_tr_b16 a[0:1], v240 offset:16384
    ds_read_b64_tr_b16 a[2:3], v240 offset:17408
    buffer_load_dwordx4 a[112:115], v16, s[16:19], s55 offen offset:2048 sc1
    v_mfma_f32_32x32x16_bf16 v[160:175], a[8:11], a[40:43], v[160:175]
    ds_read_b64_tr_b16 a[4:5], v240 offset:18432
    ds_read_b64_tr_b16 a[6:7], v240 offset:19456
    v_mfma_f32_32x32x16_bf16 v[160:175], a[12:15], a[44:47], v[160:175]
    ds_read_b64_tr_b16 a[8:9], v240 offset:20480
    ds_read_b64_tr_b16 a[10:11], v240 offset:21504
    v_cvt_pk_bf16_f32 v176, v144, v145
    v_cvt_pk_bf16_f32 v177, v146, v147
    v_cvt_pk_bf16_f32 v178, v148, v149
    s_waitcnt lgkmcnt(6)
    v_mfma_f32_32x32x16_bf16 v[160:175], a[16:19], a[48:51], v[160:175]
    ds_read_b64_tr_b16 a[12:13], v240 offset:22528
    ds_read_b64_tr_b16 a[14:15], v240 offset:23552
    s_add_u32 s55, s55, 4096
    buffer_load_dwordx4 a[116:119], v16, s[16:19], s55 offen offset:0 sc1
    v_cvt_pk_bf16_f32 v179, v150, v151
    v_cvt_pk_bf16_f32 v180, v152, v153
    v_mfma_f32_32x32x16_bf16 v[160:175], a[20:23], a[52:55], v[160:175]
    ds_read_b64_tr_b16 a[16:17], v240 offset:24576
    ds_read_b64_tr_b16 a[18:19], v240 offset:25600
    v_cvt_pk_bf16_f32 v181, v154, v155
    v_cvt_pk_bf16_f32 v182, v156, v157
    v_cvt_pk_bf16_f32 v183, v158, v159
    v_mfma_f32_32x32x16_bf16 v[160:175], a[24:27], a[56:59], v[160:175]
    ds_read_b64_tr_b16 a[20:21], v240 offset:26624
    ds_read_b64_tr_b16 a[22:23], v240 offset:27648
    v_mfma_f32_32x32x16_bf16 v[160:175], a[28:31], a[60:63], v[160:175]
    ds_read_b64_tr_b16 a[24:25], v240 offset:28672
    ds_read_b64_tr_b16 a[26:27], v240 offset:29696
    s_add_u32 s48, s34, 344064
    buffer_store_dwordx4 v[176:179], v254, s[16:19], s48 offen offset:0 sc1
    s_waitcnt lgkmcnt(6)
    v_mfma_f32_32x32x16_bf16 v[160:175], a[0:3], a[64:67], v[160:175]
    ds_read_b64_tr_b16 a[28:29], v240 offset:30720
    ds_read_b64_tr_b16 a[30:31], v240 offset:31744
    v_mfma_f32_32x32x16_bf16 v[160:175], a[4:7], a[68:71], v[160:175]
    ds_read_b64_tr_b16 a[0:1], v240 offset:32768
    ds_read_b64_tr_b16 a[2:3], v240 offset:33792
    v_mfma_f32_32x32x16_bf16 v[160:175], a[8:11], v[184:187], v[160:175]
    ds_read_b64_tr_b16 a[4:5], v240 offset:34816
    ds_read_b64_tr_b16 a[6:7], v240 offset:35840
    buffer_store_dwordx4 v[180:183], v254, s[16:19], s48 offen offset:1024 sc1
    v_mfma_f32_32x32x16_bf16 v[160:175], a[12:15], v[188:191], v[160:175]
    ds_read_b64_tr_b16 a[8:9], v240 offset:36864
    ds_read_b64_tr_b16 a[10:11], v240 offset:37888
    s_waitcnt lgkmcnt(6)
    v_mfma_f32_32x32x16_bf16 v[160:175], a[16:19], v[192:195], v[160:175]
    ds_read_b64_tr_b16 a[12:13], v240 offset:38912
    ds_read_b64_tr_b16 a[14:15], v240 offset:39936
    v_mfma_f32_32x32x16_bf16 v[160:175], a[20:23], v[196:199], v[160:175]
    ds_read_b64_tr_b16 a[16:17], v240 offset:40960
    ds_read_b64_tr_b16 a[18:19], v240 offset:41984
    buffer_load_dwordx4 a[120:123], v16, s[16:19], s55 offen offset:2048 sc1
    v_mfma_f32_32x32x16_bf16 v[160:175], a[24:27], v[200:203], v[160:175]
    ds_read_b64_tr_b16 a[20:21], v240 offset:43008
    ds_read_b64_tr_b16 a[22:23], v240 offset:44032
    v_mfma_f32_32x32x16_bf16 v[160:175], a[28:31], v[204:207], v[160:175]
    ds_read_b64_tr_b16 a[24:25], v240 offset:45056
    ds_read_b64_tr_b16 a[26:27], v240 offset:46080
    s_waitcnt lgkmcnt(6)
    v_mfma_f32_32x32x16_bf16 v[160:175], a[0:3], v[208:211], v[160:175]
    ds_read_b64_tr_b16 a[28:29], v240 offset:47104
    ds_read_b64_tr_b16 a[30:31], v240 offset:48128
    s_add_u32 s55, s55, 4096
    buffer_load_dwordx4 a[124:127], v16, s[16:19], s55 offen offset:0 sc1
    v_mfma_f32_32x32x16_bf16 v[160:175], a[4:7], v[212:215], v[160:175]
    s_barrier
    ds_read_b64_tr_b16 a[0:1], v244 offset:0
    ds_read_b64_tr_b16 a[2:3], v244 offset:1024
    v_mfma_f32_32x32x16_bf16 v[160:175], a[8:11], v[216:219], v[160:175]
    ds_read_b64_tr_b16 a[4:5], v244 offset:2048
    ds_read_b64_tr_b16 a[6:7], v244 offset:3072
    v_mfma_f32_32x32x16_bf16 v[160:175], a[12:15], v[220:223], v[160:175]
    ds_read_b64_tr_b16 a[8:9], v244 offset:4096
    ds_read_b64_tr_b16 a[10:11], v244 offset:5120
    buffer_load_dwordx4 a[128:131], v16, s[16:19], s55 offen offset:2048 sc1
    s_waitcnt lgkmcnt(6)
    v_mfma_f32_32x32x16_bf16 v[160:175], a[16:19], v[224:227], v[160:175]
    ds_read_b64_tr_b16 a[12:13], v244 offset:6144
    ds_read_b64_tr_b16 a[14:15], v244 offset:7168
    v_mfma_f32_32x32x16_bf16 v[160:175], a[20:23], v[228:231], v[160:175]
    ds_read_b64_tr_b16 a[16:17], v244 offset:8192
    ds_read_b64_tr_b16 a[18:19], v244 offset:9216
    v_mfma_f32_32x32x16_bf16 v[160:175], a[24:27], v[232:235], v[160:175]
    ds_read_b64_tr_b16 a[20:21], v244 offset:10240
    ds_read_b64_tr_b16 a[22:23], v244 offset:11264
    s_add_u32 s55, s55, 4096
    buffer_load_dwordx4 a[132:135], v16, s[16:19], s55 offen offset:0 sc1
    v_mfma_f32_32x32x16_bf16 v[160:175], a[28:31], v[236:239], v[160:175]
    ds_read_b64_tr_b16 a[24:25], v244 offset:12288
    ds_read_b64_tr_b16 a[26:27], v244 offset:13312
    s_waitcnt lgkmcnt(6)
    v_mfma_f32_32x32x16_bf16 v[144:159], a[0:3], a[32:35], 0
    ds_read_b64_tr_b16 a[28:29], v244 offset:14336
    ds_read_b64_tr_b16 a[30:31], v244 offset:15360
    v_add_u32 v240, 49152, v240
    v_mfma_f32_32x32x16_bf16 v[144:159], a[4:7], a[36:39], v[144:159]
    ds_read_b64_tr_b16 a[0:1], v244 offset:16384
    ds_read_b64_tr_b16 a[2:3], v244 offset:17408
    buffer_load_dwordx4 a[136:139], v16, s[16:19], s55 offen offset:2048 sc1
    v_mfma_f32_32x32x16_bf16 v[144:159], a[8:11], a[40:43], v[144:159]
    ds_read_b64_tr_b16 a[4:5], v244 offset:18432
    ds_read_b64_tr_b16 a[6:7], v244 offset:19456
    v_mfma_f32_32x32x16_bf16 v[144:159], a[12:15], a[44:47], v[144:159]
    ds_read_b64_tr_b16 a[8:9], v244 offset:20480
    ds_read_b64_tr_b16 a[10:11], v244 offset:21504
    v_cvt_pk_bf16_f32 v176, v160, v161
    v_cvt_pk_bf16_f32 v177, v162, v163
    v_cvt_pk_bf16_f32 v178, v164, v165
    s_waitcnt lgkmcnt(6)
    v_mfma_f32_32x32x16_bf16 v[144:159], a[16:19], a[48:51], v[144:159]
    ds_read_b64_tr_b16 a[12:13], v244 offset:22528
    ds_read_b64_tr_b16 a[14:15], v244 offset:23552
    s_add_u32 s55, s55, 4096
    buffer_load_dwordx4 a[140:143], v16, s[16:19], s55 offen offset:0 sc1
    v_cvt_pk_bf16_f32 v179, v166, v167
    v_cvt_pk_bf16_f32 v180, v168, v169
    v_mfma_f32_32x32x16_bf16 v[144:159], a[20:23], a[52:55], v[144:159]
    s_waitcnt vmcnt(18)
    s_barrier
    ds_read_b64_tr_b16 a[16:17], v244 offset:24576
    ds_read_b64_tr_b16 a[18:19], v244 offset:25600
    v_cvt_pk_bf16_f32 v181, v170, v171
    v_cvt_pk_bf16_f32 v182, v172, v173
    v_mfma_f32_32x32x16_bf16 v[144:159], a[24:27], a[56:59], v[144:159]
    ds_read_b64_tr_b16 a[20:21], v244 offset:26624
    ds_read_b64_tr_b16 a[22:23], v244 offset:27648
    v_cvt_pk_bf16_f32 v183, v174, v175
    v_mfma_f32_32x32x16_bf16 v[144:159], a[28:31], a[60:63], v[144:159]
    ds_read_b64_tr_b16 a[24:25], v244 offset:28672
    ds_read_b64_tr_b16 a[26:27], v244 offset:29696
    s_add_u32 s48, s34, 368640
    buffer_store_dwordx4 v[176:179], v254, s[16:19], s48 offen offset:0 sc1
    s_waitcnt lgkmcnt(6)
    v_mfma_f32_32x32x16_bf16 v[144:159], a[0:3], a[64:67], v[144:159]
    ds_read_b64_tr_b16 a[28:29], v244 offset:30720
    ds_read_b64_tr_b16 a[30:31], v244 offset:31744
    v_mfma_f32_32x32x16_bf16 v[144:159], a[4:7], a[68:71], v[144:159]
    ds_read_b64_tr_b16 a[0:1], v244 offset:32768
    ds_read_b64_tr_b16 a[2:3], v244 offset:33792
    v_mfma_f32_32x32x16_bf16 v[144:159], a[8:11], v[184:187], v[144:159]
    ds_read_b64_tr_b16 a[4:5], v244 offset:34816
    ds_read_b64_tr_b16 a[6:7], v244 offset:35840
    buffer_store_dwordx4 v[180:183], v254, s[16:19], s48 offen offset:1024 sc1
    v_mfma_f32_32x32x16_bf16 v[144:159], a[12:15], v[188:191], v[144:159]
    ds_read_b64_tr_b16 a[8:9], v244 offset:36864
    ds_read_b64_tr_b16 a[10:11], v244 offset:37888
    s_waitcnt lgkmcnt(6)
    v_mfma_f32_32x32x16_bf16 v[144:159], a[16:19], v[192:195], v[144:159]
    ds_read_b64_tr_b16 a[12:13], v244 offset:38912
    ds_read_b64_tr_b16 a[14:15], v244 offset:39936
    v_mfma_f32_32x32x16_bf16 v[144:159], a[20:23], v[196:199], v[144:159]
    ds_read_b64_tr_b16 a[16:17], v244 offset:40960
    ds_read_b64_tr_b16 a[18:19], v244 offset:41984
    buffer_load_dwordx4 a[144:147], v16, s[16:19], s55 offen offset:2048 sc1
    v_mfma_f32_32x32x16_bf16 v[144:159], a[24:27], v[200:203], v[144:159]
    ds_read_b64_tr_b16 a[20:21], v244 offset:43008
    ds_read_b64_tr_b16 a[22:23], v244 offset:44032
    v_mfma_f32_32x32x16_bf16 v[144:159], a[28:31], v[204:207], v[144:159]
    ds_read_b64_tr_b16 a[24:25], v244 offset:45056
    ds_read_b64_tr_b16 a[26:27], v244 offset:46080
    s_waitcnt lgkmcnt(6)
    v_mfma_f32_32x32x16_bf16 v[144:159], a[0:3], v[208:211], v[144:159]
    ds_read_b64_tr_b16 a[28:29], v244 offset:47104
    ds_read_b64_tr_b16 a[30:31], v244 offset:48128
    v_mfma_f32_32x32x16_bf16 v[144:159], a[4:7], v[212:215], v[144:159]
    ds_read_b64_tr_b16 a[0:1], v240 offset:0
    ds_read_b64_tr_b16 a[2:3], v240 offset:1024
    v_mfma_f32_32x32x16_bf16 v[144:159], a[8:11], v[216:219], v[144:159]
    ds_read_b64_tr_b16 a[4:5], v240 offset:2048
    ds_read_b64_tr_b16 a[6:7], v240 offset:3072
    v_mfma_f32_32x32x16_bf16 v[144:159], a[12:15], v[220:223], v[144:159]
    ds_read_b64_tr_b16 a[8:9], v240 offset:4096
    ds_read_b64_tr_b16 a[10:11], v240 offset:5120
    s_waitcnt lgkmcnt(6)
    v_mfma_f32_32x32x16_bf16 v[144:159], a[16:19], v[224:227], v[144:159]
    ds_read_b64_tr_b16 a[12:13], v240 offset:6144
    ds_read_b64_tr_b16 a[14:15], v240 offset:7168
    v_mfma_f32_32x32x16_bf16 v[144:159], a[20:23], v[228:231], v[144:159]
    ds_read_b64_tr_b16 a[16:17], v240 offset:8192
    ds_read_b64_tr_b16 a[18:19], v240 offset:9216
    v_mfma_f32_32x32x16_bf16 v[144:159], a[24:27], v[232:235], v[144:159]
    ds_read_b64_tr_b16 a[20:21], v240 offset:10240
    ds_read_b64_tr_b16 a[22:23], v240 offset:11264
    v_mfma_f32_32x32x16_bf16 v[144:159], a[28:31], v[236:239], v[144:159]
    ds_read_b64_tr_b16 a[24:25], v240 offset:12288
    ds_read_b64_tr_b16 a[26:27], v240 offset:13312
    s_waitcnt lgkmcnt(6)
    v_mfma_f32_32x32x16_bf16 v[160:175], a[0:3], a[32:35], 0
    ds_read_b64_tr_b16 a[28:29], v240 offset:14336
    ds_read_b64_tr_b16 a[30:31], v240 offset:15360
    v_mfma_f32_32x32x16_bf16 v[160:175], a[4:7], a[36:39], v[160:175]
    ds_read_b64_tr_b16 a[0:1], v240 offset:16384
    ds_read_b64_tr_b16 a[2:3], v240 offset:17408
    v_mfma_f32_32x32x16_bf16 v[160:175], a[8:11], a[40:43], v[160:175]
    ds_read_b64_tr_b16 a[4:5], v240 offset:18432
    ds_read_b64_tr_b16 a[6:7], v240 offset:19456
    s_mov_b32 exec_lo, 0x1fffff
    s_mov_b32 exec_hi, 0
    buffer_load_dword v141, v142, s[16:19], 0 offen sc1
    s_mov_b64 exec, -1
    v_mfma_f32_32x32x16_bf16 v[160:175], a[12:15], a[44:47], v[160:175]
    ds_read_b64_tr_b16 a[8:9], v240 offset:20480
    ds_read_b64_tr_b16 a[10:11], v240 offset:21504
    v_cvt_pk_bf16_f32 v176, v144, v145
    v_cvt_pk_bf16_f32 v177, v146, v147
    v_cvt_pk_bf16_f32 v178, v148, v149
    s_waitcnt lgkmcnt(6)
    v_mfma_f32_32x32x16_bf16 v[160:175], a[16:19], a[48:51], v[160:175]
    ds_read_b64_tr_b16 a[12:13], v240 offset:22528
    ds_read_b64_tr_b16 a[14:15], v240 offset:23552
    v_cvt_pk_bf16_f32 v179, v150, v151
    v_cvt_pk_bf16_f32 v180, v152, v153
    v_cvt_pk_bf16_f32 v181, v154, v155
    v_cvt_pk_bf16_f32 v182, v156, v157
    v_mfma_f32_32x32x16_bf16 v[160:175], a[20:23], a[52:55], v[160:175]
    ds_read_b64_tr_b16 a[16:17], v240 offset:24576
    ds_read_b64_tr_b16 a[18:19], v240 offset:25600
    v_cvt_pk_bf16_f32 v183, v158, v159
    v_mfma_f32_32x32x16_bf16 v[160:175], a[24:27], a[56:59], v[160:175]
    ds_read_b64_tr_b16 a[20:21], v240 offset:26624
    ds_read_b64_tr_b16 a[22:23], v240 offset:27648
    v_mfma_f32_32x32x16_bf16 v[160:175], a[28:31], a[60:63], v[160:175]
    ds_read_b64_tr_b16 a[24:25], v240 offset:28672
    ds_read_b64_tr_b16 a[26:27], v240 offset:29696
    s_add_u32 s48, s34, 393216
    buffer_store_dwordx4 v[176:179], v254, s[16:19], s48 offen offset:0 sc1
    s_waitcnt lgkmcnt(6)
    v_mfma_f32_32x32x16_bf16 v[160:175], a[0:3], a[64:67], v[160:175]
    ds_read_b64_tr_b16 a[28:29], v240 offset:30720
    ds_read_b64_tr_b16 a[30:31], v240 offset:31744
    v_mfma_f32_32x32x16_bf16 v[160:175], a[4:7], a[68:71], v[160:175]
    ds_read_b64_tr_b16 a[0:1], v240 offset:32768
    ds_read_b64_tr_b16 a[2:3], v240 offset:33792
    v_mfma_f32_32x32x16_bf16 v[160:175], a[8:11], v[184:187], v[160:175]
    ds_read_b64_tr_b16 a[4:5], v240 offset:34816
    ds_read_b64_tr_b16 a[6:7], v240 offset:35840
    buffer_store_dwordx4 v[180:183], v254, s[16:19], s48 offen offset:1024 sc1
    v_mfma_f32_32x32x16_bf16 v[160:175], a[12:15], v[188:191], v[160:175]
    ds_read_b64_tr_b16 a[8:9], v240 offset:36864
    ds_read_b64_tr_b16 a[10:11], v240 offset:37888
    s_waitcnt lgkmcnt(6)
    v_mfma_f32_32x32x16_bf16 v[160:175], a[16:19], v[192:195], v[160:175]
    ds_read_b64_tr_b16 a[12:13], v240 offset:38912
    ds_read_b64_tr_b16 a[14:15], v240 offset:39936
    v_mfma_f32_32x32x16_bf16 v[160:175], a[20:23], v[196:199], v[160:175]
    ds_read_b64_tr_b16 a[16:17], v240 offset:40960
    ds_read_b64_tr_b16 a[18:19], v240 offset:41984
    v_mfma_f32_32x32x16_bf16 v[160:175], a[24:27], v[200:203], v[160:175]
    ds_read_b64_tr_b16 a[20:21], v240 offset:43008
    ds_read_b64_tr_b16 a[22:23], v240 offset:44032
    v_mfma_f32_32x32x16_bf16 v[160:175], a[28:31], v[204:207], v[160:175]
    ds_read_b64_tr_b16 a[24:25], v240 offset:45056
    ds_read_b64_tr_b16 a[26:27], v240 offset:46080
    s_waitcnt lgkmcnt(6)
    v_mfma_f32_32x32x16_bf16 v[160:175], a[0:3], v[208:211], v[160:175]
    ds_read_b64_tr_b16 a[28:29], v240 offset:47104
    ds_read_b64_tr_b16 a[30:31], v240 offset:48128
    v_mfma_f32_32x32x16_bf16 v[160:175], a[4:7], v[212:215], v[160:175]
    v_mfma_f32_32x32x16_bf16 v[160:175], a[8:11], v[216:219], v[160:175]
    v_mfma_f32_32x32x16_bf16 v[160:175], a[12:15], v[220:223], v[160:175]
    s_waitcnt lgkmcnt(0)
    v_mfma_f32_32x32x16_bf16 v[160:175], a[16:19], v[224:227], v[160:175]
    v_mfma_f32_32x32x16_bf16 v[160:175], a[20:23], v[228:231], v[160:175]
    v_mfma_f32_32x32x16_bf16 v[160:175], a[24:27], v[232:235], v[160:175]
    v_mfma_f32_32x32x16_bf16 v[160:175], a[28:31], v[236:239], v[160:175]
    s_mul_i32 s36, s20, 36
    s_add_u32 s36, s36, s21
    s_lshl_b32 s36, s36, 7
    s_add_u32 s36, s36, 33623040
    s_mul_i32 s42, s20, 4608
    s_add_u32 s49, s42, 33623040
    v_lshlrev_b32 v19, 7, v1
    s_nop 4
    v_cvt_pk_bf16_f32 v176, v160, v161
    v_cvt_pk_bf16_f32 v177, v162, v163
    v_cvt_pk_bf16_f32 v178, v164, v165
    v_cvt_pk_bf16_f32 v179, v166, v167
    v_cvt_pk_bf16_f32 v180, v168, v169
    v_cvt_pk_bf16_f32 v181, v170, v171
    v_cvt_pk_bf16_f32 v182, v172, v173
    v_cvt_pk_bf16_f32 v183, v174, v175
    s_add_u32 s48, s34, 417792
    buffer_store_dwordx4 v[176:179], v254, s[16:19], s48 offen offset:0 sc1
    buffer_store_dwordx4 v[180:183], v254, s[16:19], s48 offen offset:1024 sc1
    s_add_u32 s38, s21, 12
    s_lshl_b32 s54, s38, 5
    s_mul_i32 s55, s40, 1152
    s_add_u32 s45, s55, s54
    buffer_load_dwordx4 v[32:35], v12, s[4:7], s45 offen
    buffer_load_dwordx4 v[36:39], v15, s[60:63], s54 offen
    s_add_u32 s38, s21, 24
    s_lshl_b32 s54, s38, 5
    s_mul_i32 s55, s40, 1152
    s_add_u32 s46, s55, s54
    buffer_load_dwordx4 v[44:47], v12, s[4:7], s46 offen
    buffer_load_dwordx4 v[48:51], v15, s[60:63], s54 offen
    s_waitcnt vmcnt(24)
    v_mfma_f32_32x32x16_bf16 v[56:71], v[8:11], a[100:103], 0
    s_waitcnt vmcnt(23)
    v_mfma_f32_32x32x16_bf16 v[56:71], v[8:11], a[104:107], v[56:71]
    s_waitcnt vmcnt(22)
    v_mfma_f32_32x32x16_bf16 v[56:71], v[8:11], a[108:111], v[56:71]
    s_waitcnt vmcnt(21)
    v_mfma_f32_32x32x16_bf16 v[56:71], v[8:11], a[112:115], v[56:71]
    s_waitcnt vmcnt(20)
    v_mfma_f32_32x32x16_bf16 v[56:71], v[8:11], a[116:119], v[56:71]
    s_waitcnt vmcnt(17)
    v_mfma_f32_32x32x16_bf16 v[56:71], v[8:11], a[120:123], v[56:71]
    s_waitcnt vmcnt(16)
    v_mfma_f32_32x32x16_bf16 v[56:71], v[8:11], a[124:127], v[56:71]
    s_waitcnt vmcnt(15)
    v_mfma_f32_32x32x16_bf16 v[56:71], v[8:11], a[128:131], v[56:71]
    s_waitcnt vmcnt(14)
    v_mfma_f32_32x32x16_bf16 v[56:71], v[8:11], a[132:135], v[56:71]
    s_waitcnt vmcnt(13)
    v_mfma_f32_32x32x16_bf16 v[56:71], v[8:11], a[136:139], v[56:71]
    s_waitcnt vmcnt(12)
    v_mfma_f32_32x32x16_bf16 v[56:71], v[8:11], a[140:143], v[56:71]
    s_waitcnt vmcnt(9)
    v_mfma_f32_32x32x16_bf16 v[56:71], v[8:11], a[144:147], v[56:71]
    s_waitcnt vmcnt(4)
    s_barrier
    s_mov_b64 exec, 1
    buffer_store_dword v255, off, s[16:19], s36 sc1
    s_mov_b64 exec, -1
    v_cmp_ne_u32 vcc, s23, v141
    s_nop 4
    s_and_b32 s42, vcc_lo, 0x1ff000
    s_cmp_eq_u32 s42, 0
    s_cbranch_scc1 Lok_5
    s_mov_b32 s42, 0
    s_mov_b32 s43, 0
    s_mov_b32 exec_lo, 0x1ff000
    s_mov_b32 exec_hi, 0x0
Lpoll_6:
    buffer_load_dword v2, v142, s[16:19], s42 offen sc1
    s_waitcnt vmcnt(0)
    v_cmp_ne_u32 vcc, s23, v2
    s_add_u32 s43, s43, 1
    s_cmp_ge_u32 s43, 0x200000
    s_cbranch_scc1 Lpolld_7
    s_nop 1
    s_cbranch_vccnz Lpoll_6
Lpolld_7:
    s_mov_b64 exec, -1
Lok_5:
    s_add_u32 s38, s21, 0
    s_lshl_b32 s54, s38, 16
    s_lshl_b32 s55, s40, 1
    s_add_u32 s54, s54, s55
    s_add_u32 s54, s54, 2621440
    s_lshl_b32 s55, s22, 12
    s_add_u32 m0, s55, 0
    s_nop 0
    buffer_load_dwordx4 v13, s[16:19], s54 offen sc1 lds
    s_add_u32 s38, s21, 12
    s_lshl_b32 s54, s38, 16
    s_lshl_b32 s55, s40, 1
    s_add_u32 s54, s54, s55
    s_add_u32 s54, s54, 2621440
    s_lshl_b32 s55, s22, 12
    s_add_u32 m0, s55, 1024
    s_nop 0
    buffer_load_dwordx4 v13, s[16:19], s54 offen sc1 lds
    s_add_u32 s38, s21, 24
    s_lshl_b32 s54, s38, 16
    s_lshl_b32 s55, s40, 1
    s_add_u32 s54, s54, s55
    s_add_u32 s54, s54, 2621440
    s_lshl_b32 s55, s22, 12
    s_add_u32 m0, s55, 2048
    s_nop 0
    buffer_load_dwordx4 v13, s[16:19], s54 offen sc1 lds
    v_cmp_ne_u32 vcc, s23, v141
    s_nop 4
    s_and_b32 s42, vcc_lo, 0xfff
    s_cmp_eq_u32 s42, 0
    s_cbranch_scc1 Lok_8
    s_mov_b32 s42, 0
    s_mov_b32 s43, 0
    s_mov_b32 exec_lo, 0xfff
    s_mov_b32 exec_hi, 0x0
Lpoll_9:
    buffer_load_dword v2, v142, s[16:19], s42 offen sc1
    s_waitcnt vmcnt(0)
    v_cmp_ne_u32 vcc, s23, v2
    s_add_u32 s43, s43, 1
    s_cmp_ge_u32 s43, 0x200000
    s_cbranch_scc1 Lpolld_10
    s_nop 1
    s_cbranch_vccnz Lpoll_9
Lpolld_10:
    s_mov_b64 exec, -1
Lok_8:
    s_add_u32 s38, s21, 12
    s_lshr_b32 s54, s38, 1
    s_mul_i32 s55, s41, 18
    s_add_u32 s55, s55, s54
    s_mul_i32 s55, s55, 24576
    s_and_b32 s54, s38, 1
    s_lshl_b32 s54, s54, 10
    s_add_u32 s55, s55, s54
    s_add_u32 s55, s55, 5242880
    buffer_load_dwordx4 a[148:151], v16, s[16:19], s55 offen offset:0 sc1
    buffer_load_dwordx4 a[152:155], v16, s[16:19], s55 offen offset:2048 sc1
    s_add_u32 s55, s55, 4096
    buffer_load_dwordx4 a[156:159], v16, s[16:19], s55 offen offset:0 sc1
    buffer_load_dwordx4 a[160:163], v16, s[16:19], s55 offen offset:2048 sc1
    s_add_u32 s55, s55, 4096
    buffer_load_dwordx4 a[164:167], v16, s[16:19], s55 offen offset:0 sc1
    buffer_load_dwordx4 a[168:171], v16, s[16:19], s55 offen offset:2048 sc1
    s_add_u32 s55, s55, 4096
    buffer_load_dwordx4 a[172:175], v16, s[16:19], s55 offen offset:0 sc1
    buffer_load_dwordx4 a[176:179], v16, s[16:19], s55 offen offset:2048 sc1
    s_add_u32 s55, s55, 4096
    buffer_load_dwordx4 a[180:183], v16, s[16:19], s55 offen offset:0 sc1
    buffer_load_dwordx4 a[184:187], v16, s[16:19], s55 offen offset:2048 sc1
    s_add_u32 s55, s55, 4096
    buffer_load_dwordx4 a[188:191], v16, s[16:19], s55 offen offset:0 sc1
    buffer_load_dwordx4 a[192:195], v16, s[16:19], s55 offen offset:2048 sc1
    v_mul_f32 v56, v56, v17
    v_mul_f32 v57, v57, v17
    v_mul_f32 v58, v58, v17
    v_mul_f32 v59, v59, v17
    v_mul_f32 v60, v60, v17
    v_mul_f32 v61, v61, v17
    v_mul_f32 v62, v62, v17
    v_mul_f32 v63, v63, v17
    v_mul_f32 v64, 0xbfb8aa3b, v56
    v_mul_f32 v65, 0xbfb8aa3b, v57
    v_mul_f32 v66, 0xbfb8aa3b, v58
    v_mul_f32 v67, 0xbfb8aa3b, v59
    v_mul_f32 v68, 0xbfb8aa3b, v60
    v_mul_f32 v69, 0xbfb8aa3b, v61
    v_mul_f32 v70, 0xbfb8aa3b, v62
    v_mul_f32 v71, 0xbfb8aa3b, v63
    v_exp_f32 v64, v64
    v_exp_f32 v65, v65
    v_exp_f32 v66, v66
    v_exp_f32 v67, v67
    v_exp_f32 v68, v68
    v_exp_f32 v69, v69
    v_exp_f32 v70, v70
    v_exp_f32 v71, v71
    v_add_f32 v64, 1.0, v64
    v_add_f32 v65, 1.0, v65
    v_add_f32 v66, 1.0, v66
    v_add_f32 v67, 1.0, v67
    v_add_f32 v68, 1.0, v68
    v_add_f32 v69, 1.0, v69
    v_add_f32 v70, 1.0, v70
    v_add_f32 v71, 1.0, v71
    v_rcp_f32 v64, v64
    v_rcp_f32 v65, v65
    v_rcp_f32 v66, v66
    v_rcp_f32 v67, v67
    v_rcp_f32 v68, v68
    v_rcp_f32 v69, v69
    v_rcp_f32 v70, v70
    v_rcp_f32 v71, v71
    v_mul_f32 v56, v56, v64
    v_mul_f32 v57, v57, v65
    v_mul_f32 v58, v58, v66
    v_mul_f32 v59, v59, v67
    v_mul_f32 v60, v60, v68
    v_mul_f32 v61, v61, v69
    v_mul_f32 v62, v62, v70
    v_mul_f32 v63, v63, v71
    s_waitcnt vmcnt(14)
    ds_read_b64_tr_b16 v[28:29], v14 offset:0
    ds_read_b64_tr_b16 v[30:31], v14 offset:256
    v_lshlrev_b32 v112, 16, v20
    v_lshlrev_b32 v3, 16, v24
    s_waitcnt lgkmcnt(1)
    v_lshlrev_b32 v4, 16, v28
    v_fma_f32 v5, v112, v17, v18
    v_fma_f32 v104, v5, v3, v4
    v_and_b32 v113, 0xffff0000, v20
    v_and_b32 v3, 0xffff0000, v24
    v_and_b32 v4, 0xffff0000, v28
    v_fma_f32 v5, v113, v17, v18
    v_fma_f32 v105, v5, v3, v4
    v_lshlrev_b32 v114, 16, v21
    v_lshlrev_b32 v3, 16, v25
    v_lshlrev_b32 v4, 16, v29
    v_fma_f32 v5, v114, v17, v18
    v_fma_f32 v106, v5, v3, v4
    v_and_b32 v115, 0xffff0000, v21
    v_and_b32 v3, 0xffff0000, v25
    v_and_b32 v4, 0xffff0000, v29
    v_fma_f32 v5, v115, v17, v18
    v_fma_f32 v107, v5, v3, v4
    v_lshlrev_b32 v116, 16, v22
    v_lshlrev_b32 v3, 16, v26
    s_waitcnt lgkmcnt(0)
    v_lshlrev_b32 v4, 16, v30
    v_fma_f32 v5, v116, v17, v18
    v_fma_f32 v108, v5, v3, v4
    v_and_b32 v117, 0xffff0000, v22
    v_and_b32 v3, 0xffff0000, v26
    v_and_b32 v4, 0xffff0000, v30
    v_fma_f32 v5, v117, v17, v18
    v_fma_f32 v109, v5, v3, v4
    v_lshlrev_b32 v118, 16, v23
    v_lshlrev_b32 v3, 16, v27
    v_lshlrev_b32 v4, 16, v31
    v_fma_f32 v5, v118, v17, v18
    v_fma_f32 v110, v5, v3, v4
    v_and_b32 v119, 0xffff0000, v23
    v_and_b32 v3, 0xffff0000, v27
    v_and_b32 v4, 0xffff0000, v31
    v_fma_f32 v5, v119, v17, v18
    v_fma_f32 v111, v5, v3, v4
    v_fma_f32 v64, v104, v56, v112
    v_fma_f32 v65, v105, v57, v113
    v_fma_f32 v66, v106, v58, v114
    v_fma_f32 v67, v107, v59, v115
    v_fma_f32 v68, v108, v60, v116
    v_fma_f32 v69, v109, v61, v117
    v_fma_f32 v70, v110, v62, v118
    v_fma_f32 v71, v111, v63, v119
    v_cvt_pk_bf16_f32 v56, v64, v65
    v_cvt_pk_bf16_f32 v57, v66, v67
    v_cvt_pk_bf16_f32 v58, v68, v69
    v_cvt_pk_bf16_f32 v59, v70, v71
    buffer_store_dwordx4 v[56:59], v12, s[56:59], s44 offen
    s_waitcnt vmcnt(12)
    v_mfma_f32_32x32x16_bf16 v[72:87], v[8:11], a[148:151], 0
    s_waitcnt vmcnt(11)
    v_mfma_f32_32x32x16_bf16 v[72:87], v[8:11], a[152:155], v[72:87]
    s_waitcnt vmcnt(10)
    v_mfma_f32_32x32x16_bf16 v[72:87], v[8:11], a[156:159], v[72:87]
    s_waitcnt vmcnt(9)
    v_mfma_f32_32x32x16_bf16 v[72:87], v[8:11], a[160:163], v[72:87]
    s_waitcnt vmcnt(8)
    v_mfma_f32_32x32x16_bf16 v[72:87], v[8:11], a[164:167], v[72:87]
    s_waitcnt vmcnt(7)
    v_mfma_f32_32x32x16_bf16 v[72:87], v[8:11], a[168:171], v[72:87]
    s_waitcnt vmcnt(6)
    v_mfma_f32_32x32x16_bf16 v[72:87], v[8:11], a[172:175], v[72:87]
    s_waitcnt vmcnt(5)
    v_mfma_f32_32x32x16_bf16 v[72:87], v[8:11], a[176:179], v[72:87]
    s_waitcnt vmcnt(4)
    v_mfma_f32_32x32x16_bf16 v[72:87], v[8:11], a[180:183], v[72:87]
    s_waitcnt vmcnt(3)
    v_mfma_f32_32x32x16_bf16 v[72:87], v[8:11], a[184:187], v[72:87]
    s_waitcnt vmcnt(2)
    v_mfma_f32_32x32x16_bf16 v[72:87], v[8:11], a[188:191], v[72:87]
    s_waitcnt vmcnt(1)
    v_mfma_f32_32x32x16_bf16 v[72:87], v[8:11], a[192:195], v[72:87]
    s_nop 11
    v_mul_f32 v72, v72, v17
    v_mul_f32 v73, v73, v17
    v_mul_f32 v74, v74, v17
    v_mul_f32 v75, v75, v17
    v_mul_f32 v76, v76, v17
    v_mul_f32 v77, v77, v17
    v_mul_f32 v78, v78, v17
    v_mul_f32 v79, v79, v17
    v_mul_f32 v80, 0xbfb8aa3b, v72
    v_mul_f32 v81, 0xbfb8aa3b, v73
    v_mul_f32 v82, 0xbfb8aa3b, v74
    v_mul_f32 v83, 0xbfb8aa3b, v75
    v_mul_f32 v84, 0xbfb8aa3b, v76
    v_mul_f32 v85, 0xbfb8aa3b, v77
    v_mul_f32 v86, 0xbfb8aa3b, v78
    v_mul_f32 v87, 0xbfb8aa3b, v79
    v_exp_f32 v80, v80
    v_exp_f32 v81, v81
    v_exp_f32 v82, v82
    v_exp_f32 v83, v83
    v_exp_f32 v84, v84
    v_exp_f32 v85, v85
    v_exp_f32 v86, v86
    v_exp_f32 v87, v87
    v_add_f32 v80, 1.0, v80
    v_add_f32 v81, 1.0, v81
    v_add_f32 v82, 1.0, v82
    v_add_f32 v83, 1.0, v83
    v_add_f32 v84, 1.0, v84
    v_add_f32 v85, 1.0, v85
    v_add_f32 v86, 1.0, v86
    v_add_f32 v87, 1.0, v87
    v_rcp_f32 v80, v80
    v_rcp_f32 v81, v81
    v_rcp_f32 v82, v82
    v_rcp_f32 v83, v83
    v_rcp_f32 v84, v84
    v_rcp_f32 v85, v85
    v_rcp_f32 v86, v86
    v_rcp_f32 v87, v87
    v_mul_f32 v72, v72, v80
    v_mul_f32 v73, v73, v81
    v_mul_f32 v74, v74, v82
    v_mul_f32 v75, v75, v83
    v_mul_f32 v76, v76, v84
    v_mul_f32 v77, v77, v85
    v_mul_f32 v78, v78, v86
    v_mul_f32 v79, v79, v87
    ds_read_b64_tr_b16 v[40:41], v14 offset:1024
    ds_read_b64_tr_b16 v[42:43], v14 offset:1280
    v_lshlrev_b32 v112, 16, v32
    v_lshlrev_b32 v3, 16, v36
    s_waitcnt lgkmcnt(1)
    v_lshlrev_b32 v4, 16, v40
    v_fma_f32 v5, v112, v17, v18
    v_fma_f32 v104, v5, v3, v4
    v_and_b32 v113, 0xffff0000, v32
    v_and_b32 v3, 0xffff0000, v36
    v_and_b32 v4, 0xffff0000, v40
    v_fma_f32 v5, v113, v17, v18
    v_fma_f32 v105, v5, v3, v4
    v_lshlrev_b32 v114, 16, v33
    v_lshlrev_b32 v3, 16, v37
    v_lshlrev_b32 v4, 16, v41
    v_fma_f32 v5, v114, v17, v18
    v_fma_f32 v106, v5, v3, v4
    v_and_b32 v115, 0xffff0000, v33
    v_and_b32 v3, 0xffff0000, v37
    v_and_b32 v4, 0xffff0000, v41
    v_fma_f32 v5, v115, v17, v18
    v_fma_f32 v107, v5, v3, v4
    v_lshlrev_b32 v116, 16, v34
    v_lshlrev_b32 v3, 16, v38
    s_waitcnt lgkmcnt(0)
    v_lshlrev_b32 v4, 16, v42
    v_fma_f32 v5, v116, v17, v18
    v_fma_f32 v108, v5, v3, v4
    v_and_b32 v117, 0xffff0000, v34
    v_and_b32 v3, 0xffff0000, v38
    v_and_b32 v4, 0xffff0000, v42
    v_fma_f32 v5, v117, v17, v18
    v_fma_f32 v109, v5, v3, v4
    v_lshlrev_b32 v118, 16, v35
    v_lshlrev_b32 v3, 16, v39
    v_lshlrev_b32 v4, 16, v43
    v_fma_f32 v5, v118, v17, v18
    v_fma_f32 v110, v5, v3, v4
    v_and_b32 v119, 0xffff0000, v35
    v_and_b32 v3, 0xffff0000, v39
    v_and_b32 v4, 0xffff0000, v43
    v_fma_f32 v5, v119, v17, v18
    v_fma_f32 v111, v5, v3, v4
    v_fma_f32 v80, v104, v72, v112
    v_fma_f32 v81, v105, v73, v113
    v_fma_f32 v82, v106, v74, v114
    v_fma_f32 v83, v107, v75, v115
    v_fma_f32 v84, v108, v76, v116
    v_fma_f32 v85, v109, v77, v117
    v_fma_f32 v86, v110, v78, v118
    v_fma_f32 v87, v111, v79, v119
    v_cvt_pk_bf16_f32 v72, v80, v81
    v_cvt_pk_bf16_f32 v73, v82, v83
    v_cvt_pk_bf16_f32 v74, v84, v85
    v_cvt_pk_bf16_f32 v75, v86, v87
    buffer_store_dwordx4 v[72:75], v12, s[56:59], s45 offen
    s_cmp_lg_u32 s22, 3
    s_cbranch_scc1 Lpf_11
    s_mov_b32 s43, 0
    s_mov_b32 exec_lo, 0xfff
    s_mov_b32 exec_hi, 0x0
Lpoll_12:
    buffer_load_dword v2, v19, s[16:19], s49 offen sc1
    s_waitcnt vmcnt(0)
    v_cmp_ne_u32 vcc, s23, v2
    s_add_u32 s43, s43, 1
    s_cmp_ge_u32 s43, 0x200000
    s_cbranch_scc1 Lpolld_13
    s_nop 1
    s_cbranch_vccnz Lpoll_12
Lpolld_13:
    s_mov_b64 exec, -1
Lpf_11:
    s_barrier
    s_add_u32 s38, s21, 24
    s_lshr_b32 s54, s38, 1
    s_mul_i32 s55, s41, 18
    s_add_u32 s55, s55, s54
    s_mul_i32 s55, s55, 24576
    s_and_b32 s54, s38, 1
    s_lshl_b32 s54, s54, 10
    s_add_u32 s55, s55, s54
    s_add_u32 s55, s55, 5242880
    buffer_load_dwordx4 a[196:199], v16, s[16:19], s55 offen offset:0 sc1
    buffer_load_dwordx4 a[200:203], v16, s[16:19], s55 offen offset:2048 sc1
    s_add_u32 s55, s55, 4096
    buffer_load_dwordx4 a[204:207], v16, s[16:19], s55 offen offset:0 sc1
    buffer_load_dwordx4 a[208:211], v16, s[16:19], s55 offen offset:2048 sc1
    s_add_u32 s55, s55, 4096
    buffer_load_dwordx4 a[212:215], v16, s[16:19], s55 offen offset:0 sc1
    buffer_load_dwordx4 a[216:219], v16, s[16:19], s55 offen offset:2048 sc1
    s_add_u32 s55, s55, 4096
    buffer_load_dwordx4 a[220:223], v16, s[16:19], s55 offen offset:0 sc1
    buffer_load_dwordx4 a[224:227], v16, s[16:19], s55 offen offset:2048 sc1
    s_add_u32 s55, s55, 4096
    buffer_load_dwordx4 a[228:231], v16, s[16:19], s55 offen offset:0 sc1
    buffer_load_dwordx4 a[232:235], v16, s[16:19], s55 offen offset:2048 sc1
    s_add_u32 s55, s55, 4096
    buffer_load_dwordx4 a[236:239], v16, s[16:19], s55 offen offset:0 sc1
    buffer_load_dwordx4 a[240:243], v16, s[16:19], s55 offen offset:2048 sc1
    ds_read_b64_tr_b16 v[52:53], v14 offset:2048
    ds_read_b64_tr_b16 v[54:55], v14 offset:2304
    v_lshlrev_b32 v112, 16, v44
    v_lshlrev_b32 v3, 16, v48
    s_waitcnt lgkmcnt(1)
    v_lshlrev_b32 v4, 16, v52
    v_fma_f32 v5, v112, v17, v18
    v_fma_f32 v104, v5, v3, v4
    v_and_b32 v113, 0xffff0000, v44
    v_and_b32 v3, 0xffff0000, v48
    v_and_b32 v4, 0xffff0000, v52
    v_fma_f32 v5, v113, v17, v18
    v_fma_f32 v105, v5, v3, v4
    v_lshlrev_b32 v114, 16, v45
    v_lshlrev_b32 v3, 16, v49
    v_lshlrev_b32 v4, 16, v53
    v_fma_f32 v5, v114, v17, v18
    v_fma_f32 v106, v5, v3, v4
    v_and_b32 v115, 0xffff0000, v45
    v_and_b32 v3, 0xffff0000, v49
    v_and_b32 v4, 0xffff0000, v53
    v_fma_f32 v5, v115, v17, v18
    v_fma_f32 v107, v5, v3, v4
    v_lshlrev_b32 v116, 16, v46
    v_lshlrev_b32 v3, 16, v50
    s_waitcnt lgkmcnt(0)
    v_lshlrev_b32 v4, 16, v54
    v_fma_f32 v5, v116, v17, v18
    v_fma_f32 v108, v5, v3, v4
    v_and_b32 v117, 0xffff0000, v46
    v_and_b32 v3, 0xffff0000, v50
    v_and_b32 v4, 0xffff0000, v54
    v_fma_f32 v5, v117, v17, v18
    v_fma_f32 v109, v5, v3, v4
    v_lshlrev_b32 v118, 16, v47
    v_lshlrev_b32 v3, 16, v51
    v_lshlrev_b32 v4, 16, v55
    v_fma_f32 v5, v118, v17, v18
    v_fma_f32 v110, v5, v3, v4
    v_and_b32 v119, 0xffff0000, v47
    v_and_b32 v3, 0xffff0000, v51
    v_and_b32 v4, 0xffff0000, v55
    v_fma_f32 v5, v119, v17, v18
    v_fma_f32 v111, v5, v3, v4
    s_waitcnt vmcnt(11)
    v_mfma_f32_32x32x16_bf16 v[88:103], v[8:11], a[196:199], 0
    s_waitcnt vmcnt(10)
    v_mfma_f32_32x32x16_bf16 v[88:103], v[8:11], a[200:203], v[88:103]
    s_waitcnt vmcnt(9)
    v_mfma_f32_32x32x16_bf16 v[88:103], v[8:11], a[204:207], v[88:103]
    s_waitcnt vmcnt(8)
    v_mfma_f32_32x32x16_bf16 v[88:103], v[8:11], a[208:211], v[88:103]
    s_waitcnt vmcnt(7)
    v_mfma_f32_32x32x16_bf16 v[88:103], v[8:11], a[212:215], v[88:103]
    s_waitcnt vmcnt(6)
    v_mfma_f32_32x32x16_bf16 v[88:103], v[8:11], a[216:219], v[88:103]
    s_waitcnt vmcnt(5)
    v_mfma_f32_32x32x16_bf16 v[88:103], v[8:11], a[220:223], v[88:103]
    s_waitcnt vmcnt(4)
    v_mfma_f32_32x32x16_bf16 v[88:103], v[8:11], a[224:227], v[88:103]
    s_waitcnt vmcnt(3)
    v_mfma_f32_32x32x16_bf16 v[88:103], v[8:11], a[228:231], v[88:103]
    s_waitcnt vmcnt(2)
    v_mfma_f32_32x32x16_bf16 v[88:103], v[8:11], a[232:235], v[88:103]
    s_waitcnt vmcnt(1)
    v_mfma_f32_32x32x16_bf16 v[88:103], v[8:11], a[236:239], v[88:103]
    s_waitcnt vmcnt(0)
    v_mfma_f32_32x32x16_bf16 v[88:103], v[8:11], a[240:243], v[88:103]
    s_nop 11
    v_mul_f32 v88, v88, v17
    v_mul_f32 v89, v89, v17
    v_mul_f32 v90, v90, v17
    v_mul_f32 v91, v91, v17
    v_mul_f32 v92, v92, v17
    v_mul_f32 v93, v93, v17
    v_mul_f32 v94, v94, v17
    v_mul_f32 v95, v95, v17
    v_mul_f32 v96, 0xbfb8aa3b, v88
    v_mul_f32 v97, 0xbfb8aa3b, v89
    v_mul_f32 v98, 0xbfb8aa3b, v90
    v_mul_f32 v99, 0xbfb8aa3b, v91
    v_mul_f32 v100, 0xbfb8aa3b, v92
    v_mul_f32 v101, 0xbfb8aa3b, v93
    v_mul_f32 v102, 0xbfb8aa3b, v94
    v_mul_f32 v103, 0xbfb8aa3b, v95
    v_exp_f32 v96, v96
    v_exp_f32 v97, v97
    v_exp_f32 v98, v98
    v_exp_f32 v99, v99
    v_exp_f32 v100, v100
    v_exp_f32 v101, v101
    v_exp_f32 v102, v102
    v_exp_f32 v103, v103
    v_add_f32 v96, 1.0, v96
    v_add_f32 v97, 1.0, v97
    v_add_f32 v98, 1.0, v98
    v_add_f32 v99, 1.0, v99
    v_add_f32 v100, 1.0, v100
    v_add_f32 v101, 1.0, v101
    v_add_f32 v102, 1.0, v102
    v_add_f32 v103, 1.0, v103
    v_rcp_f32 v96, v96
    v_rcp_f32 v97, v97
    v_rcp_f32 v98, v98
    v_rcp_f32 v99, v99
    v_rcp_f32 v100, v100
    v_rcp_f32 v101, v101
    v_rcp_f32 v102, v102
    v_rcp_f32 v103, v103
    v_mul_f32 v88, v88, v96
    v_mul_f32 v89, v89, v97
    v_mul_f32 v90, v90, v98
    v_mul_f32 v91, v91, v99
    v_mul_f32 v92, v92, v100
    v_mul_f32 v93, v93, v101
    v_mul_f32 v94, v94, v102
    v_mul_f32 v95, v95, v103
    v_fma_f32 v96, v104, v88, v112
    v_fma_f32 v97, v105, v89, v113
    v_fma_f32 v98, v106, v90, v114
    v_fma_f32 v99, v107, v91, v115
    v_fma_f32 v100, v108, v92, v116
    v_fma_f32 v101, v109, v93, v117
    v_fma_f32 v102, v110, v94, v118
    v_fma_f32 v103, v111, v95, v119
    v_cvt_pk_bf16_f32 v88, v96, v97
    v_cvt_pk_bf16_f32 v89, v98, v99
    v_cvt_pk_bf16_f32 v90, v100, v101
    v_cvt_pk_bf16_f32 v91, v102, v103
    buffer_store_dwordx4 v[88:91], v12, s[56:59], s46 offen
    s_endpgm
L_conv:
    s_getpc_b64 s[92:93]
L_pc_14:
    s_lshr_b32 s94, s2, 3
    s_lshl_b32 s94, s94, 2
    v_lshrrev_b32 v2, 6, v0
    v_add_u32 v2, s94, v2
    s_mov_b32 s95, ((L_code_end - L_code_begin) + 8191) / 8192
    v_cvt_f32_u32 v3, v2
    v_cvt_f32_u32 v4, s95
    v_rcp_f32 v4, v4
    v_add_f32 v3, 0.5, v3
    v_mul_f32 v3, v3, v4
    v_cvt_u32_f32 v3, v3
    v_mul_lo_u32 v3, v3, s95
    v_sub_u32 v2, v2, v3
    v_lshlrev_b32 v2, 13, v2
    v_and_b32 v3, 63, v0
    v_lshl_add_u32 v2, v3, 7, v2
    s_mov_b32 s95, (L_code_end - L_code_begin) - 4
    v_min_u32 v2, s95, v2
    s_sub_u32 s92, s92, (L_pc_14 - L_code_begin)
    s_subb_u32 s93, s93, 0
    global_load_dword a255, v2, s[92:93]
    s_load_dwordx2 s[4:5], s[0:1], 0
    s_load_dwordx2 s[24:25], s[0:1], 8
    s_load_dwordx2 s[28:29], s[0:1], 16
    s_load_dwordx2 s[32:33], s[0:1], 24
    s_load_dwordx2 s[36:37], s[0:1], 32
    s_load_dwordx2 s[40:41], s[0:1], 40
    s_load_dwordx2 s[44:45], s[0:1], 48
    s_load_dwordx2 s[8:9], s[0:1], 64
    s_load_dwordx2 s[12:13], s[0:1], 72
    s_load_dwordx2 s[48:49], s[0:1], 80
    s_load_dwordx2 s[16:17], s[0:1], 96
    s_sub_u32 s20, s2, 192
    v_mov_b32 v2, v0
    v_and_b32 v1, 63, v0
    v_lshrrev_b32 v136, 6, v0
    v_lshlrev_b32 v141, 1, v1
    v_readfirstlane_b32 s21, v136
    s_waitcnt lgkmcnt(0)
    s_mov_b32 s6, 2359296
    s_mov_b32 s7, 0x20000
    s_mov_b32 s26, 147456
    s_mov_b32 s27, 0x20000
    s_mov_b32 s30, 147456
    s_mov_b32 s31, 0x20000
    s_mov_b32 s34, 147456
    s_mov_b32 s35, 0x20000
    s_mov_b32 s38, 147456
    s_mov_b32 s39, 0x20000
    s_mov_b32 s42, 1152
    s_mov_b32 s43, 0x20000
    s_mov_b32 s46, 1152
    s_mov_b32 s47, 0x20000
    s_mov_b32 s10, 5308416
    s_mov_b32 s11, 0x20000
    s_mov_b32 s14, 5308416
    s_mov_b32 s15, 0x20000
    s_mov_b32 s50, 2359296
    s_mov_b32 s51, 0x20000
    s_mov_b32 s18, 268435456
    s_mov_b32 s19, 0x20000
    s_mul_i32 s23, s20, 9
    s_add_u32 s23, s23, s21
    s_lshl_b32 s59, s23, 8
    buffer_load_ushort v70, v141, s[24:27], s59 offen offset:0
    buffer_load_ushort v71, v141, s[28:31], s59 offen offset:0
    buffer_load_ushort v72, v141, s[32:35], s59 offen offset:0
    buffer_load_ushort v73, v141, s[36:39], s59 offen offset:0
    buffer_load_ushort v74, v141, s[24:27], s59 offen offset:128
    buffer_load_ushort v75, v141, s[28:31], s59 offen offset:128
    buffer_load_ushort v76, v141, s[32:35], s59 offen offset:128
    buffer_load_ushort v77, v141, s[36:39], s59 offen offset:128
    s_lshl_b32 s59, s23, 1
    buffer_load_ushort v78, off, s[40:43], s59
    s_load_dword s22, s[16:17], 0
    s_mul_i32 s52, s21, 17408
    s_and_b32 s57, s20, 3
    s_lshr_b32 s58, s20, 3
    v_mul_u32_u24 v136, 911, v2
    v_lshrrev_b32 v136, 16, v136
    v_mul_u32_u24 v137, 72, v136
    v_sub_u32 v137, v2, v137
    v_mul_u32_u24 v138, 9216, v137
    v_mul_u32_u24 v139, 768, v136
    v_add_u32 v142, v138, v139
    s_mul_i32 s59, s58, 663552
    s_mul_i32 s60, s57, 2304
    s_add_u32 s59, s59, s60
    s_add_u32 s96, s59, 256
    s_mov_b32 s101, s96
    v_lshlrev_b32 v143, 7, v1
    s_mul_i32 s59, s57, 1327104
    s_mul_i32 s60, s58, 165888
    s_add_u32 s97, s59, s60
    s_mul_i32 s59, s21, 41472
    s_add_u32 s97, s97, s59
    s_movk_i32 s100, 128
    s_mov_b32 s92, s8
    s_mov_b32 s93, s9
    s_mov_b32 s94, s10
    s_mov_b32 s95, s11
    v_lshrrev_b32 v136, 3, v1
    v_lshlrev_b32 v136, 6, v136
    v_bfe_u32 v137, v1, 2, 1
    v_lshl_add_u32 v136, v137, 5, v136
    v_and_b32 v137, 3, v1
    v_lshlrev_b32 v137, 3, v137
    v_sub_u32 v136, v136, v137
    v_add_u32 v140, 31, v136
    s_add_u32 s60, s52, 0
    v_add_u32 v136, 0, v140
    v_cvt_f32_u32 v136, v136
    v_cvt_pk_bf16_f32 v136, v136, v136
    v_lshlrev_b32 v136, 16, v136
    v_cvt_u32_f32 v136, v136
    v_lshrrev_b32 v137, 8, v136
    v_add_u32 v138, 12, v137
    v_bfe_u32 v139, v136, 2, 1
    v_lshl_add_u32 v139, v137, 1, v139
    v_cmp_gt_u32 vcc, 0x400, v136
    v_add_u32 v139, 8, v139
    s_nop 0
    v_cndmask_b32 v138, v138, v139, vcc
    v_bfe_u32 v139, v136, 1, 2
    v_cmp_gt_u32 vcc, 0x200, v136
    v_add_u32 v139, 8, v139
    v_and_b32 v137, 7, v136
    v_cndmask_b32 v138, v138, v139, vcc
    v_cmp_gt_u32 vcc, 0x100, v136
    s_nop 1
    v_cndmask_b32 v138, v138, v137, vcc
    v_bfe_u32 v136, v136, 3, 5
    v_lshlrev_b32 v136, 1, v136
    v_lshl_add_u32 v136, v138, 6, v136
    v_add_u32 v4, s60, v136
    v_subrev_u32 v136, 1, v140
    v_cvt_f32_u32 v136, v136
    v_cvt_pk_bf16_f32 v136, v136, v136
    v_lshlrev_b32 v136, 16, v136
    v_cvt_u32_f32 v136, v136
    v_lshrrev_b32 v137, 8, v136
    v_add_u32 v138, 12, v137
    v_bfe_u32 v139, v136, 2, 1
    v_lshl_add_u32 v139, v137, 1, v139
    v_cmp_gt_u32 vcc, 0x400, v136
    v_add_u32 v139, 8, v139
    s_nop 0
    v_cndmask_b32 v138, v138, v139, vcc
    v_bfe_u32 v139, v136, 1, 2
    v_cmp_gt_u32 vcc, 0x200, v136
    v_add_u32 v139, 8, v139
    v_and_b32 v137, 7, v136
    v_cndmask_b32 v138, v138, v139, vcc
    v_cmp_gt_u32 vcc, 0x100, v136
    s_nop 1
    v_cndmask_b32 v138, v138, v137, vcc
    v_bfe_u32 v136, v136, 3, 5
    v_lshlrev_b32 v136, 1, v136
    v_lshl_add_u32 v136, v138, 6, v136
    v_add_u32 v5, s60, v136
    v_subrev_u32 v136, 2, v140
    v_cvt_f32_u32 v136, v136
    v_cvt_pk_bf16_f32 v136, v136, v136
    v_lshlrev_b32 v136, 16, v136
    v_cvt_u32_f32 v136, v136
    v_lshrrev_b32 v137, 8, v136
    v_add_u32 v138, 12, v137
    v_bfe_u32 v139, v136, 2, 1
    v_lshl_add_u32 v139, v137, 1, v139
    v_cmp_gt_u32 vcc, 0x400, v136
    v_add_u32 v139, 8, v139
    s_nop 0
    v_cndmask_b32 v138, v138, v139, vcc
    v_bfe_u32 v139, v136, 1, 2
    v_cmp_gt_u32 vcc, 0x200, v136
    v_add_u32 v139, 8, v139
    v_and_b32 v137, 7, v136
    v_cndmask_b32 v138, v138, v139, vcc
    v_cmp_gt_u32 vcc, 0x100, v136
    s_nop 1
    v_cndmask_b32 v138, v138, v137, vcc
    v_bfe_u32 v136, v136, 3, 5
    v_lshlrev_b32 v136, 1, v136
    v_lshl_add_u32 v136, v138, 6, v136
    v_add_u32 v6, s60, v136
    v_subrev_u32 v136, 3, v140
    v_cvt_f32_u32 v136, v136
    v_cvt_pk_bf16_f32 v136, v136, v136
    v_lshlrev_b32 v136, 16, v136
    v_cvt_u32_f32 v136, v136
    v_lshrrev_b32 v137, 8, v136
    v_add_u32 v138, 12, v137
    v_bfe_u32 v139, v136, 2, 1
    v_lshl_add_u32 v139, v137, 1, v139
    v_cmp_gt_u32 vcc, 0x400, v136
    v_add_u32 v139, 8, v139
    s_nop 0
    v_cndmask_b32 v138, v138, v139, vcc
    v_bfe_u32 v139, v136, 1, 2
    v_cmp_gt_u32 vcc, 0x200, v136
    v_add_u32 v139, 8, v139
    v_and_b32 v137, 7, v136
    v_cndmask_b32 v138, v138, v139, vcc
    v_cmp_gt_u32 vcc, 0x100, v136
    s_nop 1
    v_cndmask_b32 v138, v138, v137, vcc
    v_bfe_u32 v136, v136, 3, 5
    v_lshlrev_b32 v136, 1, v136
    v_lshl_add_u32 v136, v138, 6, v136
    v_add_u32 v7, s60, v136
    v_subrev_u32 v136, 4, v140
    v_cvt_f32_u32 v136, v136
    v_cvt_pk_bf16_f32 v136, v136, v136
    v_lshlrev_b32 v136, 16, v136
    v_cvt_u32_f32 v136, v136
    v_lshrrev_b32 v137, 8, v136
    v_add_u32 v138, 12, v137
    v_bfe_u32 v139, v136, 2, 1
    v_lshl_add_u32 v139, v137, 1, v139
    v_cmp_gt_u32 vcc, 0x400, v136
    v_add_u32 v139, 8, v139
    s_nop 0
    v_cndmask_b32 v138, v138, v139, vcc
    v_bfe_u32 v139, v136, 1, 2
    v_cmp_gt_u32 vcc, 0x200, v136
    v_add_u32 v139, 8, v139
    v_and_b32 v137, 7, v136
    v_cndmask_b32 v138, v138, v139, vcc
    v_cmp_gt_u32 vcc, 0x100, v136
    s_nop 1
    v_cndmask_b32 v138, v138, v137, vcc
    v_bfe_u32 v136, v136, 3, 5
    v_lshlrev_b32 v136, 1, v136
    v_lshl_add_u32 v136, v138, 6, v136
    v_add_u32 v8, s60, v136
    v_subrev_u32 v136, 5, v140
    v_cvt_f32_u32 v136, v136
    v_cvt_pk_bf16_f32 v136, v136, v136
    v_lshlrev_b32 v136, 16, v136
    v_cvt_u32_f32 v136, v136
    v_lshrrev_b32 v137, 8, v136
    v_add_u32 v138, 12, v137
    v_bfe_u32 v139, v136, 2, 1
    v_lshl_add_u32 v139, v137, 1, v139
    v_cmp_gt_u32 vcc, 0x400, v136
    v_add_u32 v139, 8, v139
    s_nop 0
    v_cndmask_b32 v138, v138, v139, vcc
    v_bfe_u32 v139, v136, 1, 2
    v_cmp_gt_u32 vcc, 0x200, v136
    v_add_u32 v139, 8, v139
    v_and_b32 v137, 7, v136
    v_cndmask_b32 v138, v138, v139, vcc
    v_cmp_gt_u32 vcc, 0x100, v136
    s_nop 1
    v_cndmask_b32 v138, v138, v137, vcc
    v_bfe_u32 v136, v136, 3, 5
    v_lshlrev_b32 v136, 1, v136
    v_lshl_add_u32 v136, v138, 6, v136
    v_add_u32 v9, s60, v136
    v_subrev_u32 v136, 6, v140
    v_cvt_f32_u32 v136, v136
    v_cvt_pk_bf16_f32 v136, v136, v136
    v_lshlrev_b32 v136, 16, v136
    v_cvt_u32_f32 v136, v136
    v_lshrrev_b32 v137, 8, v136
    v_add_u32 v138, 12, v137
    v_bfe_u32 v139, v136, 2, 1
    v_lshl_add_u32 v139, v137, 1, v139
    v_cmp_gt_u32 vcc, 0x400, v136
    v_add_u32 v139, 8, v139
    s_nop 0
    v_cndmask_b32 v138, v138, v139, vcc
    v_bfe_u32 v139, v136, 1, 2
    v_cmp_gt_u32 vcc, 0x200, v136
    v_add_u32 v139, 8, v139
    v_and_b32 v137, 7, v136
    v_cndmask_b32 v138, v138, v139, vcc
    v_cmp_gt_u32 vcc, 0x100, v136
    s_nop 1
    v_cndmask_b32 v138, v138, v137, vcc
    v_bfe_u32 v136, v136, 3, 5
    v_lshlrev_b32 v136, 1, v136
    v_lshl_add_u32 v136, v138, 6, v136
    v_add_u32 v10, s60, v136
    v_subrev_u32 v136, 7, v140
    v_cvt_f32_u32 v136, v136
    v_cvt_pk_bf16_f32 v136, v136, v136
    v_lshlrev_b32 v136, 16, v136
    v_cvt_u32_f32 v136, v136
    v_lshrrev_b32 v137, 8, v136
    v_add_u32 v138, 12, v137
    v_bfe_u32 v139, v136, 2, 1
    v_lshl_add_u32 v139, v137, 1, v139
    v_cmp_gt_u32 vcc, 0x400, v136
    v_add_u32 v139, 8, v139
    s_nop 0
    v_cndmask_b32 v138, v138, v139, vcc
    v_bfe_u32 v139, v136, 1, 2
    v_cmp_gt_u32 vcc, 0x200, v136
    v_add_u32 v139, 8, v139
    v_and_b32 v137, 7, v136
    v_cndmask_b32 v138, v138, v139, vcc
    v_cmp_gt_u32 vcc, 0x100, v136
    s_nop 1
    v_cndmask_b32 v138, v138, v137, vcc
    v_bfe_u32 v136, v136, 3, 5
    v_lshlrev_b32 v136, 1, v136
    v_lshl_add_u32 v136, v138, 6, v136
    v_add_u32 v11, s60, v136
    v_add_u32 v136, 505, v140
    v_cvt_f32_u32 v136, v136
    v_cvt_pk_bf16_f32 v136, v136, v136
    v_lshlrev_b32 v136, 16, v136
    v_cvt_u32_f32 v136, v136
    v_lshrrev_b32 v137, 8, v136
    v_add_u32 v138, 12, v137
    v_bfe_u32 v139, v136, 2, 1
    v_lshl_add_u32 v139, v137, 1, v139
    v_cmp_gt_u32 vcc, 0x400, v136
    v_add_u32 v139, 8, v139
    s_nop 0
    v_cndmask_b32 v138, v138, v139, vcc
    v_bfe_u32 v136, v136, 3, 5
    v_lshlrev_b32 v136, 1, v136
    v_lshl_add_u32 v136, v138, 6, v136
    v_add_u32 v12, s60, v136
    v_add_u32 v136, 509, v140
    v_cvt_f32_u32 v136, v136
    v_cvt_pk_bf16_f32 v136, v136, v136
    v_lshlrev_b32 v136, 16, v136
    v_cvt_u32_f32 v136, v136
    v_lshrrev_b32 v137, 8, v136
    v_add_u32 v138, 12, v137
    v_bfe_u32 v139, v136, 2, 1
    v_lshl_add_u32 v139, v137, 1, v139
    v_cmp_gt_u32 vcc, 0x400, v136
    v_add_u32 v139, 8, v139
    s_nop 0
    v_cndmask_b32 v138, v138, v139, vcc
    v_bfe_u32 v136, v136, 3, 5
    v_lshlrev_b32 v136, 1, v136
    v_lshl_add_u32 v136, v138, 6, v136
    v_add_u32 v13, s60, v136
    v_add_u32 v136, 512, v140
    v_cvt_f32_u32 v136, v136
    v_cvt_pk_bf16_f32 v136, v136, v136
    v_lshlrev_b32 v136, 16, v136
    v_cvt_u32_f32 v136, v136
    v_lshrrev_b32 v137, 8, v136
    v_add_u32 v138, 12, v137
    v_bfe_u32 v139, v136, 2, 1
    v_lshl_add_u32 v139, v137, 1, v139
    v_cmp_gt_u32 vcc, 0x400, v136
    v_add_u32 v139, 8, v139
    s_nop 0
    v_cndmask_b32 v138, v138, v139, vcc
    v_bfe_u32 v136, v136, 3, 5
    v_lshlrev_b32 v136, 1, v136
    v_lshl_add_u32 v136, v138, 6, v136
    v_add_u32 v14, s60, v136
    v_add_u32 v136, 1017, v140
    v_cvt_f32_u32 v136, v136
    v_cvt_pk_bf16_f32 v136, v136, v136
    v_lshlrev_b32 v136, 16, v136
    v_cvt_u32_f32 v136, v136
    v_lshrrev_b32 v137, 8, v136
    v_add_u32 v138, 12, v137
    v_bfe_u32 v136, v136, 3, 5
    v_lshlrev_b32 v136, 1, v136
    v_lshl_add_u32 v136, v138, 6, v136
    v_add_u32 v15, s60, v136
    v_add_u32 v136, 1024, v140
    v_cvt_f32_u32 v136, v136
    v_cvt_pk_bf16_f32 v136, v136, v136
    v_lshlrev_b32 v136, 16, v136
    v_cvt_u32_f32 v136, v136
    v_lshrrev_b32 v137, 8, v136
    v_add_u32 v138, 12, v137
    v_bfe_u32 v136, v136, 3, 5
    v_lshlrev_b32 v136, 1, v136
    v_lshl_add_u32 v136, v138, 6, v136
    v_add_u32 v16, s60, v136
    v_add_u32 v136, 1529, v140
    v_cvt_f32_u32 v136, v136
    v_cvt_pk_bf16_f32 v136, v136, v136
    v_lshlrev_b32 v136, 16, v136
    v_cvt_u32_f32 v136, v136
    v_lshrrev_b32 v137, 8, v136
    v_add_u32 v138, 12, v137
    v_bfe_u32 v136, v136, 3, 5
    v_lshlrev_b32 v136, 1, v136
    v_lshl_add_u32 v136, v138, 6, v136
    v_add_u32 v17, s60, v136
    v_add_u32 v136, 1536, v140
    v_cvt_f32_u32 v136, v136
    v_cvt_pk_bf16_f32 v136, v136, v136
    v_lshlrev_b32 v136, 16, v136
    v_cvt_u32_f32 v136, v136
    v_lshrrev_b32 v137, 8, v136
    v_add_u32 v138, 12, v137
    v_bfe_u32 v136, v136, 3, 5
    v_lshlrev_b32 v136, 1, v136
    v_lshl_add_u32 v136, v138, 6, v136
    v_add_u32 v18, s60, v136
    v_and_b32 v136, 1, v1
    v_cmp_eq_u32 s[98:99], 0, v136
    v_bfe_u32 v136, v1, 1, 2
    v_lshlrev_b32 v136, 4, v136
    v_lshl_add_u32 v136, v1, 6, v136
    v_add_u32 v53, s60, v136
    v_xor_b32 v54, 16, v53
    v_xor_b32 v55, 32, v53
    v_xor_b32 v56, 48, v53
    v_mul_u32_u24 v136, 48, v1
    s_add_u32 s59, s52, 8192
    v_add_u32 v57, s59, v136
    v_bfe_u32 v136, v1, 2, 2
    v_lshrrev_b32 v137, 5, v1
    v_lshl_add_u32 v137, v137, 3, v136
    v_bfe_u32 v138, v1, 4, 1
    v_and_b32 v139, 3, v1
    v_mul_u32_u24 v140, 48, v137
    v_lshl_add_u32 v140, v138, 5, v140
    v_lshl_add_u32 v140, v139, 3, v140
    v_add_u32 v58, s59, v140
    v_lshlrev_b32 v140, 1, v138
    v_lshrrev_b32 v138, 1, v139
    v_or_b32 v140, v140, v138
    v_lshrrev_b32 v136, 1, v136
    v_xor_b32 v140, v140, v136
    v_and_b32 v139, 1, v139
    v_lshlrev_b32 v139, 3, v139
    v_lshl_add_u32 v139, v137, 6, v139
    v_lshl_add_u32 v138, v140, 4, v139
    v_add_u32 v59, s60, v138
    v_xor_b32 v140, 2, v140
    v_lshl_add_u32 v138, v140, 4, v139
    v_add_u32 v60, s60, v138
    v_and_b32 v136, 31, v1
    v_lshrrev_b32 v137, 5, v1
    v_lshlrev_b32 v137, 8, v137
    v_lshl_add_u32 v136, v136, 1, v137
    v_add_u32 v61, s60, v136
    v_lshrrev_b32 v136, 3, v1
    v_add_u32 v136, 15, v136
    v_mul_u32_u24 v136, 160, v136
    v_and_b32 v137, 7, v1
    v_lshl_add_u32 v62, v137, 4, v136
    v_lshlrev_b32 v69, 4, v1
    v_add_u32 v136, 0, v1
    v_mul_u32_u24 v137, 3913, v136
    v_lshrrev_b32 v137, 20, v137
    v_mul_u32_u24 v138, 268, v137
    v_sub_u32 v138, v136, v138
    v_lshlrev_b32 v138, 4, v138
    v_lshl_add_u32 v138, v137, 1, v138
    v_add_u32 v36, 65536, v138
    v_add_u32 v136, 64, v1
    v_mul_u32_u24 v137, 3913, v136
    v_lshrrev_b32 v137, 20, v137
    v_mul_u32_u24 v138, 268, v137
    v_sub_u32 v138, v136, v138
    v_lshlrev_b32 v138, 4, v138
    v_lshl_add_u32 v138, v137, 1, v138
    v_add_u32 v37, 64512, v138
    v_add_u32 v136, 128, v1
    v_mul_u32_u24 v137, 3913, v136
    v_lshrrev_b32 v137, 20, v137
    v_mul_u32_u24 v138, 268, v137
    v_sub_u32 v138, v136, v138
    v_lshlrev_b32 v138, 4, v138
    v_lshl_add_u32 v138, v137, 1, v138
    v_add_u32 v38, 63488, v138
    v_add_u32 v136, 192, v1
    v_mul_u32_u24 v137, 3913, v136
    v_lshrrev_b32 v137, 20, v137
    v_mul_u32_u24 v138, 268, v137
    v_sub_u32 v138, v136, v138
    v_lshlrev_b32 v138, 4, v138
    v_lshl_add_u32 v138, v137, 1, v138
    v_add_u32 v39, 62464, v138
    v_add_u32 v136, 256, v1
    v_mul_u32_u24 v137, 3913, v136
    v_lshrrev_b32 v137, 20, v137
    v_mul_u32_u24 v138, 268, v137
    v_sub_u32 v138, v136, v138
    v_lshlrev_b32 v138, 4, v138
    v_lshl_add_u32 v138, v137, 1, v138
    v_add_u32 v40, 65536, v138
    v_add_u32 v136, 320, v1
    v_mul_u32_u24 v137, 3913, v136
    v_lshrrev_b32 v137, 20, v137
    v_mul_u32_u24 v138, 268, v137
    v_sub_u32 v138, v136, v138
    v_lshlrev_b32 v138, 4, v138
    v_lshl_add_u32 v138, v137, 1, v138
    v_add_u32 v41, 64512, v138
    v_add_u32 v136, 384, v1
    v_mul_u32_u24 v137, 3913, v136
    v_lshrrev_b32 v137, 20, v137
    v_mul_u32_u24 v138, 268, v137
    v_sub_u32 v138, v136, v138
    v_lshlrev_b32 v138, 4, v138
    v_lshl_add_u32 v138, v137, 1, v138
    v_add_u32 v42, 63488, v138
    v_add_u32 v136, 448, v1
    v_mul_u32_u24 v137, 3913, v136
    v_lshrrev_b32 v137, 20, v137
    v_mul_u32_u24 v138, 268, v137
    v_sub_u32 v138, v136, v138
    v_lshlrev_b32 v138, 4, v138
    v_lshl_add_u32 v138, v137, 1, v138
    v_add_u32 v43, 62464, v138
    v_add_u32 v136, 512, v1
    v_mul_u32_u24 v137, 3913, v136
    v_lshrrev_b32 v137, 20, v137
    v_mul_u32_u24 v138, 268, v137
    v_sub_u32 v138, v136, v138
    v_lshlrev_b32 v138, 4, v138
    v_lshl_add_u32 v138, v137, 1, v138
    v_add_u32 v44, 65536, v138
    v_add_u32 v136, 576, v1
    v_mul_u32_u24 v137, 3913, v136
    v_lshrrev_b32 v137, 20, v137
    v_mul_u32_u24 v138, 268, v137
    v_sub_u32 v138, v136, v138
    v_lshlrev_b32 v138, 4, v138
    v_lshl_add_u32 v138, v137, 1, v138
    v_add_u32 v45, 64512, v138
    v_add_u32 v136, 640, v1
    v_mul_u32_u24 v137, 3913, v136
    v_lshrrev_b32 v137, 20, v137
    v_mul_u32_u24 v138, 268, v137
    v_sub_u32 v138, v136, v138
    v_lshlrev_b32 v138, 4, v138
    v_lshl_add_u32 v138, v137, 1, v138
    v_add_u32 v46, 63488, v138
    v_add_u32 v136, 704, v1
    v_mul_u32_u24 v137, 3913, v136
    v_lshrrev_b32 v137, 20, v137
    v_mul_u32_u24 v138, 268, v137
    v_sub_u32 v138, v136, v138
    v_lshlrev_b32 v138, 4, v138
    v_lshl_add_u32 v138, v137, 1, v138
    v_add_u32 v47, 62464, v138
    v_add_u32 v136, 768, v1
    v_mul_u32_u24 v137, 3913, v136
    v_lshrrev_b32 v137, 20, v137
    v_mul_u32_u24 v138, 268, v137
    v_sub_u32 v138, v136, v138
    v_lshlrev_b32 v138, 4, v138
    v_lshl_add_u32 v138, v137, 1, v138
    v_add_u32 v48, 65536, v138
    v_add_u32 v136, 832, v1
    v_mul_u32_u24 v137, 3913, v136
    v_lshrrev_b32 v137, 20, v137
    v_mul_u32_u24 v138, 268, v137
    v_sub_u32 v138, v136, v138
    v_lshlrev_b32 v138, 4, v138
    v_lshl_add_u32 v138, v137, 1, v138
    v_add_u32 v49, 64512, v138
    v_add_u32 v136, 896, v1
    v_mul_u32_u24 v137, 3913, v136
    v_lshrrev_b32 v137, 20, v137
    v_mul_u32_u24 v138, 268, v137
    v_sub_u32 v138, v136, v138
    v_lshlrev_b32 v138, 4, v138
    v_lshl_add_u32 v138, v137, 1, v138
    v_add_u32 v50, 63488, v138
    v_add_u32 v136, 960, v1
    v_mul_u32_u24 v137, 3913, v136
    v_lshrrev_b32 v137, 20, v137
    v_mul_u32_u24 v138, 268, v137
    v_sub_u32 v138, v136, v138
    v_lshlrev_b32 v138, 4, v138
    v_lshl_add_u32 v138, v137, 1, v138
    v_add_u32 v51, 62464, v138
    v_add_u32 v136, 1024, v1
    v_mul_u32_u24 v137, 3913, v136
    v_lshrrev_b32 v137, 20, v137
    v_mul_u32_u24 v138, 268, v137
    v_sub_u32 v138, v136, v138
    v_lshlrev_b32 v138, 4, v138
    v_lshl_add_u32 v138, v137, 1, v138
    v_add_u32 v52, 65536, v138
    v_and_b32 v136, 15, v1
    v_lshrrev_b32 v137, 4, v1
    v_add_u32 v138, 1, v136
    v_and_b32 v138, 3, v138
    v_mul_u32_u24 v139, 4288, v138
    v_lshl_add_u32 v140, v137, 3, v136
    v_add_u32 v140, 33, v140
    v_sub_u32 v140, v140, v138
    v_lshl_add_u32 v139, v140, 1, v139
    v_subrev_u32 v63, 64, v139
    v_add_u32 v138, 15, v136
    v_mul_u32_u24 v138, 160, v138
    v_lshl_add_u32 v138, v137, 4, v138
    v_subrev_u32 v64, 480, v138
    v_mul_u32_u24 v138, 144, v136
    v_lshl_add_u32 v67, v137, 3, v138
    v_lshrrev_b32 v136, 3, v1
    v_mul_u32_u24 v136, 144, v136
    v_and_b32 v137, 7, v1
    v_lshl_add_u32 v68, v137, 4, v136
    s_waitcnt lgkmcnt(0)
    s_mul_i32 s22, s22, 1664525
    s_add_u32 s22, s22, 1013904223
    v_mov_b32 v192, 0
    v_mov_b32 v193, 0
    v_mov_b32 v194, 0
    v_mov_b32 v195, 0
    s_mul_i32 s59, s21, 15040
    s_add_u32 s59, s59, 87040
    v_add_u32 v136, s59, v69
    ds_write_b128 v136, v[192:195] offset:0
    ds_write_b128 v136, v[192:195] offset:1024
    ds_write_b128 v136, v[192:195] offset:2048
    ds_write_b128 v136, v[192:195] offset:7520
    ds_write_b128 v136, v[192:195] offset:8544
    ds_write_b128 v136, v[192:195] offset:9568
    v_add_u32 v136, 147200, v69
    ds_write_b128 v136, v[192:195] offset:0
    ds_write_b128 v136, v[192:195] offset:1024
    ds_write_b128 v136, v[192:195] offset:2048
    s_lshl_b32 s56, s21, 1
    s_mul_i32 s56, s56, 7520
    s_add_u32 s56, s56, 87040
    s_mov_b32 s83, 0
    s_waitcnt vmcnt(0)
    s_waitcnt lgkmcnt(0)
L_kgen:
    s_add_u32 s84, s23, 4
    s_mul_i32 s85, s20, 9
    s_add_u32 s85, s85, 8
    s_cmp_eq_u32 s83, 0
    s_cselect_b32 s84, s84, s85
    s_and_b32 s86, s21, 1
    s_lshl_b32 s86, s86, 7
    s_cmp_eq_u32 s83, 0
    s_cselect_b32 s86, 0, s86
    s_lshl_b32 s59, s84, 8
    s_add_u32 s59, s59, s86
    buffer_load_ushort v79, v141, s[24:27], s59 offen offset:0
    buffer_load_ushort v80, v141, s[28:31], s59 offen offset:0
    buffer_load_ushort v81, v141, s[32:35], s59 offen offset:0
    buffer_load_ushort v82, v141, s[36:39], s59 offen offset:0
    buffer_load_ushort v83, v141, s[24:27], s59 offen offset:128
    buffer_load_ushort v84, v141, s[28:31], s59 offen offset:128
    buffer_load_ushort v85, v141, s[32:35], s59 offen offset:128
    buffer_load_ushort v86, v141, s[36:39], s59 offen offset:128
    s_lshl_b32 s59, s84, 1
    buffer_load_ushort v87, off, s[40:43], s59
    s_mov_b32 s57, 0x3fb8aa3b
    s_mov_b32 s58, 0x32a5705f
    v_lshlrev_b32 v136, 16, v78
    v_mul_f32 v138, 0x3fb8aa3b, v136
    v_fma_f32 v139, v136, s57, -v138
    v_fma_f32 v139, v136, s58, v139
    v_exp_f32 v88, v138
    v_mul_f32 v139, 0x3f317218, v139
    v_min_f32 v88, 0x7f7fffff, v88
    v_fma_f32 v88, v88, v139, v88
    v_cvt_pk_bf16_f32 v88, v88, v88
    v_lshlrev_b32 v88, 16, v88
    v_lshlrev_b32 v240, 16, v70
    v_mul_f32 v242, 0x3fb8aa3b, v240
    v_fma_f32 v243, v240, s57, -v242
    v_fma_f32 v243, v240, s58, v243
    v_exp_f32 v241, v242
    v_mul_f32 v243, 0x3f317218, v243
    v_min_f32 v241, 0x7f7fffff, v241
    v_fma_f32 v241, v241, v243, v241
    v_cvt_pk_bf16_f32 v241, v241, v241
    v_lshlrev_b32 v241, 16, v241
    v_mul_f32 v241, v241, v88
    v_mul_f32 v241, 0xbfb8aa3b, v241
    v_lshlrev_b32 v242, 16, v71
    v_mul_f32 v242, v242, v88
    v_mul_f32 v242, 0.15915494, v242
    v_lshlrev_b32 v100, 16, v72
    v_lshlrev_b32 v101, 16, v73
    v_mul_f32 v100, v100, v88
    v_mul_f32 v101, v101, v88
    v_add_f32 v100, v100, v100
    v_add_f32 v101, v101, v101
    v_mul_f32 v243, 0x41000000, v241
    v_mul_f32 v244, 0x41000000, v242
    v_exp_f32 v243, v243
    v_fract_f32 v244, v244
    v_cos_f32 v92, v244
    v_sin_f32 v93, v244
    s_nop 0
    v_mul_f32 v92, v92, v243
    v_mul_f32 v93, v93, v243
    v_mov_b32 v243, v241
    v_mov_b32 v244, v242
    v_exp_f32 v243, v243
    v_fract_f32 v244, v244
    v_cos_f32 v90, v244
    v_sin_f32 v91, v244
    s_nop 0
    v_mul_f32 v90, v90, v243
    v_mul_f32 v91, v91, v243
    v_mul_f32 v243, 0x43800000, v241
    v_mul_f32 v244, 0x43800000, v242
    v_exp_f32 v243, v243
    v_fract_f32 v244, v244
    v_cos_f32 v94, v244
    v_sin_f32 v95, v244
    s_nop 0
    v_mul_f32 v94, v94, v243
    v_mul_f32 v95, v95, v243
    buffer_load_dword a250, v142, s[92:95], s96 offen
    s_add_u32 s96, s96, s100
    v_mov_b32 v104, 1.0
    v_mov_b32 v208, v100
    v_mov_b32 v105, 0
    v_mov_b32 v209, v101
    v_mov_b32 v106, v92
    v_pk_mul_f32 v[210:211], v[208:209], v[90:91] op_sel:[0,0] op_sel_hi:[0,1]
    v_mov_b32 v107, v93
    v_pk_mul_f32 v[108:109], v[106:107], v[92:93] op_sel:[0,0] op_sel_hi:[0,1]
    v_pk_fma_f32 v[210:211], v[208:209], v[90:91], v[210:211] op_sel:[1,1,0] op_sel_hi:[1,0,1] neg_lo:[0,1,0]
    v_pk_fma_f32 v[108:109], v[106:107], v[92:93], v[108:109] op_sel:[1,1,0] op_sel_hi:[1,0,1] neg_lo:[0,1,0]
    v_pk_mul_f32 v[212:213], v[210:211], v[90:91] op_sel:[0,0] op_sel_hi:[0,1]
    v_pk_mul_f32 v[110:111], v[108:109], v[92:93] op_sel:[0,0] op_sel_hi:[0,1]
    v_pk_fma_f32 v[212:213], v[210:211], v[90:91], v[212:213] op_sel:[1,1,0] op_sel_hi:[1,0,1] neg_lo:[0,1,0]
    v_pk_fma_f32 v[110:111], v[108:109], v[92:93], v[110:111] op_sel:[1,1,0] op_sel_hi:[1,0,1] neg_lo:[0,1,0]
    v_pk_mul_f32 v[112:113], v[110:111], v[92:93] op_sel:[0,0] op_sel_hi:[0,1]
    v_pk_mul_f32 v[214:215], v[212:213], v[90:91] op_sel:[0,0] op_sel_hi:[0,1]
    v_pk_fma_f32 v[112:113], v[110:111], v[92:93], v[112:113] op_sel:[1,1,0] op_sel_hi:[1,0,1] neg_lo:[0,1,0]
    v_pk_fma_f32 v[214:215], v[212:213], v[90:91], v[214:215] op_sel:[1,1,0] op_sel_hi:[1,0,1] neg_lo:[0,1,0]
    v_pk_mul_f32 v[114:115], v[112:113], v[92:93] op_sel:[0,0] op_sel_hi:[0,1]
    v_pk_mul_f32 v[216:217], v[214:215], v[90:91] op_sel:[0,0] op_sel_hi:[0,1]
    v_pk_fma_f32 v[114:115], v[112:113], v[92:93], v[114:115] op_sel:[1,1,0] op_sel_hi:[1,0,1] neg_lo:[0,1,0]
    v_pk_mul_f32 v[116:117], v[114:115], v[92:93] op_sel:[0,0] op_sel_hi:[0,1]
    v_pk_fma_f32 v[216:217], v[214:215], v[90:91], v[216:217] op_sel:[1,1,0] op_sel_hi:[1,0,1] neg_lo:[0,1,0]
    v_pk_fma_f32 v[116:117], v[114:115], v[92:93], v[116:117] op_sel:[1,1,0] op_sel_hi:[1,0,1] neg_lo:[0,1,0]
    v_pk_mul_f32 v[218:219], v[216:217], v[90:91] op_sel:[0,0] op_sel_hi:[0,1]
    v_pk_mul_f32 v[118:119], v[116:117], v[92:93] op_sel:[0,0] op_sel_hi:[0,1]
    v_pk_fma_f32 v[118:119], v[116:117], v[92:93], v[118:119] op_sel:[1,1,0] op_sel_hi:[1,0,1] neg_lo:[0,1,0]
    v_pk_fma_f32 v[218:219], v[216:217], v[90:91], v[218:219] op_sel:[1,1,0] op_sel_hi:[1,0,1] neg_lo:[0,1,0]
    v_cvt_pk_bf16_f32 v120, v104, v106
    v_pk_mul_f32 v[220:221], v[218:219], v[90:91] op_sel:[0,0] op_sel_hi:[0,1]
    v_cvt_pk_bf16_f32 v121, v108, v110
    v_pk_fma_f32 v[220:221], v[218:219], v[90:91], v[220:221] op_sel:[1,1,0] op_sel_hi:[1,0,1] neg_lo:[0,1,0]
    v_cvt_pk_bf16_f32 v122, v112, v114
    v_cvt_pk_bf16_f32 v123, v116, v118
    v_pk_mul_f32 v[222:223], v[220:221], v[90:91] op_sel:[0,0] op_sel_hi:[0,1]
    ds_write_b128 v53, v[120:123] offset:0
    v_pk_fma_f32 v[222:223], v[220:221], v[90:91], v[222:223] op_sel:[1,1,0] op_sel_hi:[1,0,1] neg_lo:[0,1,0]
    v_cvt_pk_bf16_f32 v124, v105, v107
    v_pk_mul_f32 v[96:97], v[90:91], v[90:91] op_sel:[0,0] op_sel_hi:[0,1]
    v_cvt_pk_bf16_f32 v125, v109, v111
    v_cvt_pk_bf16_f32 v126, v113, v115
    v_pk_fma_f32 v[96:97], v[90:91], v[90:91], v[96:97] op_sel:[1,1,0] op_sel_hi:[1,0,1] neg_lo:[0,1,0]
    v_cvt_pk_bf16_f32 v127, v117, v119
    v_pk_mul_f32 v[98:99], v[96:97], v[96:97] op_sel:[0,0] op_sel_hi:[0,1]
    ds_write_b128 v53, v[124:127] offset:4096
    v_pk_mul_f32 v[104:105], v[118:119], v[92:93] op_sel:[0,0] op_sel_hi:[0,1]
    v_pk_fma_f32 v[98:99], v[96:97], v[96:97], v[98:99] op_sel:[1,1,0] op_sel_hi:[1,0,1] neg_lo:[0,1,0]
    v_pk_fma_f32 v[104:105], v[118:119], v[92:93], v[104:105] op_sel:[1,1,0] op_sel_hi:[1,0,1] neg_lo:[0,1,0]
    v_cvt_pk_bf16_f32 v224, v208, v210
    v_pk_mul_f32 v[106:107], v[104:105], v[92:93] op_sel:[0,0] op_sel_hi:[0,1]
    v_cvt_pk_bf16_f32 v225, v212, v214
    v_pk_fma_f32 v[106:107], v[104:105], v[92:93], v[106:107] op_sel:[1,1,0] op_sel_hi:[1,0,1] neg_lo:[0,1,0]
    v_pk_mul_f32 v[108:109], v[106:107], v[92:93] op_sel:[0,0] op_sel_hi:[0,1]
    v_cvt_pk_bf16_f32 v226, v216, v218
    v_pk_fma_f32 v[108:109], v[106:107], v[92:93], v[108:109] op_sel:[1,1,0] op_sel_hi:[1,0,1] neg_lo:[0,1,0]
    v_cvt_pk_bf16_f32 v227, v220, v222
    v_pk_mul_f32 v[110:111], v[108:109], v[92:93] op_sel:[0,0] op_sel_hi:[0,1]
    ds_write_b128 v57, v[224:227] offset:0
    v_pk_fma_f32 v[110:111], v[108:109], v[92:93], v[110:111] op_sel:[1,1,0] op_sel_hi:[1,0,1] neg_lo:[0,1,0]
    v_pk_mul_f32 v[112:113], v[110:111], v[92:93] op_sel:[0,0] op_sel_hi:[0,1]
    v_cvt_pk_bf16_f32 v228, -v209, -v211
    v_pk_fma_f32 v[112:113], v[110:111], v[92:93], v[112:113] op_sel:[1,1,0] op_sel_hi:[1,0,1] neg_lo:[0,1,0]
    v_cvt_pk_bf16_f32 v229, -v213, -v215
    v_pk_mul_f32 v[114:115], v[112:113], v[92:93] op_sel:[0,0] op_sel_hi:[0,1]
    v_cvt_pk_bf16_f32 v230, -v217, -v219
    v_pk_fma_f32 v[114:115], v[112:113], v[92:93], v[114:115] op_sel:[1,1,0] op_sel_hi:[1,0,1] neg_lo:[0,1,0]
    v_pk_mul_f32 v[116:117], v[114:115], v[92:93] op_sel:[0,0] op_sel_hi:[0,1]
    v_cvt_pk_bf16_f32 v231, -v221, -v223
    v_pk_fma_f32 v[116:117], v[114:115], v[92:93], v[116:117] op_sel:[1,1,0] op_sel_hi:[1,0,1] neg_lo:[0,1,0]
    ds_write_b128 v57, v[228:231] offset:3072
    v_pk_mul_f32 v[118:119], v[116:117], v[92:93] op_sel:[0,0] op_sel_hi:[0,1]
    v_pk_fma_f32 v[118:119], v[116:117], v[92:93], v[118:119] op_sel:[1,1,0] op_sel_hi:[1,0,1] neg_lo:[0,1,0]
    v_pk_mul_f32 v[208:209], v[100:101], v[94:95] op_sel:[0,0] op_sel_hi:[0,1]
    v_cvt_pk_bf16_f32 v128, v104, v106
    v_pk_fma_f32 v[208:209], v[100:101], v[94:95], v[208:209] op_sel:[1,1,0] op_sel_hi:[1,0,1] neg_lo:[0,1,0]
    v_cvt_pk_bf16_f32 v129, v108, v110
    v_pk_mul_f32 v[210:211], v[208:209], v[96:97] op_sel:[0,0] op_sel_hi:[0,1]
    v_cvt_pk_bf16_f32 v130, v112, v114
    v_cvt_pk_bf16_f32 v131, v116, v118
    v_pk_fma_f32 v[210:211], v[208:209], v[96:97], v[210:211] op_sel:[1,1,0] op_sel_hi:[1,0,1] neg_lo:[0,1,0]
    ds_write_b128 v54, v[128:131] offset:0
    v_pk_mul_f32 v[212:213], v[210:211], v[96:97] op_sel:[0,0] op_sel_hi:[0,1]
    v_cvt_pk_bf16_f32 v132, v105, v107
    v_pk_fma_f32 v[212:213], v[210:211], v[96:97], v[212:213] op_sel:[1,1,0] op_sel_hi:[1,0,1] neg_lo:[0,1,0]
    v_cvt_pk_bf16_f32 v133, v109, v111
    v_cvt_pk_bf16_f32 v134, v113, v115
    v_pk_mul_f32 v[214:215], v[212:213], v[96:97] op_sel:[0,0] op_sel_hi:[0,1]
    v_cvt_pk_bf16_f32 v135, v117, v119
    v_pk_fma_f32 v[214:215], v[212:213], v[96:97], v[214:215] op_sel:[1,1,0] op_sel_hi:[1,0,1] neg_lo:[0,1,0]
    ds_write_b128 v54, v[132:135] offset:4096
    v_pk_mul_f32 v[104:105], v[118:119], v[92:93] op_sel:[0,0] op_sel_hi:[0,1]
    buffer_load_dword a250, v142, s[92:95], s96 offen
    s_add_u32 s96, s96, s100
    v_pk_mul_f32 v[216:217], v[208:209], v[94:95] op_sel:[0,0] op_sel_hi:[0,1]
    v_pk_fma_f32 v[104:105], v[118:119], v[92:93], v[104:105] op_sel:[1,1,0] op_sel_hi:[1,0,1] neg_lo:[0,1,0]
    v_pk_fma_f32 v[216:217], v[208:209], v[94:95], v[216:217] op_sel:[1,1,0] op_sel_hi:[1,0,1] neg_lo:[0,1,0]
    v_pk_mul_f32 v[106:107], v[104:105], v[92:93] op_sel:[0,0] op_sel_hi:[0,1]
    v_pk_mul_f32 v[218:219], v[216:217], v[98:99] op_sel:[0,0] op_sel_hi:[0,1]
    v_pk_fma_f32 v[106:107], v[104:105], v[92:93], v[106:107] op_sel:[1,1,0] op_sel_hi:[1,0,1] neg_lo:[0,1,0]
    v_pk_mul_f32 v[108:109], v[106:107], v[92:93] op_sel:[0,0] op_sel_hi:[0,1]
    v_pk_fma_f32 v[218:219], v[216:217], v[98:99], v[218:219] op_sel:[1,1,0] op_sel_hi:[1,0,1] neg_lo:[0,1,0]
    v_pk_fma_f32 v[108:109], v[106:107], v[92:93], v[108:109] op_sel:[1,1,0] op_sel_hi:[1,0,1] neg_lo:[0,1,0]
    v_pk_mul_f32 v[220:221], v[216:217], v[94:95] op_sel:[0,0] op_sel_hi:[0,1]
    v_pk_mul_f32 v[110:111], v[108:109], v[92:93] op_sel:[0,0] op_sel_hi:[0,1]
    v_pk_fma_f32 v[220:221], v[216:217], v[94:95], v[220:221] op_sel:[1,1,0] op_sel_hi:[1,0,1] neg_lo:[0,1,0]
    v_pk_fma_f32 v[110:111], v[108:109], v[92:93], v[110:111] op_sel:[1,1,0] op_sel_hi:[1,0,1] neg_lo:[0,1,0]
    v_pk_mul_f32 v[112:113], v[110:111], v[92:93] op_sel:[0,0] op_sel_hi:[0,1]
    v_pk_mul_f32 v[222:223], v[220:221], v[98:99] op_sel:[0,0] op_sel_hi:[0,1]
    v_pk_fma_f32 v[112:113], v[110:111], v[92:93], v[112:113] op_sel:[1,1,0] op_sel_hi:[1,0,1] neg_lo:[0,1,0]
    v_pk_fma_f32 v[222:223], v[220:221], v[98:99], v[222:223] op_sel:[1,1,0] op_sel_hi:[1,0,1] neg_lo:[0,1,0]
    v_pk_mul_f32 v[114:115], v[112:113], v[92:93] op_sel:[0,0] op_sel_hi:[0,1]
    v_cvt_pk_bf16_f32 v232, v208, v210
    v_pk_fma_f32 v[114:115], v[112:113], v[92:93], v[114:115] op_sel:[1,1,0] op_sel_hi:[1,0,1] neg_lo:[0,1,0]
    v_pk_mul_f32 v[116:117], v[114:115], v[92:93] op_sel:[0,0] op_sel_hi:[0,1]
    v_cvt_pk_bf16_f32 v233, v212, v214
    v_pk_fma_f32 v[116:117], v[114:115], v[92:93], v[116:117] op_sel:[1,1,0] op_sel_hi:[1,0,1] neg_lo:[0,1,0]
    v_cvt_pk_bf16_f32 v234, v216, v218
    v_pk_mul_f32 v[118:119], v[116:117], v[92:93] op_sel:[0,0] op_sel_hi:[0,1]
    v_pk_fma_f32 v[118:119], v[116:117], v[92:93], v[118:119] op_sel:[1,1,0] op_sel_hi:[1,0,1] neg_lo:[0,1,0]
    v_cvt_pk_bf16_f32 v235, v220, v222
    v_cvt_pk_bf16_f32 v120, v104, v106
    ds_write_b128 v57, v[232:235] offset:16
    v_cvt_pk_bf16_f32 v121, v108, v110
    v_cvt_pk_bf16_f32 v236, -v209, -v211
    v_cvt_pk_bf16_f32 v122, v112, v114
    v_cvt_pk_bf16_f32 v123, v116, v118
    v_cvt_pk_bf16_f32 v237, -v213, -v215
    ds_write_b128 v55, v[120:123] offset:0
    v_cvt_pk_bf16_f32 v238, -v217, -v219
    v_cvt_pk_bf16_f32 v124, v105, v107
    v_cvt_pk_bf16_f32 v239, -v221, -v223
    v_cvt_pk_bf16_f32 v125, v109, v111
    v_cvt_pk_bf16_f32 v126, v113, v115
    ds_write_b128 v57, v[236:239] offset:3088
    v_cvt_pk_bf16_f32 v127, v117, v119
    v_pk_mul_f32 v[208:209], v[220:221], v[94:95] op_sel:[0,0] op_sel_hi:[0,1]
    ds_write_b128 v55, v[124:127] offset:4096
    v_pk_mul_f32 v[104:105], v[118:119], v[92:93] op_sel:[0,0] op_sel_hi:[0,1]
    v_pk_fma_f32 v[208:209], v[220:221], v[94:95], v[208:209] op_sel:[1,1,0] op_sel_hi:[1,0,1] neg_lo:[0,1,0]
    v_pk_fma_f32 v[104:105], v[118:119], v[92:93], v[104:105] op_sel:[1,1,0] op_sel_hi:[1,0,1] neg_lo:[0,1,0]
    v_pk_mul_f32 v[210:211], v[208:209], v[94:95] op_sel:[0,0] op_sel_hi:[0,1]
    v_pk_mul_f32 v[106:107], v[104:105], v[92:93] op_sel:[0,0] op_sel_hi:[0,1]
    v_pk_fma_f32 v[210:211], v[208:209], v[94:95], v[210:211] op_sel:[1,1,0] op_sel_hi:[1,0,1] neg_lo:[0,1,0]
    v_pk_fma_f32 v[106:107], v[104:105], v[92:93], v[106:107] op_sel:[1,1,0] op_sel_hi:[1,0,1] neg_lo:[0,1,0]
    v_pk_mul_f32 v[108:109], v[106:107], v[92:93] op_sel:[0,0] op_sel_hi:[0,1]
    v_pk_mul_f32 v[212:213], v[210:211], v[94:95] op_sel:[0,0] op_sel_hi:[0,1]
    v_pk_fma_f32 v[108:109], v[106:107], v[92:93], v[108:109] op_sel:[1,1,0] op_sel_hi:[1,0,1] neg_lo:[0,1,0]
    v_pk_fma_f32 v[212:213], v[210:211], v[94:95], v[212:213] op_sel:[1,1,0] op_sel_hi:[1,0,1] neg_lo:[0,1,0]
    v_pk_mul_f32 v[110:111], v[108:109], v[92:93] op_sel:[0,0] op_sel_hi:[0,1]
    v_pk_mul_f32 v[214:215], v[212:213], v[94:95] op_sel:[0,0] op_sel_hi:[0,1]
    v_pk_fma_f32 v[110:111], v[108:109], v[92:93], v[110:111] op_sel:[1,1,0] op_sel_hi:[1,0,1] neg_lo:[0,1,0]
    v_pk_mul_f32 v[112:113], v[110:111], v[92:93] op_sel:[0,0] op_sel_hi:[0,1]
    v_pk_fma_f32 v[214:215], v[212:213], v[94:95], v[214:215] op_sel:[1,1,0] op_sel_hi:[1,0,1] neg_lo:[0,1,0]
    v_pk_fma_f32 v[112:113], v[110:111], v[92:93], v[112:113] op_sel:[1,1,0] op_sel_hi:[1,0,1] neg_lo:[0,1,0]
    v_pk_mul_f32 v[216:217], v[214:215], v[94:95] op_sel:[0,0] op_sel_hi:[0,1]
    v_pk_mul_f32 v[114:115], v[112:113], v[92:93] op_sel:[0,0] op_sel_hi:[0,1]
    v_pk_fma_f32 v[216:217], v[214:215], v[94:95], v[216:217] op_sel:[1,1,0] op_sel_hi:[1,0,1] neg_lo:[0,1,0]
    v_pk_fma_f32 v[114:115], v[112:113], v[92:93], v[114:115] op_sel:[1,1,0] op_sel_hi:[1,0,1] neg_lo:[0,1,0]
    v_pk_mul_f32 v[116:117], v[114:115], v[92:93] op_sel:[0,0] op_sel_hi:[0,1]
    v_cvt_pk_bf16_f32 v224, v208, v210
    v_pk_fma_f32 v[116:117], v[114:115], v[92:93], v[116:117] op_sel:[1,1,0] op_sel_hi:[1,0,1] neg_lo:[0,1,0]
    v_cvt_pk_bf16_f32 v225, v212, v214
    v_pk_mul_f32 v[118:119], v[116:117], v[92:93] op_sel:[0,0] op_sel_hi:[0,1]
    v_pk_fma_f32 v[118:119], v[116:117], v[92:93], v[118:119] op_sel:[1,1,0] op_sel_hi:[1,0,1] neg_lo:[0,1,0]
    v_cvt_pk_bf16_f32 v226, v216, v218
    v_cvt_pk_bf16_f32 v128, v104, v106
    v_cvt_pk_bf16_f32 v227, v220, v222
    v_cvt_pk_bf16_f32 v129, v108, v110
    ds_write_b128 v57, v[224:227] offset:32
    v_cvt_pk_bf16_f32 v130, v112, v114
    v_cvt_pk_bf16_f32 v131, v116, v118
    v_cvt_pk_bf16_f32 v228, -v209, -v211
    ds_write_b128 v56, v[128:131] offset:0
    v_cvt_pk_bf16_f32 v229, -v213, -v215
    v_cvt_pk_bf16_f32 v132, v105, v107
    v_cvt_pk_bf16_f32 v230, -v217, -v219
    v_cvt_pk_bf16_f32 v133, v109, v111
    v_cvt_pk_bf16_f32 v134, v113, v115
    v_cvt_pk_bf16_f32 v231, -v221, -v223
    v_cvt_pk_bf16_f32 v135, v117, v119
    ds_write_b128 v57, v[228:231] offset:3104
    ds_write_b128 v56, v[132:135] offset:4096
    ds_read_b64_tr_b16 a[96:97], v58 offset:0
    ds_read_b64_tr_b16 a[98:99], v58 offset:192
    ds_read_b64_tr_b16 a[112:113], v59 offset:0
    ds_read_b64_tr_b16 a[114:115], v60 offset:256
    ds_read_b64_tr_b16 a[100:101], v58 offset:768
    ds_read_b64_tr_b16 a[102:103], v58 offset:960
    ds_read_b64_tr_b16 a[116:117], v59 offset:1024
    ds_read_b64_tr_b16 a[118:119], v60 offset:1280
    ds_read_b64_tr_b16 a[104:105], v58 offset:1536
    ds_read_b64_tr_b16 a[106:107], v58 offset:1728
    ds_read_b64_tr_b16 a[120:121], v59 offset:2048
    ds_read_b64_tr_b16 a[122:123], v60 offset:2304
    v_lshlrev_b32 v240, 16, v74
    v_mul_f32 v242, 0x3fb8aa3b, v240
    v_fma_f32 v243, v240, s57, -v242
    v_fma_f32 v243, v240, s58, v243
    v_exp_f32 v241, v242
    v_mul_f32 v243, 0x3f317218, v243
    ds_read_b64_tr_b16 a[108:109], v58 offset:2304
    ds_read_b64_tr_b16 a[110:111], v58 offset:2496
    ds_read_b64_tr_b16 a[124:125], v59 offset:3072
    ds_read_b64_tr_b16 a[126:127], v60 offset:3328
    s_waitcnt lgkmcnt(12)
    v_mfma_f32_32x32x16_bf16 v[176:191], a[96:99], a[112:115], 0
    v_min_f32 v241, 0x7f7fffff, v241
    v_fma_f32 v241, v241, v243, v241
    v_cvt_pk_bf16_f32 v241, v241, v241
    v_lshlrev_b32 v241, 16, v241
    v_mul_f32 v241, v241, v88
    v_mul_f32 v241, 0xbfb8aa3b, v241
    ds_read_b64_tr_b16 a[96:97], v58 offset:3072
    ds_read_b64_tr_b16 a[98:99], v58 offset:3264
    ds_read_b64_tr_b16 a[112:113], v59 offset:4096
    ds_read_b64_tr_b16 a[114:115], v60 offset:4352
    s_waitcnt lgkmcnt(12)
    v_mfma_f32_32x32x16_bf16 v[176:191], a[100:103], a[116:119], v[176:191]
    v_lshlrev_b32 v242, 16, v75
    v_mul_f32 v242, v242, v88
    v_mul_f32 v242, 0.15915494, v242
    v_lshlrev_b32 v100, 16, v76
    v_lshlrev_b32 v101, 16, v77
    v_mul_f32 v100, v100, v88
    ds_read_b64_tr_b16 a[100:101], v58 offset:3840
    ds_read_b64_tr_b16 a[102:103], v58 offset:4032
    ds_read_b64_tr_b16 a[116:117], v59 offset:5120
    ds_read_b64_tr_b16 a[118:119], v60 offset:5376
    s_waitcnt lgkmcnt(12)
    v_mfma_f32_32x32x16_bf16 v[176:191], a[104:107], a[120:123], v[176:191]
    v_mul_f32 v101, v101, v88
    v_add_f32 v100, v100, v100
    v_add_f32 v101, v101, v101
    v_mul_f32 v243, 0x41000000, v241
    v_mul_f32 v244, 0x41000000, v242
    v_exp_f32 v243, v243
    ds_read_b64_tr_b16 a[104:105], v58 offset:4608
    ds_read_b64_tr_b16 a[106:107], v58 offset:4800
    ds_read_b64_tr_b16 a[120:121], v59 offset:6144
    ds_read_b64_tr_b16 a[122:123], v60 offset:6400
    s_waitcnt lgkmcnt(12)
    v_mfma_f32_32x32x16_bf16 v[176:191], a[108:111], a[124:127], v[176:191]
    v_fract_f32 v244, v244
    v_cos_f32 v92, v244
    v_sin_f32 v93, v244
    s_nop 0
    v_mul_f32 v92, v92, v243
    v_mul_f32 v93, v93, v243
    ds_read_b64_tr_b16 a[108:109], v58 offset:5376
    ds_read_b64_tr_b16 a[110:111], v58 offset:5568
    ds_read_b64_tr_b16 a[124:125], v59 offset:7168
    ds_read_b64_tr_b16 a[126:127], v60 offset:7424
    s_waitcnt lgkmcnt(12)
    v_mfma_f32_32x32x16_bf16 v[176:191], a[96:99], a[112:115], v[176:191]
    v_mov_b32 v243, v241
    v_mov_b32 v244, v242
    v_exp_f32 v243, v243
    v_fract_f32 v244, v244
    v_cos_f32 v90, v244
    v_sin_f32 v91, v244
    s_waitcnt lgkmcnt(8)
    v_mfma_f32_32x32x16_bf16 v[176:191], a[100:103], a[116:119], v[176:191]
    s_nop 0
    v_mul_f32 v90, v90, v243
    v_mul_f32 v91, v91, v243
    v_mul_f32 v243, 0x43800000, v241
    v_mul_f32 v244, 0x43800000, v242
    v_exp_f32 v243, v243
    s_waitcnt lgkmcnt(4)
    v_mfma_f32_32x32x16_bf16 v[176:191], a[104:107], a[120:123], v[176:191]
    v_fract_f32 v244, v244
    v_cos_f32 v94, v244
    v_sin_f32 v95, v244
    s_nop 0
    v_mul_f32 v94, v94, v243
    v_mul_f32 v95, v95, v243
    s_waitcnt lgkmcnt(0)
    v_mfma_f32_32x32x16_bf16 v[176:191], a[108:111], a[124:127], v[176:191]
    buffer_load_dword a250, v142, s[92:95], s96 offen
    s_add_u32 s96, s96, s100
    v_mov_b32 v104, 1.0
    v_mov_b32 v208, v100
    v_mov_b32 v105, 0
    v_mov_b32 v209, v101
    v_mov_b32 v106, v92
    v_pk_mul_f32 v[210:211], v[208:209], v[90:91] op_sel:[0,0] op_sel_hi:[0,1]
    v_mov_b32 v107, v93
    v_pk_mul_f32 v[108:109], v[106:107], v[92:93] op_sel:[0,0] op_sel_hi:[0,1]
    v_pk_fma_f32 v[210:211], v[208:209], v[90:91], v[210:211] op_sel:[1,1,0] op_sel_hi:[1,0,1] neg_lo:[0,1,0]
    v_pk_fma_f32 v[108:109], v[106:107], v[92:93], v[108:109] op_sel:[1,1,0] op_sel_hi:[1,0,1] neg_lo:[0,1,0]
    v_pk_mul_f32 v[212:213], v[210:211], v[90:91] op_sel:[0,0] op_sel_hi:[0,1]
    v_pk_mul_f32 v[110:111], v[108:109], v[92:93] op_sel:[0,0] op_sel_hi:[0,1]
    v_pk_fma_f32 v[212:213], v[210:211], v[90:91], v[212:213] op_sel:[1,1,0] op_sel_hi:[1,0,1] neg_lo:[0,1,0]
    v_pk_fma_f32 v[110:111], v[108:109], v[92:93], v[110:111] op_sel:[1,1,0] op_sel_hi:[1,0,1] neg_lo:[0,1,0]
    v_pk_mul_f32 v[112:113], v[110:111], v[92:93] op_sel:[0,0] op_sel_hi:[0,1]
    v_pk_mul_f32 v[214:215], v[212:213], v[90:91] op_sel:[0,0] op_sel_hi:[0,1]
    v_pk_fma_f32 v[112:113], v[110:111], v[92:93], v[112:113] op_sel:[1,1,0] op_sel_hi:[1,0,1] neg_lo:[0,1,0]
    v_pk_fma_f32 v[214:215], v[212:213], v[90:91], v[214:215] op_sel:[1,1,0] op_sel_hi:[1,0,1] neg_lo:[0,1,0]
    v_pk_mul_f32 v[114:115], v[112:113], v[92:93] op_sel:[0,0] op_sel_hi:[0,1]
    v_pk_mul_f32 v[216:217], v[214:215], v[90:91] op_sel:[0,0] op_sel_hi:[0,1]
    v_pk_fma_f32 v[114:115], v[112:113], v[92:93], v[114:115] op_sel:[1,1,0] op_sel_hi:[1,0,1] neg_lo:[0,1,0]
    v_pk_mul_f32 v[116:117], v[114:115], v[92:93] op_sel:[0,0] op_sel_hi:[0,1]
    v_pk_fma_f32 v[216:217], v[214:215], v[90:91], v[216:217] op_sel:[1,1,0] op_sel_hi:[1,0,1] neg_lo:[0,1,0]
    v_pk_fma_f32 v[116:117], v[114:115], v[92:93], v[116:117] op_sel:[1,1,0] op_sel_hi:[1,0,1] neg_lo:[0,1,0]
    v_pk_mul_f32 v[218:219], v[216:217], v[90:91] op_sel:[0,0] op_sel_hi:[0,1]
    v_pk_mul_f32 v[118:119], v[116:117], v[92:93] op_sel:[0,0] op_sel_hi:[0,1]
    v_pk_fma_f32 v[118:119], v[116:117], v[92:93], v[118:119] op_sel:[1,1,0] op_sel_hi:[1,0,1] neg_lo:[0,1,0]
    v_pk_fma_f32 v[218:219], v[216:217], v[90:91], v[218:219] op_sel:[1,1,0] op_sel_hi:[1,0,1] neg_lo:[0,1,0]
    v_cvt_pk_bf16_f32 v120, v104, v106
    v_pk_mul_f32 v[220:221], v[218:219], v[90:91] op_sel:[0,0] op_sel_hi:[0,1]
    v_cvt_pk_bf16_f32 v121, v108, v110
    v_pk_fma_f32 v[220:221], v[218:219], v[90:91], v[220:221] op_sel:[1,1,0] op_sel_hi:[1,0,1] neg_lo:[0,1,0]
    v_cvt_pk_bf16_f32 v122, v112, v114
    v_cvt_pk_bf16_f32 v123, v116, v118
    v_pk_mul_f32 v[222:223], v[220:221], v[90:91] op_sel:[0,0] op_sel_hi:[0,1]
    ds_write_b128 v53, v[120:123] offset:0
    v_pk_fma_f32 v[222:223], v[220:221], v[90:91], v[222:223] op_sel:[1,1,0] op_sel_hi:[1,0,1] neg_lo:[0,1,0]
    v_cvt_pk_bf16_f32 v124, v105, v107
    v_pk_mul_f32 v[96:97], v[90:91], v[90:91] op_sel:[0,0] op_sel_hi:[0,1]
    v_cvt_pk_bf16_f32 v125, v109, v111
    v_cvt_pk_bf16_f32 v126, v113, v115
    v_pk_fma_f32 v[96:97], v[90:91], v[90:91], v[96:97] op_sel:[1,1,0] op_sel_hi:[1,0,1] neg_lo:[0,1,0]
    v_cvt_pk_bf16_f32 v127, v117, v119
    v_pk_mul_f32 v[98:99], v[96:97], v[96:97] op_sel:[0,0] op_sel_hi:[0,1]
    ds_write_b128 v53, v[124:127] offset:4096
    v_pk_mul_f32 v[104:105], v[118:119], v[92:93] op_sel:[0,0] op_sel_hi:[0,1]
    v_pk_fma_f32 v[98:99], v[96:97], v[96:97], v[98:99] op_sel:[1,1,0] op_sel_hi:[1,0,1] neg_lo:[0,1,0]
    v_pk_fma_f32 v[104:105], v[118:119], v[92:93], v[104:105] op_sel:[1,1,0] op_sel_hi:[1,0,1] neg_lo:[0,1,0]
    v_cvt_pk_bf16_f32 v224, v208, v210
    v_pk_mul_f32 v[106:107], v[104:105], v[92:93] op_sel:[0,0] op_sel_hi:[0,1]
    v_cvt_pk_bf16_f32 v225, v212, v214
    v_pk_fma_f32 v[106:107], v[104:105], v[92:93], v[106:107] op_sel:[1,1,0] op_sel_hi:[1,0,1] neg_lo:[0,1,0]
    v_pk_mul_f32 v[108:109], v[106:107], v[92:93] op_sel:[0,0] op_sel_hi:[0,1]
    v_cvt_pk_bf16_f32 v226, v216, v218
    v_pk_fma_f32 v[108:109], v[106:107], v[92:93], v[108:109] op_sel:[1,1,0] op_sel_hi:[1,0,1] neg_lo:[0,1,0]
    v_cvt_pk_bf16_f32 v227, v220, v222
    v_pk_mul_f32 v[110:111], v[108:109], v[92:93] op_sel:[0,0] op_sel_hi:[0,1]
    ds_write_b128 v57, v[224:227] offset:0
    v_pk_fma_f32 v[110:111], v[108:109], v[92:93], v[110:111] op_sel:[1,1,0] op_sel_hi:[1,0,1] neg_lo:[0,1,0]
    v_pk_mul_f32 v[112:113], v[110:111], v[92:93] op_sel:[0,0] op_sel_hi:[0,1]
    v_cvt_pk_bf16_f32 v228, -v209, -v211
    v_pk_fma_f32 v[112:113], v[110:111], v[92:93], v[112:113] op_sel:[1,1,0] op_sel_hi:[1,0,1] neg_lo:[0,1,0]
    v_cvt_pk_bf16_f32 v229, -v213, -v215
    v_pk_mul_f32 v[114:115], v[112:113], v[92:93] op_sel:[0,0] op_sel_hi:[0,1]
    v_cvt_pk_bf16_f32 v230, -v217, -v219
    v_pk_fma_f32 v[114:115], v[112:113], v[92:93], v[114:115] op_sel:[1,1,0] op_sel_hi:[1,0,1] neg_lo:[0,1,0]
    v_pk_mul_f32 v[116:117], v[114:115], v[92:93] op_sel:[0,0] op_sel_hi:[0,1]
    v_cvt_pk_bf16_f32 v231, -v221, -v223
    v_pk_fma_f32 v[116:117], v[114:115], v[92:93], v[116:117] op_sel:[1,1,0] op_sel_hi:[1,0,1] neg_lo:[0,1,0]
    ds_write_b128 v57, v[228:231] offset:3072
    v_pk_mul_f32 v[118:119], v[116:117], v[92:93] op_sel:[0,0] op_sel_hi:[0,1]
    v_pk_fma_f32 v[118:119], v[116:117], v[92:93], v[118:119] op_sel:[1,1,0] op_sel_hi:[1,0,1] neg_lo:[0,1,0]
    v_pk_mul_f32 v[208:209], v[100:101], v[94:95] op_sel:[0,0] op_sel_hi:[0,1]
    v_cvt_pk_bf16_f32 v128, v104, v106
    v_pk_fma_f32 v[208:209], v[100:101], v[94:95], v[208:209] op_sel:[1,1,0] op_sel_hi:[1,0,1] neg_lo:[0,1,0]
    v_cvt_pk_bf16_f32 v129, v108, v110
    v_pk_mul_f32 v[210:211], v[208:209], v[96:97] op_sel:[0,0] op_sel_hi:[0,1]
    v_cvt_pk_bf16_f32 v130, v112, v114
    v_cvt_pk_bf16_f32 v131, v116, v118
    v_pk_fma_f32 v[210:211], v[208:209], v[96:97], v[210:211] op_sel:[1,1,0] op_sel_hi:[1,0,1] neg_lo:[0,1,0]
    ds_write_b128 v54, v[128:131] offset:0
    v_pk_mul_f32 v[212:213], v[210:211], v[96:97] op_sel:[0,0] op_sel_hi:[0,1]
    v_cvt_pk_bf16_f32 v132, v105, v107
    v_pk_fma_f32 v[212:213], v[210:211], v[96:97], v[212:213] op_sel:[1,1,0] op_sel_hi:[1,0,1] neg_lo:[0,1,0]
    v_cvt_pk_bf16_f32 v133, v109, v111
    v_cvt_pk_bf16_f32 v134, v113, v115
    v_pk_mul_f32 v[214:215], v[212:213], v[96:97] op_sel:[0,0] op_sel_hi:[0,1]
    v_cvt_pk_bf16_f32 v135, v117, v119
    v_pk_fma_f32 v[214:215], v[212:213], v[96:97], v[214:215] op_sel:[1,1,0] op_sel_hi:[1,0,1] neg_lo:[0,1,0]
    ds_write_b128 v54, v[132:135] offset:4096
    v_pk_mul_f32 v[104:105], v[118:119], v[92:93] op_sel:[0,0] op_sel_hi:[0,1]
    buffer_load_dword a250, v142, s[92:95], s96 offen
    s_add_u32 s96, s96, s100
    v_pk_mul_f32 v[216:217], v[208:209], v[94:95] op_sel:[0,0] op_sel_hi:[0,1]
    v_pk_fma_f32 v[104:105], v[118:119], v[92:93], v[104:105] op_sel:[1,1,0] op_sel_hi:[1,0,1] neg_lo:[0,1,0]
    v_pk_fma_f32 v[216:217], v[208:209], v[94:95], v[216:217] op_sel:[1,1,0] op_sel_hi:[1,0,1] neg_lo:[0,1,0]
    v_pk_mul_f32 v[106:107], v[104:105], v[92:93] op_sel:[0,0] op_sel_hi:[0,1]
    v_pk_mul_f32 v[218:219], v[216:217], v[98:99] op_sel:[0,0] op_sel_hi:[0,1]
    v_pk_fma_f32 v[106:107], v[104:105], v[92:93], v[106:107] op_sel:[1,1,0] op_sel_hi:[1,0,1] neg_lo:[0,1,0]
    v_pk_mul_f32 v[108:109], v[106:107], v[92:93] op_sel:[0,0] op_sel_hi:[0,1]
    v_pk_fma_f32 v[218:219], v[216:217], v[98:99], v[218:219] op_sel:[1,1,0] op_sel_hi:[1,0,1] neg_lo:[0,1,0]
    v_pk_fma_f32 v[108:109], v[106:107], v[92:93], v[108:109] op_sel:[1,1,0] op_sel_hi:[1,0,1] neg_lo:[0,1,0]
    v_pk_mul_f32 v[220:221], v[216:217], v[94:95] op_sel:[0,0] op_sel_hi:[0,1]
    v_pk_mul_f32 v[110:111], v[108:109], v[92:93] op_sel:[0,0] op_sel_hi:[0,1]
    v_pk_fma_f32 v[220:221], v[216:217], v[94:95], v[220:221] op_sel:[1,1,0] op_sel_hi:[1,0,1] neg_lo:[0,1,0]
    v_pk_fma_f32 v[110:111], v[108:109], v[92:93], v[110:111] op_sel:[1,1,0] op_sel_hi:[1,0,1] neg_lo:[0,1,0]
    v_pk_mul_f32 v[112:113], v[110:111], v[92:93] op_sel:[0,0] op_sel_hi:[0,1]
    v_pk_mul_f32 v[222:223], v[220:221], v[98:99] op_sel:[0,0] op_sel_hi:[0,1]
    v_pk_fma_f32 v[112:113], v[110:111], v[92:93], v[112:113] op_sel:[1,1,0] op_sel_hi:[1,0,1] neg_lo:[0,1,0]
    v_pk_fma_f32 v[222:223], v[220:221], v[98:99], v[222:223] op_sel:[1,1,0] op_sel_hi:[1,0,1] neg_lo:[0,1,0]
    v_pk_mul_f32 v[114:115], v[112:113], v[92:93] op_sel:[0,0] op_sel_hi:[0,1]
    v_cvt_pk_bf16_f32 v232, v208, v210
    v_pk_fma_f32 v[114:115], v[112:113], v[92:93], v[114:115] op_sel:[1,1,0] op_sel_hi:[1,0,1] neg_lo:[0,1,0]
    v_pk_mul_f32 v[116:117], v[114:115], v[92:93] op_sel:[0,0] op_sel_hi:[0,1]
    v_cvt_pk_bf16_f32 v233, v212, v214
    v_pk_fma_f32 v[116:117], v[114:115], v[92:93], v[116:117] op_sel:[1,1,0] op_sel_hi:[1,0,1] neg_lo:[0,1,0]
    v_cvt_pk_bf16_f32 v234, v216, v218
    v_pk_mul_f32 v[118:119], v[116:117], v[92:93] op_sel:[0,0] op_sel_hi:[0,1]
    v_pk_fma_f32 v[118:119], v[116:117], v[92:93], v[118:119] op_sel:[1,1,0] op_sel_hi:[1,0,1] neg_lo:[0,1,0]
    v_cvt_pk_bf16_f32 v235, v220, v222
    v_cvt_pk_bf16_f32 v120, v104, v106
    ds_write_b128 v57, v[232:235] offset:16
    v_cvt_pk_bf16_f32 v121, v108, v110
    v_cvt_pk_bf16_f32 v236, -v209, -v211
    v_cvt_pk_bf16_f32 v122, v112, v114
    v_cvt_pk_bf16_f32 v123, v116, v118
    v_cvt_pk_bf16_f32 v237, -v213, -v215
    ds_write_b128 v55, v[120:123] offset:0
    v_cvt_pk_bf16_f32 v238, -v217, -v219
    v_cvt_pk_bf16_f32 v124, v105, v107
    v_cvt_pk_bf16_f32 v239, -v221, -v223
    v_cvt_pk_bf16_f32 v125, v109, v111
    v_cvt_pk_bf16_f32 v126, v113, v115
    ds_write_b128 v57, v[236:239] offset:3088
    v_cvt_pk_bf16_f32 v127, v117, v119
    v_pk_mul_f32 v[208:209], v[220:221], v[94:95] op_sel:[0,0] op_sel_hi:[0,1]
    ds_write_b128 v55, v[124:127] offset:4096
    v_pk_mul_f32 v[104:105], v[118:119], v[92:93] op_sel:[0,0] op_sel_hi:[0,1]
    v_pk_fma_f32 v[208:209], v[220:221], v[94:95], v[208:209] op_sel:[1,1,0] op_sel_hi:[1,0,1] neg_lo:[0,1,0]
    v_pk_fma_f32 v[104:105], v[118:119], v[92:93], v[104:105] op_sel:[1,1,0] op_sel_hi:[1,0,1] neg_lo:[0,1,0]
    v_pk_mul_f32 v[210:211], v[208:209], v[94:95] op_sel:[0,0] op_sel_hi:[0,1]
    v_pk_mul_f32 v[106:107], v[104:105], v[92:93] op_sel:[0,0] op_sel_hi:[0,1]
    v_pk_fma_f32 v[210:211], v[208:209], v[94:95], v[210:211] op_sel:[1,1,0] op_sel_hi:[1,0,1] neg_lo:[0,1,0]
    v_pk_fma_f32 v[106:107], v[104:105], v[92:93], v[106:107] op_sel:[1,1,0] op_sel_hi:[1,0,1] neg_lo:[0,1,0]
    v_pk_mul_f32 v[108:109], v[106:107], v[92:93] op_sel:[0,0] op_sel_hi:[0,1]
    v_pk_mul_f32 v[212:213], v[210:211], v[94:95] op_sel:[0,0] op_sel_hi:[0,1]
    v_pk_fma_f32 v[108:109], v[106:107], v[92:93], v[108:109] op_sel:[1,1,0] op_sel_hi:[1,0,1] neg_lo:[0,1,0]
    v_pk_fma_f32 v[212:213], v[210:211], v[94:95], v[212:213] op_sel:[1,1,0] op_sel_hi:[1,0,1] neg_lo:[0,1,0]
    v_pk_mul_f32 v[110:111], v[108:109], v[92:93] op_sel:[0,0] op_sel_hi:[0,1]
    v_pk_mul_f32 v[214:215], v[212:213], v[94:95] op_sel:[0,0] op_sel_hi:[0,1]
    v_pk_fma_f32 v[110:111], v[108:109], v[92:93], v[110:111] op_sel:[1,1,0] op_sel_hi:[1,0,1] neg_lo:[0,1,0]
    v_pk_mul_f32 v[112:113], v[110:111], v[92:93] op_sel:[0,0] op_sel_hi:[0,1]
    v_pk_fma_f32 v[214:215], v[212:213], v[94:95], v[214:215] op_sel:[1,1,0] op_sel_hi:[1,0,1] neg_lo:[0,1,0]
    v_pk_fma_f32 v[112:113], v[110:111], v[92:93], v[112:113] op_sel:[1,1,0] op_sel_hi:[1,0,1] neg_lo:[0,1,0]
    v_pk_mul_f32 v[216:217], v[214:215], v[94:95] op_sel:[0,0] op_sel_hi:[0,1]
    v_pk_mul_f32 v[114:115], v[112:113], v[92:93] op_sel:[0,0] op_sel_hi:[0,1]
    v_pk_fma_f32 v[216:217], v[214:215], v[94:95], v[216:217] op_sel:[1,1,0] op_sel_hi:[1,0,1] neg_lo:[0,1,0]
    v_pk_fma_f32 v[114:115], v[112:113], v[92:93], v[114:115] op_sel:[1,1,0] op_sel_hi:[1,0,1] neg_lo:[0,1,0]
    v_pk_mul_f32 v[116:117], v[114:115], v[92:93] op_sel:[0,0] op_sel_hi:[0,1]
    v_cvt_pk_bf16_f32 v224, v208, v210
    v_pk_fma_f32 v[116:117], v[114:115], v[92:93], v[116:117] op_sel:[1,1,0] op_sel_hi:[1,0,1] neg_lo:[0,1,0]
    v_cvt_pk_bf16_f32 v225, v212, v214
    v_pk_mul_f32 v[118:119], v[116:117], v[92:93] op_sel:[0,0] op_sel_hi:[0,1]
    v_pk_fma_f32 v[118:119], v[116:117], v[92:93], v[118:119] op_sel:[1,1,0] op_sel_hi:[1,0,1] neg_lo:[0,1,0]
    v_cvt_pk_bf16_f32 v226, v216, v218
    v_cvt_pk_bf16_f32 v128, v104, v106
    v_cvt_pk_bf16_f32 v227, v220, v222
    v_cvt_pk_bf16_f32 v129, v108, v110
    ds_write_b128 v57, v[224:227] offset:32
    v_cvt_pk_bf16_f32 v130, v112, v114
    v_cvt_pk_bf16_f32 v131, v116, v118
    v_cvt_pk_bf16_f32 v228, -v209, -v211
    ds_write_b128 v56, v[128:131] offset:0
    v_cvt_pk_bf16_f32 v229, -v213, -v215
    v_cvt_pk_bf16_f32 v132, v105, v107
    v_cvt_pk_bf16_f32 v230, -v217, -v219
    v_cvt_pk_bf16_f32 v133, v109, v111
    v_cvt_pk_bf16_f32 v134, v113, v115
    v_cvt_pk_bf16_f32 v231, -v221, -v223
    v_cvt_pk_bf16_f32 v135, v117, v119
    ds_write_b128 v57, v[228:231] offset:3104
    ds_write_b128 v56, v[132:135] offset:4096
    ds_read_b64_tr_b16 a[96:97], v58 offset:0
    ds_read_b64_tr_b16 a[98:99], v58 offset:192
    ds_read_b64_tr_b16 a[112:113], v59 offset:0
    ds_read_b64_tr_b16 a[114:115], v60 offset:256
    ds_read_b64_tr_b16 a[100:101], v58 offset:768
    ds_read_b64_tr_b16 a[102:103], v58 offset:960
    ds_read_b64_tr_b16 a[116:117], v59 offset:1024
    ds_read_b64_tr_b16 a[118:119], v60 offset:1280
    ds_read_b64_tr_b16 a[104:105], v58 offset:1536
    ds_read_b64_tr_b16 a[106:107], v58 offset:1728
    ds_read_b64_tr_b16 a[120:121], v59 offset:2048
    ds_read_b64_tr_b16 a[122:123], v60 offset:2304
    ds_read_b64_tr_b16 a[108:109], v58 offset:2304
    ds_read_b64_tr_b16 a[110:111], v58 offset:2496
    ds_read_b64_tr_b16 a[124:125], v59 offset:3072
    ds_read_b64_tr_b16 a[126:127], v60 offset:3328
    s_waitcnt lgkmcnt(12)
    v_mfma_f32_32x32x16_bf16 v[176:191], a[96:99], a[112:115], v[176:191]
    ds_read_b64_tr_b16 a[96:97], v58 offset:3072
    ds_read_b64_tr_b16 a[98:99], v58 offset:3264
    ds_read_b64_tr_b16 a[112:113], v59 offset:4096
    ds_read_b64_tr_b16 a[114:115], v60 offset:4352
    s_waitcnt lgkmcnt(12)
    v_mfma_f32_32x32x16_bf16 v[176:191], a[100:103], a[116:119], v[176:191]
    ds_read_b64_tr_b16 a[100:101], v58 offset:3840
    ds_read_b64_tr_b16 a[102:103], v58 offset:4032
    ds_read_b64_tr_b16 a[116:117], v59 offset:5120
    ds_read_b64_tr_b16 a[118:119], v60 offset:5376
    s_waitcnt lgkmcnt(12)
    v_mfma_f32_32x32x16_bf16 v[176:191], a[104:107], a[120:123], v[176:191]
    ds_read_b64_tr_b16 a[104:105], v58 offset:4608
    ds_read_b64_tr_b16 a[106:107], v58 offset:4800
    ds_read_b64_tr_b16 a[120:121], v59 offset:6144
    ds_read_b64_tr_b16 a[122:123], v60 offset:6400
    s_waitcnt lgkmcnt(12)
    v_mfma_f32_32x32x16_bf16 v[176:191], a[108:111], a[124:127], v[176:191]
    ds_read_b64_tr_b16 a[108:109], v58 offset:5376
    ds_read_b64_tr_b16 a[110:111], v58 offset:5568
    ds_read_b64_tr_b16 a[124:125], v59 offset:7168
    ds_read_b64_tr_b16 a[126:127], v60 offset:7424
    s_waitcnt lgkmcnt(12)
    v_mfma_f32_32x32x16_bf16 v[176:191], a[96:99], a[112:115], v[176:191]
    s_waitcnt lgkmcnt(8)
    v_mfma_f32_32x32x16_bf16 v[176:191], a[100:103], a[116:119], v[176:191]
    s_waitcnt lgkmcnt(4)
    v_mfma_f32_32x32x16_bf16 v[176:191], a[104:107], a[120:123], v[176:191]
    s_waitcnt lgkmcnt(0)
    v_mfma_f32_32x32x16_bf16 v[176:191], a[108:111], a[124:127], v[176:191]
    buffer_load_dword a250, v142, s[92:95], s96 offen
    s_add_u32 s96, s96, s100
    buffer_load_dword a250, v142, s[92:95], s96 offen
    s_add_u32 s96, s96, s100
    s_nop 7
    v_cvt_pk_bf16_f32 v192, v176, v177
    v_cvt_pk_bf16_f32 v193, v178, v179
    v_cvt_pk_bf16_f32 v194, v180, v181
    v_cvt_pk_bf16_f32 v195, v182, v183
    v_cvt_pk_bf16_f32 v196, v184, v185
    v_cvt_pk_bf16_f32 v197, v186, v187
    ds_write_b16 v61, v192 offset:0
    ds_write_b16_d16_hi v61, v192 offset:64
    ds_write_b16 v61, v193 offset:128
    ds_write_b16_d16_hi v61, v193 offset:192
    ds_write_b16 v61, v194 offset:512
    ds_write_b16_d16_hi v61, v194 offset:576
    ds_write_b16 v61, v195 offset:640
    ds_write_b16_d16_hi v61, v195 offset:704
    ds_write_b16 v61, v196 offset:1024
    ds_write_b16_d16_hi v61, v196 offset:1088
    ds_write_b16 v61, v197 offset:1152
    ds_write_b16_d16_hi v61, v197 offset:1216
    ds_read_u16 v192, v4
    ds_read_u16_d16_hi v120, v5
    ds_read_u16 v193, v6
    ds_read_u16_d16_hi v121, v7
    ds_read_u16 v194, v8
    ds_read_u16_d16_hi v122, v9
    ds_read_u16 v195, v10
    ds_read_u16_d16_hi v123, v11
    ds_read_u16 v124, v12
    ds_read_u16 v125, v13
    ds_read_u16 v126, v14
    ds_read_u16 v127, v15
    ds_read_u16 v128, v16
    ds_read_u16 v129, v17
    ds_read_u16 v130, v18
    v_add_u32 v136, s56, v62
    s_waitcnt lgkmcnt(13)
    v_or_b32 v192, v192, v120
    s_waitcnt lgkmcnt(11)
    v_or_b32 v193, v193, v121
    s_waitcnt lgkmcnt(9)
    v_or_b32 v194, v194, v122
    s_waitcnt lgkmcnt(7)
    v_or_b32 v195, v195, v123
    ds_write_b128 v136, v[192:195]
    s_waitcnt lgkmcnt(5)
    v_lshl_or_b32 v196, v126, 16, v126
    v_lshl_or_b32 v197, v125, 16, v125
    v_lshl_or_b32 v198, v124, 16, v125
    v_lshl_or_b32 v199, v124, 16, v124
    ds_write_b128 v136, v[196:199] offset:1280
    s_waitcnt lgkmcnt(4)
    v_cndmask_b32 v137, v127, v128, s[98:99]
    v_lshl_or_b32 v200, v128, 16, v128
    v_lshl_or_b32 v202, v127, 16, v127
    v_lshl_or_b32 v201, v137, 16, v128
    v_mov_b32 v203, v202
    ds_write_b128 v136, v[200:203] offset:2560
    s_waitcnt lgkmcnt(3)
    v_cndmask_b32 v137, v129, v130, s[98:99]
    v_lshl_or_b32 v204, v130, 16, v130
    v_lshl_or_b32 v206, v129, 16, v129
    v_lshl_or_b32 v205, v137, 16, v130
    v_mov_b32 v207, v206
    ds_write_b128 v136, v[204:207] offset:3840
    s_waitcnt vmcnt(6)
    s_mov_b32 s92, s12
    s_mov_b32 s93, s13
    s_mov_b32 s94, s14
    s_mov_b32 s95, s15
    s_mov_b32 s96, s97
    v_mov_b32 v142, v143
    s_movk_i32 s100, 8192
    v_mov_b32 v70, v79
    v_mov_b32 v71, v80
    v_mov_b32 v72, v81
    v_mov_b32 v73, v82
    v_mov_b32 v74, v83
    v_mov_b32 v75, v84
    v_mov_b32 v76, v85
    v_mov_b32 v77, v86
    v_mov_b32 v78, v87
    s_add_u32 s23, s23, 4
    s_add_u32 s83, s83, 1
    s_add_u32 s56, s56, 7520
    s_waitcnt lgkmcnt(0)
    s_cmp_lt_u32 s83, 2
    s_cbranch_scc1 L_kgen
    s_cmp_ge_u32 s21, 2
    s_cbranch_scc1 Lsk_15
    s_mov_b32 s57, 0x3fb8aa3b
    s_mov_b32 s58, 0x32a5705f
    v_lshlrev_b32 v136, 16, v78
    v_mul_f32 v138, 0x3fb8aa3b, v136
    v_fma_f32 v139, v136, s57, -v138
    v_fma_f32 v139, v136, s58, v139
    v_exp_f32 v88, v138
    v_mul_f32 v139, 0x3f317218, v139
    v_min_f32 v88, 0x7f7fffff, v88
    v_fma_f32 v88, v88, v139, v88
    v_cvt_pk_bf16_f32 v88, v88, v88
    v_lshlrev_b32 v88, 16, v88
    v_lshlrev_b32 v240, 16, v70
    v_mul_f32 v242, 0x3fb8aa3b, v240
    v_fma_f32 v243, v240, s57, -v242
    v_fma_f32 v243, v240, s58, v243
    v_exp_f32 v241, v242
    v_mul_f32 v243, 0x3f317218, v243
    v_min_f32 v241, 0x7f7fffff, v241
    v_fma_f32 v241, v241, v243, v241
    v_cvt_pk_bf16_f32 v241, v241, v241
    v_lshlrev_b32 v241, 16, v241
    v_mul_f32 v241, v241, v88
    v_mul_f32 v241, 0xbfb8aa3b, v241
    v_lshlrev_b32 v242, 16, v71
    v_mul_f32 v242, v242, v88
    v_mul_f32 v242, 0.15915494, v242
    v_lshlrev_b32 v100, 16, v72
    v_lshlrev_b32 v101, 16, v73
    v_mul_f32 v100, v100, v88
    v_mul_f32 v101, v101, v88
    v_add_f32 v100, v100, v100
    v_add_f32 v101, v101, v101
    v_mul_f32 v243, 0x41000000, v241
    v_mul_f32 v244, 0x41000000, v242
    v_exp_f32 v243, v243
    v_fract_f32 v244, v244
    v_cos_f32 v92, v244
    v_sin_f32 v93, v244
    s_nop 0
    v_mul_f32 v92, v92, v243
    v_mul_f32 v93, v93, v243
    v_mov_b32 v243, v241
    v_mov_b32 v244, v242
    v_exp_f32 v243, v243
    v_fract_f32 v244, v244
    v_cos_f32 v90, v244
    v_sin_f32 v91, v244
    s_nop 0
    v_mul_f32 v90, v90, v243
    v_mul_f32 v91, v91, v243
    v_mul_f32 v243, 0x43800000, v241
    v_mul_f32 v244, 0x43800000, v242
    v_exp_f32 v243, v243
    v_fract_f32 v244, v244
    v_cos_f32 v94, v244
    v_sin_f32 v95, v244
    s_nop 0
    v_mul_f32 v94, v94, v243
    v_mul_f32 v95, v95, v243
    v_mov_b32 v104, 1.0
    v_mov_b32 v208, v100
    v_mov_b32 v105, 0
    v_mov_b32 v209, v101
    v_mov_b32 v106, v92
    v_pk_mul_f32 v[210:211], v[208:209], v[90:91] op_sel:[0,0] op_sel_hi:[0,1]
    v_mov_b32 v107, v93
    v_pk_mul_f32 v[108:109], v[106:107], v[92:93] op_sel:[0,0] op_sel_hi:[0,1]
    v_pk_fma_f32 v[210:211], v[208:209], v[90:91], v[210:211] op_sel:[1,1,0] op_sel_hi:[1,0,1] neg_lo:[0,1,0]
    v_pk_fma_f32 v[108:109], v[106:107], v[92:93], v[108:109] op_sel:[1,1,0] op_sel_hi:[1,0,1] neg_lo:[0,1,0]
    v_pk_mul_f32 v[212:213], v[210:211], v[90:91] op_sel:[0,0] op_sel_hi:[0,1]
    v_pk_mul_f32 v[110:111], v[108:109], v[92:93] op_sel:[0,0] op_sel_hi:[0,1]
    v_pk_fma_f32 v[212:213], v[210:211], v[90:91], v[212:213] op_sel:[1,1,0] op_sel_hi:[1,0,1] neg_lo:[0,1,0]
    v_pk_fma_f32 v[110:111], v[108:109], v[92:93], v[110:111] op_sel:[1,1,0] op_sel_hi:[1,0,1] neg_lo:[0,1,0]
    v_pk_mul_f32 v[112:113], v[110:111], v[92:93] op_sel:[0,0] op_sel_hi:[0,1]
    v_pk_mul_f32 v[214:215], v[212:213], v[90:91] op_sel:[0,0] op_sel_hi:[0,1]
    v_pk_fma_f32 v[112:113], v[110:111], v[92:93], v[112:113] op_sel:[1,1,0] op_sel_hi:[1,0,1] neg_lo:[0,1,0]
    v_pk_fma_f32 v[214:215], v[212:213], v[90:91], v[214:215] op_sel:[1,1,0] op_sel_hi:[1,0,1] neg_lo:[0,1,0]
    v_pk_mul_f32 v[114:115], v[112:113], v[92:93] op_sel:[0,0] op_sel_hi:[0,1]
    v_pk_mul_f32 v[216:217], v[214:215], v[90:91] op_sel:[0,0] op_sel_hi:[0,1]
    v_pk_fma_f32 v[114:115], v[112:113], v[92:93], v[114:115] op_sel:[1,1,0] op_sel_hi:[1,0,1] neg_lo:[0,1,0]
    v_pk_mul_f32 v[116:117], v[114:115], v[92:93] op_sel:[0,0] op_sel_hi:[0,1]
    v_pk_fma_f32 v[216:217], v[214:215], v[90:91], v[216:217] op_sel:[1,1,0] op_sel_hi:[1,0,1] neg_lo:[0,1,0]
    v_pk_fma_f32 v[116:117], v[114:115], v[92:93], v[116:117] op_sel:[1,1,0] op_sel_hi:[1,0,1] neg_lo:[0,1,0]
    v_pk_mul_f32 v[218:219], v[216:217], v[90:91] op_sel:[0,0] op_sel_hi:[0,1]
    v_pk_mul_f32 v[118:119], v[116:117], v[92:93] op_sel:[0,0] op_sel_hi:[0,1]
    v_pk_fma_f32 v[118:119], v[116:117], v[92:93], v[118:119] op_sel:[1,1,0] op_sel_hi:[1,0,1] neg_lo:[0,1,0]
    v_pk_fma_f32 v[218:219], v[216:217], v[90:91], v[218:219] op_sel:[1,1,0] op_sel_hi:[1,0,1] neg_lo:[0,1,0]
    v_cvt_pk_bf16_f32 v120, v104, v106
    v_pk_mul_f32 v[220:221], v[218:219], v[90:91] op_sel:[0,0] op_sel_hi:[0,1]
    v_cvt_pk_bf16_f32 v121, v108, v110
    v_pk_fma_f32 v[220:221], v[218:219], v[90:91], v[220:221] op_sel:[1,1,0] op_sel_hi:[1,0,1] neg_lo:[0,1,0]
    v_cvt_pk_bf16_f32 v122, v112, v114
    v_cvt_pk_bf16_f32 v123, v116, v118
    v_pk_mul_f32 v[222:223], v[220:221], v[90:91] op_sel:[0,0] op_sel_hi:[0,1]
    ds_write_b128 v53, v[120:123] offset:0
    v_pk_fma_f32 v[222:223], v[220:221], v[90:91], v[222:223] op_sel:[1,1,0] op_sel_hi:[1,0,1] neg_lo:[0,1,0]
    v_cvt_pk_bf16_f32 v124, v105, v107
    v_pk_mul_f32 v[96:97], v[90:91], v[90:91] op_sel:[0,0] op_sel_hi:[0,1]
    v_cvt_pk_bf16_f32 v125, v109, v111
    v_cvt_pk_bf16_f32 v126, v113, v115
    v_pk_fma_f32 v[96:97], v[90:91], v[90:91], v[96:97] op_sel:[1,1,0] op_sel_hi:[1,0,1] neg_lo:[0,1,0]
    v_cvt_pk_bf16_f32 v127, v117, v119
    v_pk_mul_f32 v[98:99], v[96:97], v[96:97] op_sel:[0,0] op_sel_hi:[0,1]
    ds_write_b128 v53, v[124:127] offset:4096
    v_pk_mul_f32 v[104:105], v[118:119], v[92:93] op_sel:[0,0] op_sel_hi:[0,1]
    v_pk_fma_f32 v[98:99], v[96:97], v[96:97], v[98:99] op_sel:[1,1,0] op_sel_hi:[1,0,1] neg_lo:[0,1,0]
    v_pk_fma_f32 v[104:105], v[118:119], v[92:93], v[104:105] op_sel:[1,1,0] op_sel_hi:[1,0,1] neg_lo:[0,1,0]
    v_cvt_pk_bf16_f32 v224, v208, v210
    v_pk_mul_f32 v[106:107], v[104:105], v[92:93] op_sel:[0,0] op_sel_hi:[0,1]
    v_cvt_pk_bf16_f32 v225, v212, v214
    v_pk_fma_f32 v[106:107], v[104:105], v[92:93], v[106:107] op_sel:[1,1,0] op_sel_hi:[1,0,1] neg_lo:[0,1,0]
    v_pk_mul_f32 v[108:109], v[106:107], v[92:93] op_sel:[0,0] op_sel_hi:[0,1]
    v_cvt_pk_bf16_f32 v226, v216, v218
    v_pk_fma_f32 v[108:109], v[106:107], v[92:93], v[108:109] op_sel:[1,1,0] op_sel_hi:[1,0,1] neg_lo:[0,1,0]
    v_cvt_pk_bf16_f32 v227, v220, v222
    v_pk_mul_f32 v[110:111], v[108:109], v[92:93] op_sel:[0,0] op_sel_hi:[0,1]
    ds_write_b128 v57, v[224:227] offset:0
    v_pk_fma_f32 v[110:111], v[108:109], v[92:93], v[110:111] op_sel:[1,1,0] op_sel_hi:[1,0,1] neg_lo:[0,1,0]
    v_pk_mul_f32 v[112:113], v[110:111], v[92:93] op_sel:[0,0] op_sel_hi:[0,1]
    v_cvt_pk_bf16_f32 v228, -v209, -v211
    v_pk_fma_f32 v[112:113], v[110:111], v[92:93], v[112:113] op_sel:[1,1,0] op_sel_hi:[1,0,1] neg_lo:[0,1,0]
    v_cvt_pk_bf16_f32 v229, -v213, -v215
    v_pk_mul_f32 v[114:115], v[112:113], v[92:93] op_sel:[0,0] op_sel_hi:[0,1]
    v_cvt_pk_bf16_f32 v230, -v217, -v219
    v_pk_fma_f32 v[114:115], v[112:113], v[92:93], v[114:115] op_sel:[1,1,0] op_sel_hi:[1,0,1] neg_lo:[0,1,0]
    v_pk_mul_f32 v[116:117], v[114:115], v[92:93] op_sel:[0,0] op_sel_hi:[0,1]
    v_cvt_pk_bf16_f32 v231, -v221, -v223
    v_pk_fma_f32 v[116:117], v[114:115], v[92:93], v[116:117] op_sel:[1,1,0] op_sel_hi:[1,0,1] neg_lo:[0,1,0]
    ds_write_b128 v57, v[228:231] offset:3072
    v_pk_mul_f32 v[118:119], v[116:117], v[92:93] op_sel:[0,0] op_sel_hi:[0,1]
    v_pk_fma_f32 v[118:119], v[116:117], v[92:93], v[118:119] op_sel:[1,1,0] op_sel_hi:[1,0,1] neg_lo:[0,1,0]
    v_pk_mul_f32 v[208:209], v[100:101], v[94:95] op_sel:[0,0] op_sel_hi:[0,1]
    v_cvt_pk_bf16_f32 v128, v104, v106
    v_pk_fma_f32 v[208:209], v[100:101], v[94:95], v[208:209] op_sel:[1,1,0] op_sel_hi:[1,0,1] neg_lo:[0,1,0]
    v_cvt_pk_bf16_f32 v129, v108, v110
    v_pk_mul_f32 v[210:211], v[208:209], v[96:97] op_sel:[0,0] op_sel_hi:[0,1]
    v_cvt_pk_bf16_f32 v130, v112, v114
    v_cvt_pk_bf16_f32 v131, v116, v118
    v_pk_fma_f32 v[210:211], v[208:209], v[96:97], v[210:211] op_sel:[1,1,0] op_sel_hi:[1,0,1] neg_lo:[0,1,0]
    ds_write_b128 v54, v[128:131] offset:0
    v_pk_mul_f32 v[212:213], v[210:211], v[96:97] op_sel:[0,0] op_sel_hi:[0,1]
    v_cvt_pk_bf16_f32 v132, v105, v107
    v_pk_fma_f32 v[212:213], v[210:211], v[96:97], v[212:213] op_sel:[1,1,0] op_sel_hi:[1,0,1] neg_lo:[0,1,0]
    v_cvt_pk_bf16_f32 v133, v109, v111
    v_cvt_pk_bf16_f32 v134, v113, v115
    v_pk_mul_f32 v[214:215], v[212:213], v[96:97] op_sel:[0,0] op_sel_hi:[0,1]
    v_cvt_pk_bf16_f32 v135, v117, v119
    v_pk_fma_f32 v[214:215], v[212:213], v[96:97], v[214:215] op_sel:[1,1,0] op_sel_hi:[1,0,1] neg_lo:[0,1,0]
    ds_write_b128 v54, v[132:135] offset:4096
    v_pk_mul_f32 v[104:105], v[118:119], v[92:93] op_sel:[0,0] op_sel_hi:[0,1]
    v_pk_mul_f32 v[216:217], v[208:209], v[94:95] op_sel:[0,0] op_sel_hi:[0,1]
    v_pk_fma_f32 v[104:105], v[118:119], v[92:93], v[104:105] op_sel:[1,1,0] op_sel_hi:[1,0,1] neg_lo:[0,1,0]
    v_pk_fma_f32 v[216:217], v[208:209], v[94:95], v[216:217] op_sel:[1,1,0] op_sel_hi:[1,0,1] neg_lo:[0,1,0]
    v_pk_mul_f32 v[106:107], v[104:105], v[92:93] op_sel:[0,0] op_sel_hi:[0,1]
    v_pk_mul_f32 v[218:219], v[216:217], v[98:99] op_sel:[0,0] op_sel_hi:[0,1]
    v_pk_fma_f32 v[106:107], v[104:105], v[92:93], v[106:107] op_sel:[1,1,0] op_sel_hi:[1,0,1] neg_lo:[0,1,0]
    v_pk_mul_f32 v[108:109], v[106:107], v[92:93] op_sel:[0,0] op_sel_hi:[0,1]
    v_pk_fma_f32 v[218:219], v[216:217], v[98:99], v[218:219] op_sel:[1,1,0] op_sel_hi:[1,0,1] neg_lo:[0,1,0]
    v_pk_fma_f32 v[108:109], v[106:107], v[92:93], v[108:109] op_sel:[1,1,0] op_sel_hi:[1,0,1] neg_lo:[0,1,0]
    v_pk_mul_f32 v[220:221], v[216:217], v[94:95] op_sel:[0,0] op_sel_hi:[0,1]
    v_pk_mul_f32 v[110:111], v[108:109], v[92:93] op_sel:[0,0] op_sel_hi:[0,1]
    v_pk_fma_f32 v[220:221], v[216:217], v[94:95], v[220:221] op_sel:[1,1,0] op_sel_hi:[1,0,1] neg_lo:[0,1,0]
    v_pk_fma_f32 v[110:111], v[108:109], v[92:93], v[110:111] op_sel:[1,1,0] op_sel_hi:[1,0,1] neg_lo:[0,1,0]
    v_pk_mul_f32 v[112:113], v[110:111], v[92:93] op_sel:[0,0] op_sel_hi:[0,1]
    v_pk_mul_f32 v[222:223], v[220:221], v[98:99] op_sel:[0,0] op_sel_hi:[0,1]
    v_pk_fma_f32 v[112:113], v[110:111], v[92:93], v[112:113] op_sel:[1,1,0] op_sel_hi:[1,0,1] neg_lo:[0,1,0]
    v_pk_fma_f32 v[222:223], v[220:221], v[98:99], v[222:223] op_sel:[1,1,0] op_sel_hi:[1,0,1] neg_lo:[0,1,0]
    v_pk_mul_f32 v[114:115], v[112:113], v[92:93] op_sel:[0,0] op_sel_hi:[0,1]
    v_cvt_pk_bf16_f32 v232, v208, v210
    v_pk_fma_f32 v[114:115], v[112:113], v[92:93], v[114:115] op_sel:[1,1,0] op_sel_hi:[1,0,1] neg_lo:[0,1,0]
    v_pk_mul_f32 v[116:117], v[114:115], v[92:93] op_sel:[0,0] op_sel_hi:[0,1]
    v_cvt_pk_bf16_f32 v233, v212, v214
    v_pk_fma_f32 v[116:117], v[114:115], v[92:93], v[116:117] op_sel:[1,1,0] op_sel_hi:[1,0,1] neg_lo:[0,1,0]
    v_cvt_pk_bf16_f32 v234, v216, v218
    v_pk_mul_f32 v[118:119], v[116:117], v[92:93] op_sel:[0,0] op_sel_hi:[0,1]
    v_pk_fma_f32 v[118:119], v[116:117], v[92:93], v[118:119] op_sel:[1,1,0] op_sel_hi:[1,0,1] neg_lo:[0,1,0]
    v_cvt_pk_bf16_f32 v235, v220, v222
    v_cvt_pk_bf16_f32 v120, v104, v106
    ds_write_b128 v57, v[232:235] offset:16
    v_cvt_pk_bf16_f32 v121, v108, v110
    v_cvt_pk_bf16_f32 v236, -v209, -v211
    v_cvt_pk_bf16_f32 v122, v112, v114
    v_cvt_pk_bf16_f32 v123, v116, v118
    v_cvt_pk_bf16_f32 v237, -v213, -v215
    ds_write_b128 v55, v[120:123] offset:0
    v_cvt_pk_bf16_f32 v238, -v217, -v219
    v_cvt_pk_bf16_f32 v124, v105, v107
    v_cvt_pk_bf16_f32 v239, -v221, -v223
    v_cvt_pk_bf16_f32 v125, v109, v111
    v_cvt_pk_bf16_f32 v126, v113, v115
    ds_write_b128 v57, v[236:239] offset:3088
    v_cvt_pk_bf16_f32 v127, v117, v119
    v_pk_mul_f32 v[208:209], v[220:221], v[94:95] op_sel:[0,0] op_sel_hi:[0,1]
    ds_write_b128 v55, v[124:127] offset:4096
    v_pk_mul_f32 v[104:105], v[118:119], v[92:93] op_sel:[0,0] op_sel_hi:[0,1]
    v_pk_fma_f32 v[208:209], v[220:221], v[94:95], v[208:209] op_sel:[1,1,0] op_sel_hi:[1,0,1] neg_lo:[0,1,0]
    v_pk_fma_f32 v[104:105], v[118:119], v[92:93], v[104:105] op_sel:[1,1,0] op_sel_hi:[1,0,1] neg_lo:[0,1,0]
    v_pk_mul_f32 v[210:211], v[208:209], v[94:95] op_sel:[0,0] op_sel_hi:[0,1]
    v_pk_mul_f32 v[106:107], v[104:105], v[92:93] op_sel:[0,0] op_sel_hi:[0,1]
    v_pk_fma_f32 v[210:211], v[208:209], v[94:95], v[210:211] op_sel:[1,1,0] op_sel_hi:[1,0,1] neg_lo:[0,1,0]
    v_pk_fma_f32 v[106:107], v[104:105], v[92:93], v[106:107] op_sel:[1,1,0] op_sel_hi:[1,0,1] neg_lo:[0,1,0]
    v_pk_mul_f32 v[108:109], v[106:107], v[92:93] op_sel:[0,0] op_sel_hi:[0,1]
    v_pk_mul_f32 v[212:213], v[210:211], v[94:95] op_sel:[0,0] op_sel_hi:[0,1]
    v_pk_fma_f32 v[108:109], v[106:107], v[92:93], v[108:109] op_sel:[1,1,0] op_sel_hi:[1,0,1] neg_lo:[0,1,0]
    v_pk_fma_f32 v[212:213], v[210:211], v[94:95], v[212:213] op_sel:[1,1,0] op_sel_hi:[1,0,1] neg_lo:[0,1,0]
    v_pk_mul_f32 v[110:111], v[108:109], v[92:93] op_sel:[0,0] op_sel_hi:[0,1]
    v_pk_mul_f32 v[214:215], v[212:213], v[94:95] op_sel:[0,0] op_sel_hi:[0,1]
    v_pk_fma_f32 v[110:111], v[108:109], v[92:93], v[110:111] op_sel:[1,1,0] op_sel_hi:[1,0,1] neg_lo:[0,1,0]
    v_pk_mul_f32 v[112:113], v[110:111], v[92:93] op_sel:[0,0] op_sel_hi:[0,1]
    v_pk_fma_f32 v[214:215], v[212:213], v[94:95], v[214:215] op_sel:[1,1,0] op_sel_hi:[1,0,1] neg_lo:[0,1,0]
    v_pk_fma_f32 v[112:113], v[110:111], v[92:93], v[112:113] op_sel:[1,1,0] op_sel_hi:[1,0,1] neg_lo:[0,1,0]
    v_pk_mul_f32 v[216:217], v[214:215], v[94:95] op_sel:[0,0] op_sel_hi:[0,1]
    v_pk_mul_f32 v[114:115], v[112:113], v[92:93] op_sel:[0,0] op_sel_hi:[0,1]
    v_pk_fma_f32 v[216:217], v[214:215], v[94:95], v[216:217] op_sel:[1,1,0] op_sel_hi:[1,0,1] neg_lo:[0,1,0]
    v_pk_fma_f32 v[114:115], v[112:113], v[92:93], v[114:115] op_sel:[1,1,0] op_sel_hi:[1,0,1] neg_lo:[0,1,0]
    v_pk_mul_f32 v[116:117], v[114:115], v[92:93] op_sel:[0,0] op_sel_hi:[0,1]
    v_cvt_pk_bf16_f32 v224, v208, v210
    v_pk_fma_f32 v[116:117], v[114:115], v[92:93], v[116:117] op_sel:[1,1,0] op_sel_hi:[1,0,1] neg_lo:[0,1,0]
    v_cvt_pk_bf16_f32 v225, v212, v214
    v_pk_mul_f32 v[118:119], v[116:117], v[92:93] op_sel:[0,0] op_sel_hi:[0,1]
    v_pk_fma_f32 v[118:119], v[116:117], v[92:93], v[118:119] op_sel:[1,1,0] op_sel_hi:[1,0,1] neg_lo:[0,1,0]
    v_cvt_pk_bf16_f32 v226, v216, v218
    v_cvt_pk_bf16_f32 v128, v104, v106
    v_cvt_pk_bf16_f32 v227, v220, v222
    v_cvt_pk_bf16_f32 v129, v108, v110
    ds_write_b128 v57, v[224:227] offset:32
    v_cvt_pk_bf16_f32 v130, v112, v114
    v_cvt_pk_bf16_f32 v131, v116, v118
    v_cvt_pk_bf16_f32 v228, -v209, -v211
    ds_write_b128 v56, v[128:131] offset:0
    v_cvt_pk_bf16_f32 v229, -v213, -v215
    v_cvt_pk_bf16_f32 v132, v105, v107
    v_cvt_pk_bf16_f32 v230, -v217, -v219
    v_cvt_pk_bf16_f32 v133, v109, v111
    v_cvt_pk_bf16_f32 v134, v113, v115
    v_cvt_pk_bf16_f32 v231, -v221, -v223
    v_cvt_pk_bf16_f32 v135, v117, v119
    ds_write_b128 v57, v[228:231] offset:3104
    ds_write_b128 v56, v[132:135] offset:4096
    ds_read_b64_tr_b16 a[96:97], v58 offset:0
    ds_read_b64_tr_b16 a[98:99], v58 offset:192
    ds_read_b64_tr_b16 a[112:113], v59 offset:0
    ds_read_b64_tr_b16 a[114:115], v60 offset:256
    ds_read_b64_tr_b16 a[100:101], v58 offset:768
    ds_read_b64_tr_b16 a[102:103], v58 offset:960
    ds_read_b64_tr_b16 a[116:117], v59 offset:1024
    ds_read_b64_tr_b16 a[118:119], v60 offset:1280
    ds_read_b64_tr_b16 a[104:105], v58 offset:1536
    ds_read_b64_tr_b16 a[106:107], v58 offset:1728
    ds_read_b64_tr_b16 a[120:121], v59 offset:2048
    ds_read_b64_tr_b16 a[122:123], v60 offset:2304
    ds_read_b64_tr_b16 a[108:109], v58 offset:2304
    ds_read_b64_tr_b16 a[110:111], v58 offset:2496
    ds_read_b64_tr_b16 a[124:125], v59 offset:3072
    ds_read_b64_tr_b16 a[126:127], v60 offset:3328
    s_waitcnt lgkmcnt(12)
    v_mfma_f32_32x32x16_bf16 v[176:191], a[96:99], a[112:115], 0
    ds_read_b64_tr_b16 a[96:97], v58 offset:3072
    ds_read_b64_tr_b16 a[98:99], v58 offset:3264
    ds_read_b64_tr_b16 a[112:113], v59 offset:4096
    ds_read_b64_tr_b16 a[114:115], v60 offset:4352
    s_waitcnt lgkmcnt(12)
    v_mfma_f32_32x32x16_bf16 v[176:191], a[100:103], a[116:119], v[176:191]
    ds_read_b64_tr_b16 a[100:101], v58 offset:3840
    ds_read_b64_tr_b16 a[102:103], v58 offset:4032
    ds_read_b64_tr_b16 a[116:117], v59 offset:5120
    ds_read_b64_tr_b16 a[118:119], v60 offset:5376
    s_waitcnt lgkmcnt(12)
    v_mfma_f32_32x32x16_bf16 v[176:191], a[104:107], a[120:123], v[176:191]
    ds_read_b64_tr_b16 a[104:105], v58 offset:4608
    ds_read_b64_tr_b16 a[106:107], v58 offset:4800
    ds_read_b64_tr_b16 a[120:121], v59 offset:6144
    ds_read_b64_tr_b16 a[122:123], v60 offset:6400
    s_waitcnt lgkmcnt(12)
    v_mfma_f32_32x32x16_bf16 v[176:191], a[108:111], a[124:127], v[176:191]
    ds_read_b64_tr_b16 a[108:109], v58 offset:5376
    ds_read_b64_tr_b16 a[110:111], v58 offset:5568
    ds_read_b64_tr_b16 a[124:125], v59 offset:7168
    ds_read_b64_tr_b16 a[126:127], v60 offset:7424
    s_waitcnt lgkmcnt(12)
    v_mfma_f32_32x32x16_bf16 v[176:191], a[96:99], a[112:115], v[176:191]
    s_waitcnt lgkmcnt(8)
    v_mfma_f32_32x32x16_bf16 v[176:191], a[100:103], a[116:119], v[176:191]
    s_waitcnt lgkmcnt(4)
    v_mfma_f32_32x32x16_bf16 v[176:191], a[104:107], a[120:123], v[176:191]
    s_waitcnt lgkmcnt(0)
    v_mfma_f32_32x32x16_bf16 v[176:191], a[108:111], a[124:127], v[176:191]
    s_nop 11
    s_cmp_eq_u32 s21, 0
    s_cbranch_scc1 Lsk_15
    v_add_u32 v136, 69632, v69
    ds_write_b128 v136, v[176:179] offset:0
    ds_write_b128 v136, v[180:183] offset:1024
    ds_write_b128 v136, v[184:187] offset:2048
    s_waitcnt lgkmcnt(0)
Lsk_15:
    s_waitcnt lgkmcnt(0)
    s_barrier
    s_cmp_lg_u32 s21, 0
    s_cbranch_scc1 Lsk_18
    v_add_u32 v136, 69632, v69
    ds_read_b128 v[208:211], v136 offset:0
    ds_read_b128 v[212:215], v136 offset:1024
    ds_read_b128 v[216:219], v136 offset:2048
    s_waitcnt lgkmcnt(2)
    v_add_f32 v176, v176, v208
    v_add_f32 v177, v177, v209
    v_add_f32 v178, v178, v210
    v_add_f32 v179, v179, v211
    s_waitcnt lgkmcnt(1)
    v_add_f32 v180, v180, v212
    v_add_f32 v181, v181, v213
    v_add_f32 v182, v182, v214
    v_add_f32 v183, v183, v215
    s_waitcnt lgkmcnt(0)
    v_add_f32 v184, v184, v216
    v_add_f32 v185, v185, v217
    v_add_f32 v186, v186, v218
    v_add_f32 v187, v187, v219
    s_mov_b32 s56, 147200
    v_cvt_pk_bf16_f32 v192, v176, v177
    v_cvt_pk_bf16_f32 v193, v178, v179
    v_cvt_pk_bf16_f32 v194, v180, v181
    v_cvt_pk_bf16_f32 v195, v182, v183
    v_cvt_pk_bf16_f32 v196, v184, v185
    v_cvt_pk_bf16_f32 v197, v186, v187
    ds_write_b16 v61, v192 offset:0
    ds_write_b16_d16_hi v61, v192 offset:64
    ds_write_b16 v61, v193 offset:128
    ds_write_b16_d16_hi v61, v193 offset:192
    ds_write_b16 v61, v194 offset:512
    ds_write_b16_d16_hi v61, v194 offset:576
    ds_write_b16 v61, v195 offset:640
    ds_write_b16_d16_hi v61, v195 offset:704
    ds_write_b16 v61, v196 offset:1024
    ds_write_b16_d16_hi v61, v196 offset:1088
    ds_write_b16 v61, v197 offset:1152
    ds_write_b16_d16_hi v61, v197 offset:1216
    ds_read_u16 v192, v4
    ds_read_u16_d16_hi v120, v5
    ds_read_u16 v193, v6
    ds_read_u16_d16_hi v121, v7
    ds_read_u16 v194, v8
    ds_read_u16_d16_hi v122, v9
    ds_read_u16 v195, v10
    ds_read_u16_d16_hi v123, v11
    ds_read_u16 v124, v12
    ds_read_u16 v125, v13
    ds_read_u16 v126, v14
    ds_read_u16 v127, v15
    ds_read_u16 v128, v16
    ds_read_u16 v129, v17
    ds_read_u16 v130, v18
    v_add_u32 v136, s56, v62
    s_waitcnt lgkmcnt(13)
    v_or_b32 v192, v192, v120
    s_waitcnt lgkmcnt(11)
    v_or_b32 v193, v193, v121
    s_waitcnt lgkmcnt(9)
    v_or_b32 v194, v194, v122
    s_waitcnt lgkmcnt(7)
    v_or_b32 v195, v195, v123
    ds_write_b128 v136, v[192:195]
    s_waitcnt lgkmcnt(5)
    v_lshl_or_b32 v196, v126, 16, v126
    v_lshl_or_b32 v197, v125, 16, v125
    v_lshl_or_b32 v198, v124, 16, v125
    v_lshl_or_b32 v199, v124, 16, v124
    ds_write_b128 v136, v[196:199] offset:1280
    s_waitcnt lgkmcnt(4)
    v_cndmask_b32 v137, v127, v128, s[98:99]
    v_lshl_or_b32 v200, v128, 16, v128
    v_lshl_or_b32 v202, v127, 16, v127
    v_lshl_or_b32 v201, v137, 16, v128
    v_mov_b32 v203, v202
    ds_write_b128 v136, v[200:203] offset:2560
    s_waitcnt lgkmcnt(3)
    v_cndmask_b32 v137, v129, v130, s[98:99]
    v_lshl_or_b32 v204, v130, 16, v130
    v_lshl_or_b32 v206, v129, 16, v129
    v_lshl_or_b32 v205, v137, 16, v130
    v_mov_b32 v207, v206
    ds_write_b128 v136, v[204:207] offset:3840
    s_waitcnt lgkmcnt(0)
Lsk_18:
    s_mul_i32 s85, s20, 9
    s_add_u32 s86, s85, 8
    s_add_u32 s85, s85, s21
    s_add_u32 s87, s85, 4
    s_mul_i32 s57, s20, 9
    s_add_u32 s58, s57, 8
    s_mul_i32 s57, s57, 1366
    s_lshr_b32 s57, s57, 16
    s_lshl_b32 s57, s57, 11
    s_mul_i32 s58, s58, 1366
    s_lshr_b32 s58, s58, 16
    s_lshl_b32 s58, s58, 11
    v_and_b32 v137, 15, v1
    v_lshlrev_b32 v137, 7, v137
    v_mov_b32 v138, s57
    v_mov_b32 v139, s58
    v_cmp_gt_u32 vcc, 16, v1
    s_nop 1
    v_cndmask_b32 v138, v139, v138, vcc
    v_add_u32 v137, v137, v138
    s_mov_b32 s59, 33554432
    s_cmp_lg_u32 s21, 0
    s_cbranch_scc1 Lnp_19
    s_mov_b32 s82, 0
    s_mov_b32 exec_lo, 0xffffffff
    s_mov_b32 exec_hi, 0x0
Lpoll_20:
    buffer_load_dword v136, v137, s[16:19], s59 offen sc1
    s_waitcnt vmcnt(0)
    v_cmp_ne_u32 vcc, s22, v136
    s_add_u32 s82, s82, 1
    s_cmp_ge_u32 s82, 0x200000
    s_cbranch_scc1 Lpolld_21
    s_nop 1
    s_cbranch_vccnz Lpoll_20
Lpolld_21:
    s_mov_b64 exec, -1
Lnp_19:
    s_barrier
    s_mul_i32 s55, s85, 4224
    s_add_u32 m0, s52, 0
    s_nop 0
    buffer_load_dwordx4 v36, s[16:19], s55 offen offset:0 sc1 lds
    s_add_u32 m0, s52, 4096
    s_nop 0
    buffer_load_dwordx4 v40, s[16:19], s55 offen offset:0 sc1 lds
    buffer_load_dwordx4 v41, s[16:19], s55 offen offset:1024 sc1 lds
    s_add_u32 m0, s52, 8192
    s_nop 0
    buffer_load_dwordx4 v44, s[16:19], s55 offen offset:0 sc1 lds
    buffer_load_dwordx4 v45, s[16:19], s55 offen offset:1024 sc1 lds
    s_add_u32 m0, s52, 12288
    s_nop 0
    buffer_load_dwordx4 v48, s[16:19], s55 offen offset:0 sc1 lds
    buffer_load_dwordx4 v49, s[16:19], s55 offen offset:1024 sc1 lds
    s_add_u32 m0, s52, 0
    s_nop 0
    buffer_load_dwordx4 v37, s[16:19], s55 offen offset:1024 sc1 lds
    s_mul_i32 s55, s85, 4224
    s_add_u32 m0, s52, 0
    s_nop 0
    buffer_load_dwordx4 v38, s[16:19], s55 offen offset:2048 sc1 lds
    buffer_load_dwordx4 v39, s[16:19], s55 offen offset:3072 sc1 lds
    s_add_u32 m0, s52, 4096
    s_nop 0
    buffer_load_dwordx4 v42, s[16:19], s55 offen offset:2048 sc1 lds
    buffer_load_dwordx4 v43, s[16:19], s55 offen offset:3072 sc1 lds
    s_add_u32 m0, s52, 8192
    s_nop 0
    buffer_load_dwordx4 v46, s[16:19], s55 offen offset:2048 sc1 lds
    buffer_load_dwordx4 v47, s[16:19], s55 offen offset:3072 sc1 lds
    s_add_u32 m0, s52, 12288
    s_nop 0
    buffer_load_dwordx4 v50, s[16:19], s55 offen offset:2048 sc1 lds
    buffer_load_dwordx4 v51, s[16:19], s55 offen offset:3072 sc1 lds
    s_add_u32 m0, s52, 16384
    s_nop 0
    buffer_load_dwordx4 v52, s[16:19], s55 offen offset:0 sc1 lds
    s_lshl_b32 s56, s21, 1
    s_mul_i32 s56, s56, 7520
    s_add_u32 s56, s56, 87040
    s_waitcnt vmcnt(9)
    v_add_u32 v65, s52, v63
    v_add_u32 v66, s56, v64
    v_subrev_u32 v66, 160, v66
    ds_read_b128 a[68:71], v66 offset:704
    ds_read_b128 a[64:67], v66 offset:640
    ds_read_b128 a[76:79], v66 offset:3264
    ds_read_b128 a[72:75], v66 offset:3200
    ds_read_b64 a[0:1], v65 offset:0
    ds_read_b64 a[2:3], v65 offset:8
    ds_read_b64 a[4:5], v65 offset:32
    ds_read_b64 a[6:7], v65 offset:40
    ds_read_b64 a[8:9], v65 offset:64
    ds_read_b64 a[10:11], v65 offset:72
    ds_read_b64 a[12:13], v65 offset:96
    ds_read_b64 a[14:15], v65 offset:104
    ds_read_b64 a[16:17], v65 offset:128
    ds_read_b64 a[18:19], v65 offset:136
    ds_read_b64 a[20:21], v65 offset:160
    ds_read_b64 a[22:23], v65 offset:168
    s_waitcnt lgkmcnt(10)
    v_mfma_f32_16x16x32_bf16 v[144:147], a[0:3], a[68:71], 0
    ds_read_b128 a[84:87], v66 offset:544
    v_mfma_f32_16x16x32_bf16 v[160:163], a[0:3], a[76:79], 0
    ds_read_b64 a[24:25], v65 offset:192
    s_waitcnt lgkmcnt(10)
    v_mfma_f32_16x16x32_bf16 v[148:151], a[4:7], a[68:71], 0
    ds_read_b64 a[26:27], v65 offset:200
    v_mfma_f32_16x16x32_bf16 v[164:167], a[4:7], a[76:79], 0
    ds_read_b128 a[80:83], v66 offset:480
    s_waitcnt lgkmcnt(10)
    v_mfma_f32_16x16x32_bf16 v[152:155], a[8:11], a[68:71], 0
    ds_read_b128 a[92:95], v66 offset:3104
    v_mfma_f32_16x16x32_bf16 v[168:171], a[8:11], a[76:79], 0
    ds_read_b128 a[88:91], v66 offset:3040
    v_mfma_f32_16x16x32_bf16 v[144:147], a[8:11], a[64:67], v[144:147]
    ds_read_b64 a[28:29], v65 offset:224
    v_mfma_f32_16x16x32_bf16 v[160:163], a[8:11], a[72:75], v[160:163]
    ds_read_b64 a[30:31], v65 offset:232
    s_waitcnt lgkmcnt(12)
    v_mfma_f32_16x16x32_bf16 v[156:159], a[12:15], a[68:71], 0
    ds_read_b64 a[32:33], v65 offset:256
    v_mfma_f32_16x16x32_bf16 v[172:175], a[12:15], a[76:79], 0
    ds_read_b64 a[34:35], v65 offset:264
    v_mfma_f32_16x16x32_bf16 v[148:151], a[12:15], a[64:67], v[148:151]
    ds_read_b64 a[36:37], v65 offset:288
    v_mfma_f32_16x16x32_bf16 v[164:167], a[12:15], a[72:75], v[164:167]
    ds_read_b64 a[38:39], v65 offset:296
    s_waitcnt lgkmcnt(14)
    v_mfma_f32_16x16x32_bf16 v[152:155], a[16:19], a[64:67], v[152:155]
    v_mfma_f32_16x16x32_bf16 v[168:171], a[16:19], a[72:75], v[168:171]
    s_waitcnt lgkmcnt(12)
    v_mfma_f32_16x16x32_bf16 v[156:159], a[20:23], a[64:67], v[156:159]
    v_mfma_f32_16x16x32_bf16 v[172:175], a[20:23], a[72:75], v[172:175]
    s_waitcnt lgkmcnt(11)
    v_mfma_f32_16x16x32_bf16 v[144:147], a[16:19], a[84:87], v[144:147]
    ds_read_b128 a[68:71], v66 offset:384
    s_waitcnt lgkmcnt(8)
    v_mfma_f32_16x16x32_bf16 v[160:163], a[16:19], a[92:95], v[160:163]
    ds_read_b64 a[40:41], v65 offset:320
    v_mfma_f32_16x16x32_bf16 v[148:151], a[20:23], a[84:87], v[148:151]
    ds_read_b64 a[42:43], v65 offset:328
    v_mfma_f32_16x16x32_bf16 v[164:167], a[20:23], a[92:95], v[164:167]
    ds_read_b128 a[64:67], v66 offset:320
    v_mfma_f32_16x16x32_bf16 v[152:155], a[24:27], a[84:87], v[152:155]
    ds_read_b128 a[76:79], v66 offset:2944
    v_mfma_f32_16x16x32_bf16 v[168:171], a[24:27], a[92:95], v[168:171]
    ds_read_b128 a[72:75], v66 offset:2880
    v_mfma_f32_16x16x32_bf16 v[144:147], a[24:27], a[80:83], v[144:147]
    ds_read_b64 a[44:45], v65 offset:352
    s_waitcnt lgkmcnt(13)
    v_mfma_f32_16x16x32_bf16 v[160:163], a[24:27], a[88:91], v[160:163]
    ds_read_b64 a[46:47], v65 offset:360
    s_waitcnt lgkmcnt(12)
    v_mfma_f32_16x16x32_bf16 v[156:159], a[28:31], a[84:87], v[156:159]
    ds_read_b64 a[48:49], v65 offset:384
    v_mfma_f32_16x16x32_bf16 v[172:175], a[28:31], a[92:95], v[172:175]
    ds_read_b64 a[50:51], v65 offset:392
    v_mfma_f32_16x16x32_bf16 v[148:151], a[28:31], a[80:83], v[148:151]
    ds_read_b64 a[52:53], v65 offset:416
    v_mfma_f32_16x16x32_bf16 v[164:167], a[28:31], a[88:91], v[164:167]
    ds_read_b64 a[54:55], v65 offset:424
    s_waitcnt lgkmcnt(14)
    v_mfma_f32_16x16x32_bf16 v[152:155], a[32:35], a[80:83], v[152:155]
    v_mfma_f32_16x16x32_bf16 v[168:171], a[32:35], a[88:91], v[168:171]
    s_waitcnt lgkmcnt(12)
    v_mfma_f32_16x16x32_bf16 v[156:159], a[36:39], a[80:83], v[156:159]
    v_mfma_f32_16x16x32_bf16 v[172:175], a[36:39], a[88:91], v[172:175]
    s_waitcnt lgkmcnt(11)
    v_mfma_f32_16x16x32_bf16 v[144:147], a[32:35], a[68:71], v[144:147]
    ds_read_b128 a[84:87], v66 offset:224
    s_waitcnt lgkmcnt(8)
    v_mfma_f32_16x16x32_bf16 v[160:163], a[32:35], a[76:79], v[160:163]
    ds_read_b64 a[56:57], v65 offset:448
    v_mfma_f32_16x16x32_bf16 v[148:151], a[36:39], a[68:71], v[148:151]
    ds_read_b64 a[58:59], v65 offset:456
    v_mfma_f32_16x16x32_bf16 v[164:167], a[36:39], a[76:79], v[164:167]
    ds_read_b128 a[80:83], v66 offset:160
    v_mfma_f32_16x16x32_bf16 v[152:155], a[40:43], a[68:71], v[152:155]
    ds_read_b128 a[92:95], v66 offset:2784
    v_mfma_f32_16x16x32_bf16 v[168:171], a[40:43], a[76:79], v[168:171]
    ds_read_b128 a[88:91], v66 offset:2720
    v_mfma_f32_16x16x32_bf16 v[144:147], a[40:43], a[64:67], v[144:147]
    ds_read_b64 a[60:61], v65 offset:480
    s_waitcnt lgkmcnt(13)
    v_mfma_f32_16x16x32_bf16 v[160:163], a[40:43], a[72:75], v[160:163]
    ds_read_b64 a[62:63], v65 offset:488
    s_waitcnt lgkmcnt(12)
    v_mfma_f32_16x16x32_bf16 v[156:159], a[44:47], a[68:71], v[156:159]
    ds_read_b64 a[0:1], v65 offset:512
    v_mfma_f32_16x16x32_bf16 v[172:175], a[44:47], a[76:79], v[172:175]
    ds_read_b64 a[2:3], v65 offset:520
    v_mfma_f32_16x16x32_bf16 v[148:151], a[44:47], a[64:67], v[148:151]
    ds_read_b64 a[4:5], v65 offset:544
    v_mfma_f32_16x16x32_bf16 v[164:167], a[44:47], a[72:75], v[164:167]
    ds_read_b64 a[6:7], v65 offset:552
    s_waitcnt lgkmcnt(14)
    v_mfma_f32_16x16x32_bf16 v[152:155], a[48:51], a[64:67], v[152:155]
    v_mfma_f32_16x16x32_bf16 v[168:171], a[48:51], a[72:75], v[168:171]
    s_waitcnt lgkmcnt(12)
    v_mfma_f32_16x16x32_bf16 v[156:159], a[52:55], a[64:67], v[156:159]
    v_mfma_f32_16x16x32_bf16 v[172:175], a[52:55], a[72:75], v[172:175]
    s_waitcnt lgkmcnt(11)
    v_mfma_f32_16x16x32_bf16 v[144:147], a[48:51], a[84:87], v[144:147]
    ds_read_b128 a[68:71], v66 offset:64
    s_waitcnt lgkmcnt(8)
    v_mfma_f32_16x16x32_bf16 v[160:163], a[48:51], a[92:95], v[160:163]
    ds_read_b64 a[8:9], v65 offset:576
    v_mfma_f32_16x16x32_bf16 v[148:151], a[52:55], a[84:87], v[148:151]
    ds_read_b64 a[10:11], v65 offset:584
    v_mfma_f32_16x16x32_bf16 v[164:167], a[52:55], a[92:95], v[164:167]
    ds_read_b128 a[64:67], v66 offset:0
    v_mfma_f32_16x16x32_bf16 v[152:155], a[56:59], a[84:87], v[152:155]
    ds_read_b128 a[76:79], v66 offset:2624
    v_mfma_f32_16x16x32_bf16 v[168:171], a[56:59], a[92:95], v[168:171]
    ds_read_b128 a[72:75], v66 offset:2560
    v_mfma_f32_16x16x32_bf16 v[144:147], a[56:59], a[80:83], v[144:147]
    ds_read_b64 a[12:13], v65 offset:608
    s_waitcnt lgkmcnt(13)
    v_mfma_f32_16x16x32_bf16 v[160:163], a[56:59], a[88:91], v[160:163]
    ds_read_b64 a[14:15], v65 offset:616
    s_waitcnt lgkmcnt(12)
    v_mfma_f32_16x16x32_bf16 v[156:159], a[60:63], a[84:87], v[156:159]
    ds_read_b64 a[16:17], v65 offset:640
    v_mfma_f32_16x16x32_bf16 v[172:175], a[60:63], a[92:95], v[172:175]
    ds_read_b64 a[18:19], v65 offset:648
    v_mfma_f32_16x16x32_bf16 v[148:151], a[60:63], a[80:83], v[148:151]
    ds_read_b64 a[20:21], v65 offset:672
    v_mfma_f32_16x16x32_bf16 v[164:167], a[60:63], a[88:91], v[164:167]
    ds_read_b64 a[22:23], v65 offset:680
    s_waitcnt lgkmcnt(14)
    v_mfma_f32_16x16x32_bf16 v[152:155], a[0:3], a[80:83], v[152:155]
    v_mfma_f32_16x16x32_bf16 v[168:171], a[0:3], a[88:91], v[168:171]
    s_waitcnt lgkmcnt(12)
    v_mfma_f32_16x16x32_bf16 v[156:159], a[4:7], a[80:83], v[156:159]
    v_mfma_f32_16x16x32_bf16 v[172:175], a[4:7], a[88:91], v[172:175]
    v_add_u32 v65, 512, v65
    v_subrev_u32 v66, 640, v66
    s_waitcnt vmcnt(0)
    s_cmp_lg_u32 s21, 0
    s_cbranch_scc1 Lux_24
    s_mul_i32 s55, s86, 4224
    s_mov_b32 m0, 69632
    s_nop 0
    buffer_load_dwordx4 v36, s[16:19], s55 offen offset:0 sc1 lds
    buffer_load_dwordx4 v37, s[16:19], s55 offen offset:1024 sc1 lds
    buffer_load_dwordx4 v38, s[16:19], s55 offen offset:2048 sc1 lds
    buffer_load_dwordx4 v39, s[16:19], s55 offen offset:3072 sc1 lds
    s_branch Lux_22
Lux_24:
    s_cmp_lg_u32 s21, 1
    s_cbranch_scc1 Lux_25
    s_mul_i32 s55, s86, 4224
    s_mov_b32 m0, 73728
    s_nop 0
    buffer_load_dwordx4 v40, s[16:19], s55 offen offset:0 sc1 lds
    buffer_load_dwordx4 v41, s[16:19], s55 offen offset:1024 sc1 lds
    buffer_load_dwordx4 v42, s[16:19], s55 offen offset:2048 sc1 lds
    buffer_load_dwordx4 v43, s[16:19], s55 offen offset:3072 sc1 lds
    s_branch Lux_22
Lux_25:
    s_cmp_lg_u32 s21, 2
    s_cbranch_scc1 Lux_26
    s_mul_i32 s55, s86, 4224
    s_mov_b32 m0, 77824
    s_nop 0
    buffer_load_dwordx4 v44, s[16:19], s55 offen offset:0 sc1 lds
    buffer_load_dwordx4 v45, s[16:19], s55 offen offset:1024 sc1 lds
    buffer_load_dwordx4 v46, s[16:19], s55 offen offset:2048 sc1 lds
    buffer_load_dwordx4 v47, s[16:19], s55 offen offset:3072 sc1 lds
    s_branch Lux_22
Lux_26:
    s_mul_i32 s55, s86, 4224
    s_mov_b32 m0, 81920
    s_nop 0
    buffer_load_dwordx4 v48, s[16:19], s55 offen offset:0 sc1 lds
    buffer_load_dwordx4 v49, s[16:19], s55 offen offset:1024 sc1 lds
    buffer_load_dwordx4 v50, s[16:19], s55 offen offset:2048 sc1 lds
    buffer_load_dwordx4 v51, s[16:19], s55 offen offset:3072 sc1 lds
    s_mov_b32 m0, 86016
    s_nop 0
    buffer_load_dwordx4 v52, s[16:19], s55 offen offset:0 sc1 lds
Lux_22:
    s_mov_b32 s54, 3
L_cAa:
    s_waitcnt lgkmcnt(11)
    v_mfma_f32_16x16x32_bf16 v[144:147], a[0:3], a[68:71], v[144:147]
    ds_read_b128 a[84:87], v66 offset:544
    s_waitcnt lgkmcnt(8)
    v_mfma_f32_16x16x32_bf16 v[160:163], a[0:3], a[76:79], v[160:163]
    ds_read_b64 a[24:25], v65 offset:192
    v_mfma_f32_16x16x32_bf16 v[148:151], a[4:7], a[68:71], v[148:151]
    ds_read_b64 a[26:27], v65 offset:200
    v_mfma_f32_16x16x32_bf16 v[164:167], a[4:7], a[76:79], v[164:167]
    ds_read_b128 a[80:83], v66 offset:480
    v_mfma_f32_16x16x32_bf16 v[152:155], a[8:11], a[68:71], v[152:155]
    ds_read_b128 a[92:95], v66 offset:3104
    v_mfma_f32_16x16x32_bf16 v[168:171], a[8:11], a[76:79], v[168:171]
    ds_read_b128 a[88:91], v66 offset:3040
    v_mfma_f32_16x16x32_bf16 v[144:147], a[8:11], a[64:67], v[144:147]
    ds_read_b64 a[28:29], v65 offset:224
    s_waitcnt lgkmcnt(13)
    v_mfma_f32_16x16x32_bf16 v[160:163], a[8:11], a[72:75], v[160:163]
    ds_read_b64 a[30:31], v65 offset:232
    s_waitcnt lgkmcnt(12)
    v_mfma_f32_16x16x32_bf16 v[156:159], a[12:15], a[68:71], v[156:159]
    ds_read_b64 a[32:33], v65 offset:256
    v_mfma_f32_16x16x32_bf16 v[172:175], a[12:15], a[76:79], v[172:175]
    ds_read_b64 a[34:35], v65 offset:264
    v_mfma_f32_16x16x32_bf16 v[148:151], a[12:15], a[64:67], v[148:151]
    ds_read_b64 a[36:37], v65 offset:288
    v_mfma_f32_16x16x32_bf16 v[164:167], a[12:15], a[72:75], v[164:167]
    ds_read_b64 a[38:39], v65 offset:296
    s_waitcnt lgkmcnt(14)
    v_mfma_f32_16x16x32_bf16 v[152:155], a[16:19], a[64:67], v[152:155]
    v_mfma_f32_16x16x32_bf16 v[168:171], a[16:19], a[72:75], v[168:171]
    s_waitcnt lgkmcnt(12)
    v_mfma_f32_16x16x32_bf16 v[156:159], a[20:23], a[64:67], v[156:159]
    v_mfma_f32_16x16x32_bf16 v[172:175], a[20:23], a[72:75], v[172:175]
    s_waitcnt lgkmcnt(11)
    v_mfma_f32_16x16x32_bf16 v[144:147], a[16:19], a[84:87], v[144:147]
    ds_read_b128 a[68:71], v66 offset:384
    s_waitcnt lgkmcnt(8)
    v_mfma_f32_16x16x32_bf16 v[160:163], a[16:19], a[92:95], v[160:163]
    ds_read_b64 a[40:41], v65 offset:320
    v_mfma_f32_16x16x32_bf16 v[148:151], a[20:23], a[84:87], v[148:151]
    ds_read_b64 a[42:43], v65 offset:328
    v_mfma_f32_16x16x32_bf16 v[164:167], a[20:23], a[92:95], v[164:167]
    ds_read_b128 a[64:67], v66 offset:320
    v_mfma_f32_16x16x32_bf16 v[152:155], a[24:27], a[84:87], v[152:155]
    ds_read_b128 a[76:79], v66 offset:2944
    v_mfma_f32_16x16x32_bf16 v[168:171], a[24:27], a[92:95], v[168:171]
    ds_read_b128 a[72:75], v66 offset:2880
    v_mfma_f32_16x16x32_bf16 v[144:147], a[24:27], a[80:83], v[144:147]
    ds_read_b64 a[44:45], v65 offset:352
    s_waitcnt lgkmcnt(13)
    v_mfma_f32_16x16x32_bf16 v[160:163], a[24:27], a[88:91], v[160:163]
    ds_read_b64 a[46:47], v65 offset:360
    s_waitcnt lgkmcnt(12)
    v_mfma_f32_16x16x32_bf16 v[156:159], a[28:31], a[84:87], v[156:159]
    ds_read_b64 a[48:49], v65 offset:384
    v_mfma_f32_16x16x32_bf16 v[172:175], a[28:31], a[92:95], v[172:175]
    ds_read_b64 a[50:51], v65 offset:392
    v_mfma_f32_16x16x32_bf16 v[148:151], a[28:31], a[80:83], v[148:151]
    ds_read_b64 a[52:53], v65 offset:416
    v_mfma_f32_16x16x32_bf16 v[164:167], a[28:31], a[88:91], v[164:167]
    ds_read_b64 a[54:55], v65 offset:424
    s_waitcnt lgkmcnt(14)
    v_mfma_f32_16x16x32_bf16 v[152:155], a[32:35], a[80:83], v[152:155]
    v_mfma_f32_16x16x32_bf16 v[168:171], a[32:35], a[88:91], v[168:171]
    s_waitcnt lgkmcnt(12)
    v_mfma_f32_16x16x32_bf16 v[156:159], a[36:39], a[80:83], v[156:159]
    v_mfma_f32_16x16x32_bf16 v[172:175], a[36:39], a[88:91], v[172:175]
    s_waitcnt lgkmcnt(11)
    v_mfma_f32_16x16x32_bf16 v[144:147], a[32:35], a[68:71], v[144:147]
    ds_read_b128 a[84:87], v66 offset:224
    s_waitcnt lgkmcnt(8)
    v_mfma_f32_16x16x32_bf16 v[160:163], a[32:35], a[76:79], v[160:163]
    ds_read_b64 a[56:57], v65 offset:448
    v_mfma_f32_16x16x32_bf16 v[148:151], a[36:39], a[68:71], v[148:151]
    ds_read_b64 a[58:59], v65 offset:456
    v_mfma_f32_16x16x32_bf16 v[164:167], a[36:39], a[76:79], v[164:167]
    ds_read_b128 a[80:83], v66 offset:160
    v_mfma_f32_16x16x32_bf16 v[152:155], a[40:43], a[68:71], v[152:155]
    ds_read_b128 a[92:95], v66 offset:2784
    v_mfma_f32_16x16x32_bf16 v[168:171], a[40:43], a[76:79], v[168:171]
    ds_read_b128 a[88:91], v66 offset:2720
    v_mfma_f32_16x16x32_bf16 v[144:147], a[40:43], a[64:67], v[144:147]
    ds_read_b64 a[60:61], v65 offset:480
    s_waitcnt lgkmcnt(13)
    v_mfma_f32_16x16x32_bf16 v[160:163], a[40:43], a[72:75], v[160:163]
    ds_read_b64 a[62:63], v65 offset:488
    s_waitcnt lgkmcnt(12)
    v_mfma_f32_16x16x32_bf16 v[156:159], a[44:47], a[68:71], v[156:159]
    ds_read_b64 a[0:1], v65 offset:512
    v_mfma_f32_16x16x32_bf16 v[172:175], a[44:47], a[76:79], v[172:175]
    ds_read_b64 a[2:3], v65 offset:520
    v_mfma_f32_16x16x32_bf16 v[148:151], a[44:47], a[64:67], v[148:151]
    ds_read_b64 a[4:5], v65 offset:544
    v_mfma_f32_16x16x32_bf16 v[164:167], a[44:47], a[72:75], v[164:167]
    ds_read_b64 a[6:7], v65 offset:552
    s_waitcnt lgkmcnt(14)
    v_mfma_f32_16x16x32_bf16 v[152:155], a[48:51], a[64:67], v[152:155]
    v_mfma_f32_16x16x32_bf16 v[168:171], a[48:51], a[72:75], v[168:171]
    s_waitcnt lgkmcnt(12)
    v_mfma_f32_16x16x32_bf16 v[156:159], a[52:55], a[64:67], v[156:159]
    v_mfma_f32_16x16x32_bf16 v[172:175], a[52:55], a[72:75], v[172:175]
    s_waitcnt lgkmcnt(11)
    v_mfma_f32_16x16x32_bf16 v[144:147], a[48:51], a[84:87], v[144:147]
    ds_read_b128 a[68:71], v66 offset:64
    s_waitcnt lgkmcnt(8)
    v_mfma_f32_16x16x32_bf16 v[160:163], a[48:51], a[92:95], v[160:163]
    ds_read_b64 a[8:9], v65 offset:576
    v_mfma_f32_16x16x32_bf16 v[148:151], a[52:55], a[84:87], v[148:151]
    ds_read_b64 a[10:11], v65 offset:584
    v_mfma_f32_16x16x32_bf16 v[164:167], a[52:55], a[92:95], v[164:167]
    ds_read_b128 a[64:67], v66 offset:0
    v_mfma_f32_16x16x32_bf16 v[152:155], a[56:59], a[84:87], v[152:155]
    ds_read_b128 a[76:79], v66 offset:2624
    v_mfma_f32_16x16x32_bf16 v[168:171], a[56:59], a[92:95], v[168:171]
    ds_read_b128 a[72:75], v66 offset:2560
    v_mfma_f32_16x16x32_bf16 v[144:147], a[56:59], a[80:83], v[144:147]
    ds_read_b64 a[12:13], v65 offset:608
    s_waitcnt lgkmcnt(13)
    v_mfma_f32_16x16x32_bf16 v[160:163], a[56:59], a[88:91], v[160:163]
    ds_read_b64 a[14:15], v65 offset:616
    s_waitcnt lgkmcnt(12)
    v_mfma_f32_16x16x32_bf16 v[156:159], a[60:63], a[84:87], v[156:159]
    ds_read_b64 a[16:17], v65 offset:640
    v_mfma_f32_16x16x32_bf16 v[172:175], a[60:63], a[92:95], v[172:175]
    ds_read_b64 a[18:19], v65 offset:648
    v_mfma_f32_16x16x32_bf16 v[148:151], a[60:63], a[80:83], v[148:151]
    ds_read_b64 a[20:21], v65 offset:672
    v_mfma_f32_16x16x32_bf16 v[164:167], a[60:63], a[88:91], v[164:167]
    ds_read_b64 a[22:23], v65 offset:680
    s_waitcnt lgkmcnt(14)
    v_mfma_f32_16x16x32_bf16 v[152:155], a[0:3], a[80:83], v[152:155]
    v_mfma_f32_16x16x32_bf16 v[168:171], a[0:3], a[88:91], v[168:171]
    s_waitcnt lgkmcnt(12)
    v_mfma_f32_16x16x32_bf16 v[156:159], a[4:7], a[80:83], v[156:159]
    v_mfma_f32_16x16x32_bf16 v[172:175], a[4:7], a[88:91], v[172:175]
    v_add_u32 v65, 512, v65
    v_subrev_u32 v66, 640, v66
    s_sub_u32 s54, s54, 1
    s_cmp_lg_u32 s54, 0
    s_cbranch_scc1 L_cAa
    s_waitcnt lgkmcnt(7)
    v_mfma_f32_16x16x32_bf16 v[160:163], a[0:3], a[76:79], v[160:163]
    ds_read_b128 a[92:95], v66 offset:3104
    ds_read_b64 a[24:25], v65 offset:192
    v_mfma_f32_16x16x32_bf16 v[164:167], a[4:7], a[76:79], v[164:167]
    ds_read_b64 a[26:27], v65 offset:200
    ds_read_b128 a[88:91], v66 offset:3040
    v_mfma_f32_16x16x32_bf16 v[168:171], a[8:11], a[76:79], v[168:171]
    ds_read_b64 a[28:29], v65 offset:224
    ds_read_b64 a[30:31], v65 offset:232
    s_waitcnt lgkmcnt(12)
    v_mfma_f32_16x16x32_bf16 v[160:163], a[8:11], a[72:75], v[160:163]
    ds_read_b64 a[32:33], v65 offset:256
    ds_read_b64 a[34:35], v65 offset:264
    s_waitcnt lgkmcnt(12)
    v_mfma_f32_16x16x32_bf16 v[172:175], a[12:15], a[76:79], v[172:175]
    ds_read_b64 a[36:37], v65 offset:288
    ds_read_b64 a[38:39], v65 offset:296
    v_mfma_f32_16x16x32_bf16 v[164:167], a[12:15], a[72:75], v[164:167]
    s_waitcnt lgkmcnt(12)
    v_mfma_f32_16x16x32_bf16 v[168:171], a[16:19], a[72:75], v[168:171]
    s_waitcnt lgkmcnt(10)
    v_mfma_f32_16x16x32_bf16 v[172:175], a[20:23], a[72:75], v[172:175]
    s_waitcnt lgkmcnt(9)
    v_mfma_f32_16x16x32_bf16 v[160:163], a[16:19], a[92:95], v[160:163]
    ds_read_b128 a[76:79], v66 offset:2944
    ds_read_b64 a[40:41], v65 offset:320
    v_mfma_f32_16x16x32_bf16 v[164:167], a[20:23], a[92:95], v[164:167]
    ds_read_b64 a[42:43], v65 offset:328
    ds_read_b128 a[72:75], v66 offset:2880
    s_waitcnt lgkmcnt(11)
    v_mfma_f32_16x16x32_bf16 v[168:171], a[24:27], a[92:95], v[168:171]
    ds_read_b64 a[44:45], v65 offset:352
    ds_read_b64 a[46:47], v65 offset:360
    s_waitcnt lgkmcnt(12)
    v_mfma_f32_16x16x32_bf16 v[160:163], a[24:27], a[88:91], v[160:163]
    ds_read_b64 a[48:49], v65 offset:384
    ds_read_b64 a[50:51], v65 offset:392
    s_waitcnt lgkmcnt(12)
    v_mfma_f32_16x16x32_bf16 v[172:175], a[28:31], a[92:95], v[172:175]
    ds_read_b64 a[52:53], v65 offset:416
    ds_read_b64 a[54:55], v65 offset:424
    v_mfma_f32_16x16x32_bf16 v[164:167], a[28:31], a[88:91], v[164:167]
    s_waitcnt lgkmcnt(12)
    v_mfma_f32_16x16x32_bf16 v[168:171], a[32:35], a[88:91], v[168:171]
    s_waitcnt lgkmcnt(10)
    v_mfma_f32_16x16x32_bf16 v[172:175], a[36:39], a[88:91], v[172:175]
    s_waitcnt lgkmcnt(9)
    v_mfma_f32_16x16x32_bf16 v[160:163], a[32:35], a[76:79], v[160:163]
    ds_read_b128 a[92:95], v66 offset:2784
    ds_read_b64 a[56:57], v65 offset:448
    v_mfma_f32_16x16x32_bf16 v[164:167], a[36:39], a[76:79], v[164:167]
    ds_read_b64 a[58:59], v65 offset:456
    ds_read_b128 a[88:91], v66 offset:2720
    s_waitcnt lgkmcnt(11)
    v_mfma_f32_16x16x32_bf16 v[168:171], a[40:43], a[76:79], v[168:171]
    ds_read_b64 a[60:61], v65 offset:480
    ds_read_b64 a[62:63], v65 offset:488
    s_waitcnt lgkmcnt(12)
    v_mfma_f32_16x16x32_bf16 v[160:163], a[40:43], a[72:75], v[160:163]
    ds_read_b64 a[0:1], v65 offset:512
    ds_read_b64 a[2:3], v65 offset:520
    s_waitcnt lgkmcnt(12)
    v_mfma_f32_16x16x32_bf16 v[172:175], a[44:47], a[76:79], v[172:175]
    ds_read_b64 a[4:5], v65 offset:544
    ds_read_b64 a[6:7], v65 offset:552
    v_mfma_f32_16x16x32_bf16 v[164:167], a[44:47], a[72:75], v[164:167]
    s_waitcnt lgkmcnt(12)
    v_mfma_f32_16x16x32_bf16 v[168:171], a[48:51], a[72:75], v[168:171]
    s_waitcnt lgkmcnt(10)
    v_mfma_f32_16x16x32_bf16 v[172:175], a[52:55], a[72:75], v[172:175]
    s_waitcnt lgkmcnt(9)
    v_mfma_f32_16x16x32_bf16 v[160:163], a[48:51], a[92:95], v[160:163]
    ds_read_b128 a[76:79], v66 offset:2624
    ds_read_b64 a[8:9], v65 offset:576
    v_mfma_f32_16x16x32_bf16 v[164:167], a[52:55], a[92:95], v[164:167]
    ds_read_b64 a[10:11], v65 offset:584
    ds_read_b128 a[72:75], v66 offset:2560
    s_waitcnt lgkmcnt(11)
    v_mfma_f32_16x16x32_bf16 v[168:171], a[56:59], a[92:95], v[168:171]
    ds_read_b64 a[12:13], v65 offset:608
    ds_read_b64 a[14:15], v65 offset:616
    s_waitcnt lgkmcnt(12)
    v_mfma_f32_16x16x32_bf16 v[160:163], a[56:59], a[88:91], v[160:163]
    ds_read_b64 a[16:17], v65 offset:640
    ds_read_b64 a[18:19], v65 offset:648
    s_waitcnt lgkmcnt(12)
    v_mfma_f32_16x16x32_bf16 v[172:175], a[60:63], a[92:95], v[172:175]
    ds_read_b64 a[20:21], v65 offset:672
    ds_read_b64 a[22:23], v65 offset:680
    v_mfma_f32_16x16x32_bf16 v[164:167], a[60:63], a[88:91], v[164:167]
    s_waitcnt lgkmcnt(12)
    v_mfma_f32_16x16x32_bf16 v[168:171], a[0:3], a[88:91], v[168:171]
    s_waitcnt lgkmcnt(10)
    v_mfma_f32_16x16x32_bf16 v[172:175], a[4:7], a[88:91], v[172:175]
    v_add_u32 v65, 512, v65
    v_subrev_u32 v66, 640, v66
    s_mov_b32 s54, 3
L_cAb:
    s_waitcnt lgkmcnt(9)
    v_mfma_f32_16x16x32_bf16 v[160:163], a[0:3], a[76:79], v[160:163]
    ds_read_b128 a[92:95], v66 offset:3104
    ds_read_b64 a[24:25], v65 offset:192
    v_mfma_f32_16x16x32_bf16 v[164:167], a[4:7], a[76:79], v[164:167]
    ds_read_b64 a[26:27], v65 offset:200
    ds_read_b128 a[88:91], v66 offset:3040
    s_waitcnt lgkmcnt(11)
    v_mfma_f32_16x16x32_bf16 v[168:171], a[8:11], a[76:79], v[168:171]
    ds_read_b64 a[28:29], v65 offset:224
    ds_read_b64 a[30:31], v65 offset:232
    s_waitcnt lgkmcnt(12)
    v_mfma_f32_16x16x32_bf16 v[160:163], a[8:11], a[72:75], v[160:163]
    ds_read_b64 a[32:33], v65 offset:256
    ds_read_b64 a[34:35], v65 offset:264
    s_waitcnt lgkmcnt(12)
    v_mfma_f32_16x16x32_bf16 v[172:175], a[12:15], a[76:79], v[172:175]
    ds_read_b64 a[36:37], v65 offset:288
    ds_read_b64 a[38:39], v65 offset:296
    v_mfma_f32_16x16x32_bf16 v[164:167], a[12:15], a[72:75], v[164:167]
    s_waitcnt lgkmcnt(12)
    v_mfma_f32_16x16x32_bf16 v[168:171], a[16:19], a[72:75], v[168:171]
    s_waitcnt lgkmcnt(10)
    v_mfma_f32_16x16x32_bf16 v[172:175], a[20:23], a[72:75], v[172:175]
    s_waitcnt lgkmcnt(9)
    v_mfma_f32_16x16x32_bf16 v[160:163], a[16:19], a[92:95], v[160:163]
    ds_read_b128 a[76:79], v66 offset:2944
    ds_read_b64 a[40:41], v65 offset:320
    v_mfma_f32_16x16x32_bf16 v[164:167], a[20:23], a[92:95], v[164:167]
    ds_read_b64 a[42:43], v65 offset:328
    ds_read_b128 a[72:75], v66 offset:2880
    s_waitcnt lgkmcnt(11)
    v_mfma_f32_16x16x32_bf16 v[168:171], a[24:27], a[92:95], v[168:171]
    ds_read_b64 a[44:45], v65 offset:352
    ds_read_b64 a[46:47], v65 offset:360
    s_waitcnt lgkmcnt(12)
    v_mfma_f32_16x16x32_bf16 v[160:163], a[24:27], a[88:91], v[160:163]
    ds_read_b64 a[48:49], v65 offset:384
    ds_read_b64 a[50:51], v65 offset:392
    s_waitcnt lgkmcnt(12)
    v_mfma_f32_16x16x32_bf16 v[172:175], a[28:31], a[92:95], v[172:175]
    ds_read_b64 a[52:53], v65 offset:416
    ds_read_b64 a[54:55], v65 offset:424
    v_mfma_f32_16x16x32_bf16 v[164:167], a[28:31], a[88:91], v[164:167]
    s_waitcnt lgkmcnt(12)
    v_mfma_f32_16x16x32_bf16 v[168:171], a[32:35], a[88:91], v[168:171]
    s_waitcnt lgkmcnt(10)
    v_mfma_f32_16x16x32_bf16 v[172:175], a[36:39], a[88:91], v[172:175]
    s_waitcnt lgkmcnt(9)
    v_mfma_f32_16x16x32_bf16 v[160:163], a[32:35], a[76:79], v[160:163]
    ds_read_b128 a[92:95], v66 offset:2784
    ds_read_b64 a[56:57], v65 offset:448
    v_mfma_f32_16x16x32_bf16 v[164:167], a[36:39], a[76:79], v[164:167]
    ds_read_b64 a[58:59], v65 offset:456
    ds_read_b128 a[88:91], v66 offset:2720
    s_waitcnt lgkmcnt(11)
    v_mfma_f32_16x16x32_bf16 v[168:171], a[40:43], a[76:79], v[168:171]
    ds_read_b64 a[60:61], v65 offset:480
    ds_read_b64 a[62:63], v65 offset:488
    s_waitcnt lgkmcnt(12)
    v_mfma_f32_16x16x32_bf16 v[160:163], a[40:43], a[72:75], v[160:163]
    ds_read_b64 a[0:1], v65 offset:512
    ds_read_b64 a[2:3], v65 offset:520
    s_waitcnt lgkmcnt(12)
    v_mfma_f32_16x16x32_bf16 v[172:175], a[44:47], a[76:79], v[172:175]
    ds_read_b64 a[4:5], v65 offset:544
    ds_read_b64 a[6:7], v65 offset:552
    v_mfma_f32_16x16x32_bf16 v[164:167], a[44:47], a[72:75], v[164:167]
    s_waitcnt lgkmcnt(12)
    v_mfma_f32_16x16x32_bf16 v[168:171], a[48:51], a[72:75], v[168:171]
    s_waitcnt lgkmcnt(10)
    v_mfma_f32_16x16x32_bf16 v[172:175], a[52:55], a[72:75], v[172:175]
    s_waitcnt lgkmcnt(9)
    v_mfma_f32_16x16x32_bf16 v[160:163], a[48:51], a[92:95], v[160:163]
    ds_read_b128 a[76:79], v66 offset:2624
    ds_read_b64 a[8:9], v65 offset:576
    v_mfma_f32_16x16x32_bf16 v[164:167], a[52:55], a[92:95], v[164:167]
    ds_read_b64 a[10:11], v65 offset:584
    ds_read_b128 a[72:75], v66 offset:2560
    s_waitcnt lgkmcnt(11)
    v_mfma_f32_16x16x32_bf16 v[168:171], a[56:59], a[92:95], v[168:171]
    ds_read_b64 a[12:13], v65 offset:608
    ds_read_b64 a[14:15], v65 offset:616
    s_waitcnt lgkmcnt(12)
    v_mfma_f32_16x16x32_bf16 v[160:163], a[56:59], a[88:91], v[160:163]
    ds_read_b64 a[16:17], v65 offset:640
    ds_read_b64 a[18:19], v65 offset:648
    s_waitcnt lgkmcnt(12)
    v_mfma_f32_16x16x32_bf16 v[172:175], a[60:63], a[92:95], v[172:175]
    ds_read_b64 a[20:21], v65 offset:672
    ds_read_b64 a[22:23], v65 offset:680
    v_mfma_f32_16x16x32_bf16 v[164:167], a[60:63], a[88:91], v[164:167]
    s_waitcnt lgkmcnt(12)
    v_mfma_f32_16x16x32_bf16 v[168:171], a[0:3], a[88:91], v[168:171]
    s_waitcnt lgkmcnt(10)
    v_mfma_f32_16x16x32_bf16 v[172:175], a[4:7], a[88:91], v[172:175]
    v_add_u32 v65, 512, v65
    v_subrev_u32 v66, 640, v66
    s_sub_u32 s54, s54, 1
    s_cmp_lg_u32 s54, 0
    s_cbranch_scc1 L_cAb
    s_waitcnt vmcnt(0)
    s_waitcnt lgkmcnt(0)
    s_nop 7
    v_cvt_pk_bf16_f32 v144, v144, v145
    v_cvt_pk_bf16_f32 v145, v146, v147
    v_cvt_pk_bf16_f32 v148, v148, v149
    v_cvt_pk_bf16_f32 v149, v150, v151
    v_cvt_pk_bf16_f32 v152, v152, v153
    v_cvt_pk_bf16_f32 v153, v154, v155
    v_cvt_pk_bf16_f32 v156, v156, v157
    v_cvt_pk_bf16_f32 v157, v158, v159
    v_cvt_pk_bf16_f32 v160, v160, v161
    v_cvt_pk_bf16_f32 v161, v162, v163
    v_cvt_pk_bf16_f32 v164, v164, v165
    v_cvt_pk_bf16_f32 v165, v166, v167
    v_cvt_pk_bf16_f32 v168, v168, v169
    v_cvt_pk_bf16_f32 v169, v170, v171
    v_cvt_pk_bf16_f32 v172, v172, v173
    v_cvt_pk_bf16_f32 v173, v174, v175
    v_add_u32 v136, s56, v67
    v_add_u32 v137, s56, v68
    ds_write_b64 v136, v[144:145] offset:0
    ds_write_b64 v136, v[148:149] offset:32
    ds_write_b64 v136, v[152:153] offset:64
    ds_write_b64 v136, v[156:157] offset:96
    ds_write_b64 v136, v[160:161] offset:2304
    ds_write_b64 v136, v[164:165] offset:2336
    ds_write_b64 v136, v[168:169] offset:2368
    ds_write_b64 v136, v[172:173] offset:2400
    ds_read_b128 v[192:195], v137 offset:0
    ds_read_b128 v[196:199], v137 offset:1152
    ds_read_b128 v[200:203], v137 offset:2304
    ds_read_b128 v[204:207], v137 offset:3456
    s_lshl_b32 s55, s85, 12
    s_add_u32 s55, s55, 2621440
    s_waitcnt lgkmcnt(3)
    buffer_store_dwordx4 v[192:195], v69, s[16:19], s55 offen offset:0 sc1
    s_waitcnt lgkmcnt(2)
    buffer_store_dwordx4 v[196:199], v69, s[16:19], s55 offen offset:1024 sc1
    s_waitcnt lgkmcnt(1)
    buffer_store_dwordx4 v[200:203], v69, s[16:19], s55 offen offset:2048 sc1
    s_waitcnt lgkmcnt(0)
    buffer_store_dwordx4 v[204:207], v69, s[16:19], s55 offen offset:3072 sc1
    s_barrier
    s_lshl_b32 s57, s21, 9
    s_add_u32 s57, s57, 69632
    s_mul_i32 s58, s21, 640
    s_sub_u32 s58, 147040, s58
    v_add_u32 v65, s57, v63
    v_add_u32 v66, s58, v64
    ds_read_b128 a[68:71], v66 offset:704
    ds_read_b128 a[64:67], v66 offset:640
    ds_read_b128 a[76:79], v66 offset:3264
    ds_read_b128 a[72:75], v66 offset:3200
    ds_read_b64 a[0:1], v65 offset:0
    ds_read_b64 a[2:3], v65 offset:8
    ds_read_b64 a[4:5], v65 offset:32
    ds_read_b64 a[6:7], v65 offset:40
    ds_read_b64 a[8:9], v65 offset:64
    ds_read_b64 a[10:11], v65 offset:72
    ds_read_b64 a[12:13], v65 offset:96
    ds_read_b64 a[14:15], v65 offset:104
    ds_read_b64 a[16:17], v65 offset:128
    ds_read_b64 a[18:19], v65 offset:136
    ds_read_b64 a[20:21], v65 offset:160
    ds_read_b64 a[22:23], v65 offset:168
    s_waitcnt lgkmcnt(10)
    v_mfma_f32_16x16x32_bf16 v[144:147], a[0:3], a[68:71], 0
    ds_read_b128 a[84:87], v66 offset:544
    v_mfma_f32_16x16x32_bf16 v[160:163], a[0:3], a[76:79], 0
    ds_read_b64 a[24:25], v65 offset:192
    s_waitcnt lgkmcnt(10)
    v_mfma_f32_16x16x32_bf16 v[148:151], a[4:7], a[68:71], 0
    ds_read_b64 a[26:27], v65 offset:200
    v_mfma_f32_16x16x32_bf16 v[164:167], a[4:7], a[76:79], 0
    ds_read_b128 a[80:83], v66 offset:480
    s_waitcnt lgkmcnt(10)
    v_mfma_f32_16x16x32_bf16 v[152:155], a[8:11], a[68:71], 0
    ds_read_b128 a[92:95], v66 offset:3104
    s_mul_i32 s55, s87, 4224
    s_add_u32 m0, s52, 0
    s_nop 0
    buffer_load_dwordx4 v36, s[16:19], s55 offen offset:0 sc1 lds
    v_mfma_f32_16x16x32_bf16 v[168:171], a[8:11], a[76:79], 0
    ds_read_b128 a[88:91], v66 offset:3040
    v_mfma_f32_16x16x32_bf16 v[144:147], a[8:11], a[64:67], v[144:147]
    ds_read_b64 a[28:29], v65 offset:224
    v_mfma_f32_16x16x32_bf16 v[160:163], a[8:11], a[72:75], v[160:163]
    ds_read_b64 a[30:31], v65 offset:232
    s_waitcnt lgkmcnt(12)
    v_mfma_f32_16x16x32_bf16 v[156:159], a[12:15], a[68:71], 0
    ds_read_b64 a[32:33], v65 offset:256
    v_mfma_f32_16x16x32_bf16 v[172:175], a[12:15], a[76:79], 0
    ds_read_b64 a[34:35], v65 offset:264
    buffer_load_dwordx4 v37, s[16:19], s55 offen offset:1024 sc1 lds
    v_mfma_f32_16x16x32_bf16 v[148:151], a[12:15], a[64:67], v[148:151]
    ds_read_b64 a[36:37], v65 offset:288
    v_mfma_f32_16x16x32_bf16 v[164:167], a[12:15], a[72:75], v[164:167]
    ds_read_b64 a[38:39], v65 offset:296
    s_waitcnt lgkmcnt(14)
    v_mfma_f32_16x16x32_bf16 v[152:155], a[16:19], a[64:67], v[152:155]
    v_mfma_f32_16x16x32_bf16 v[168:171], a[16:19], a[72:75], v[168:171]
    s_waitcnt lgkmcnt(12)
    v_mfma_f32_16x16x32_bf16 v[156:159], a[20:23], a[64:67], v[156:159]
    buffer_load_dwordx4 v38, s[16:19], s55 offen offset:2048 sc1 lds
    v_mfma_f32_16x16x32_bf16 v[172:175], a[20:23], a[72:75], v[172:175]
    s_waitcnt lgkmcnt(11)
    v_mfma_f32_16x16x32_bf16 v[144:147], a[16:19], a[84:87], v[144:147]
    ds_read_b128 a[68:71], v66 offset:384
    s_waitcnt lgkmcnt(8)
    v_mfma_f32_16x16x32_bf16 v[160:163], a[16:19], a[92:95], v[160:163]
    ds_read_b64 a[40:41], v65 offset:320
    v_mfma_f32_16x16x32_bf16 v[148:151], a[20:23], a[84:87], v[148:151]
    ds_read_b64 a[42:43], v65 offset:328
    v_mfma_f32_16x16x32_bf16 v[164:167], a[20:23], a[92:95], v[164:167]
    ds_read_b128 a[64:67], v66 offset:320
    v_mfma_f32_16x16x32_bf16 v[152:155], a[24:27], a[84:87], v[152:155]
    ds_read_b128 a[76:79], v66 offset:2944
    buffer_load_dwordx4 v39, s[16:19], s55 offen offset:3072 sc1 lds
    v_mfma_f32_16x16x32_bf16 v[168:171], a[24:27], a[92:95], v[168:171]
    ds_read_b128 a[72:75], v66 offset:2880
    v_mfma_f32_16x16x32_bf16 v[144:147], a[24:27], a[80:83], v[144:147]
    ds_read_b64 a[44:45], v65 offset:352
    s_waitcnt lgkmcnt(13)
    v_mfma_f32_16x16x32_bf16 v[160:163], a[24:27], a[88:91], v[160:163]
    ds_read_b64 a[46:47], v65 offset:360
    s_waitcnt lgkmcnt(12)
    v_mfma_f32_16x16x32_bf16 v[156:159], a[28:31], a[84:87], v[156:159]
    ds_read_b64 a[48:49], v65 offset:384
    v_mfma_f32_16x16x32_bf16 v[172:175], a[28:31], a[92:95], v[172:175]
    ds_read_b64 a[50:51], v65 offset:392
    s_add_u32 m0, s52, 4096
    s_nop 0
    buffer_load_dwordx4 v40, s[16:19], s55 offen offset:0 sc1 lds
    v_mfma_f32_16x16x32_bf16 v[148:151], a[28:31], a[80:83], v[148:151]
    ds_read_b64 a[52:53], v65 offset:416
    v_mfma_f32_16x16x32_bf16 v[164:167], a[28:31], a[88:91], v[164:167]
    ds_read_b64 a[54:55], v65 offset:424
    s_waitcnt lgkmcnt(14)
    v_mfma_f32_16x16x32_bf16 v[152:155], a[32:35], a[80:83], v[152:155]
    v_mfma_f32_16x16x32_bf16 v[168:171], a[32:35], a[88:91], v[168:171]
    s_waitcnt lgkmcnt(12)
    v_mfma_f32_16x16x32_bf16 v[156:159], a[36:39], a[80:83], v[156:159]
    buffer_load_dwordx4 v41, s[16:19], s55 offen offset:1024 sc1 lds
    v_mfma_f32_16x16x32_bf16 v[172:175], a[36:39], a[88:91], v[172:175]
    s_waitcnt lgkmcnt(11)
    v_mfma_f32_16x16x32_bf16 v[144:147], a[32:35], a[68:71], v[144:147]
    ds_read_b128 a[84:87], v66 offset:224
    s_waitcnt lgkmcnt(8)
    v_mfma_f32_16x16x32_bf16 v[160:163], a[32:35], a[76:79], v[160:163]
    ds_read_b64 a[56:57], v65 offset:448
    v_mfma_f32_16x16x32_bf16 v[148:151], a[36:39], a[68:71], v[148:151]
    ds_read_b64 a[58:59], v65 offset:456
    v_mfma_f32_16x16x32_bf16 v[164:167], a[36:39], a[76:79], v[164:167]
    ds_read_b128 a[80:83], v66 offset:160
    v_mfma_f32_16x16x32_bf16 v[152:155], a[40:43], a[68:71], v[152:155]
    ds_read_b128 a[92:95], v66 offset:2784
    buffer_load_dwordx4 v42, s[16:19], s55 offen offset:2048 sc1 lds
    v_mfma_f32_16x16x32_bf16 v[168:171], a[40:43], a[76:79], v[168:171]
    ds_read_b128 a[88:91], v66 offset:2720
    v_mfma_f32_16x16x32_bf16 v[144:147], a[40:43], a[64:67], v[144:147]
    ds_read_b64 a[60:61], v65 offset:480
    s_waitcnt lgkmcnt(13)
    v_mfma_f32_16x16x32_bf16 v[160:163], a[40:43], a[72:75], v[160:163]
    ds_read_b64 a[62:63], v65 offset:488
    s_waitcnt lgkmcnt(12)
    v_mfma_f32_16x16x32_bf16 v[156:159], a[44:47], a[68:71], v[156:159]
    ds_read_b64 a[0:1], v65 offset:512
    v_mfma_f32_16x16x32_bf16 v[172:175], a[44:47], a[76:79], v[172:175]
    ds_read_b64 a[2:3], v65 offset:520
    buffer_load_dwordx4 v43, s[16:19], s55 offen offset:3072 sc1 lds
    v_mfma_f32_16x16x32_bf16 v[148:151], a[44:47], a[64:67], v[148:151]
    ds_read_b64 a[4:5], v65 offset:544
    v_mfma_f32_16x16x32_bf16 v[164:167], a[44:47], a[72:75], v[164:167]
    ds_read_b64 a[6:7], v65 offset:552
    s_waitcnt lgkmcnt(14)
    v_mfma_f32_16x16x32_bf16 v[152:155], a[48:51], a[64:67], v[152:155]
    v_mfma_f32_16x16x32_bf16 v[168:171], a[48:51], a[72:75], v[168:171]
    s_waitcnt lgkmcnt(12)
    v_mfma_f32_16x16x32_bf16 v[156:159], a[52:55], a[64:67], v[156:159]
    s_add_u32 m0, s52, 8192
    s_nop 0
    buffer_load_dwordx4 v44, s[16:19], s55 offen offset:0 sc1 lds
    v_mfma_f32_16x16x32_bf16 v[172:175], a[52:55], a[72:75], v[172:175]
    s_waitcnt lgkmcnt(11)
    v_mfma_f32_16x16x32_bf16 v[144:147], a[48:51], a[84:87], v[144:147]
    ds_read_b128 a[68:71], v66 offset:64
    s_waitcnt lgkmcnt(8)
    v_mfma_f32_16x16x32_bf16 v[160:163], a[48:51], a[92:95], v[160:163]
    ds_read_b64 a[8:9], v65 offset:576
    v_mfma_f32_16x16x32_bf16 v[148:151], a[52:55], a[84:87], v[148:151]
    ds_read_b64 a[10:11], v65 offset:584
    v_mfma_f32_16x16x32_bf16 v[164:167], a[52:55], a[92:95], v[164:167]
    ds_read_b128 a[64:67], v66 offset:0
    v_mfma_f32_16x16x32_bf16 v[152:155], a[56:59], a[84:87], v[152:155]
    ds_read_b128 a[76:79], v66 offset:2624
    buffer_load_dwordx4 v45, s[16:19], s55 offen offset:1024 sc1 lds
    v_mfma_f32_16x16x32_bf16 v[168:171], a[56:59], a[92:95], v[168:171]
    ds_read_b128 a[72:75], v66 offset:2560
    v_mfma_f32_16x16x32_bf16 v[144:147], a[56:59], a[80:83], v[144:147]
    ds_read_b64 a[12:13], v65 offset:608
    s_waitcnt lgkmcnt(13)
    v_mfma_f32_16x16x32_bf16 v[160:163], a[56:59], a[88:91], v[160:163]
    ds_read_b64 a[14:15], v65 offset:616
    s_waitcnt lgkmcnt(12)
    v_mfma_f32_16x16x32_bf16 v[156:159], a[60:63], a[84:87], v[156:159]
    ds_read_b64 a[16:17], v65 offset:640
    v_mfma_f32_16x16x32_bf16 v[172:175], a[60:63], a[92:95], v[172:175]
    ds_read_b64 a[18:19], v65 offset:648
    buffer_load_dwordx4 v46, s[16:19], s55 offen offset:2048 sc1 lds
    v_mfma_f32_16x16x32_bf16 v[148:151], a[60:63], a[80:83], v[148:151]
    ds_read_b64 a[20:21], v65 offset:672
    v_mfma_f32_16x16x32_bf16 v[164:167], a[60:63], a[88:91], v[164:167]
    ds_read_b64 a[22:23], v65 offset:680
    s_waitcnt lgkmcnt(14)
    v_mfma_f32_16x16x32_bf16 v[152:155], a[0:3], a[80:83], v[152:155]
    v_mfma_f32_16x16x32_bf16 v[168:171], a[0:3], a[88:91], v[168:171]
    s_waitcnt lgkmcnt(12)
    v_mfma_f32_16x16x32_bf16 v[156:159], a[4:7], a[80:83], v[156:159]
    buffer_load_dwordx4 v47, s[16:19], s55 offen offset:3072 sc1 lds
    v_mfma_f32_16x16x32_bf16 v[172:175], a[4:7], a[88:91], v[172:175]
    s_waitcnt lgkmcnt(0)
    v_add_u32 v65, 2048, v65
    v_subrev_u32 v66, 2560, v66
    ds_read_b128 a[76:79], v66 offset:3264
    ds_read_b128 a[72:75], v66 offset:3200
    ds_read_b64 a[0:1], v65 offset:0
    ds_read_b64 a[2:3], v65 offset:8
    ds_read_b64 a[4:5], v65 offset:32
    ds_read_b64 a[6:7], v65 offset:40
    ds_read_b64 a[8:9], v65 offset:64
    ds_read_b64 a[10:11], v65 offset:72
    ds_read_b64 a[12:13], v65 offset:96
    ds_read_b64 a[14:15], v65 offset:104
    ds_read_b64 a[16:17], v65 offset:128
    ds_read_b64 a[18:19], v65 offset:136
    ds_read_b64 a[20:21], v65 offset:160
    ds_read_b64 a[22:23], v65 offset:168
    s_waitcnt lgkmcnt(10)
    v_mfma_f32_16x16x32_bf16 v[160:163], a[0:3], a[76:79], v[160:163]
    ds_read_b128 a[92:95], v66 offset:3104
    ds_read_b64 a[24:25], v65 offset:192
    s_waitcnt lgkmcnt(10)
    v_mfma_f32_16x16x32_bf16 v[164:167], a[4:7], a[76:79], v[164:167]
    ds_read_b64 a[26:27], v65 offset:200
    ds_read_b128 a[88:91], v66 offset:3040
    s_waitcnt lgkmcnt(10)
    v_mfma_f32_16x16x32_bf16 v[168:171], a[8:11], a[76:79], v[168:171]
    ds_read_b64 a[28:29], v65 offset:224
    ds_read_b64 a[30:31], v65 offset:232
    v_mfma_f32_16x16x32_bf16 v[160:163], a[8:11], a[72:75], v[160:163]
    ds_read_b64 a[32:33], v65 offset:256
    ds_read_b64 a[34:35], v65 offset:264
    s_add_u32 m0, s52, 12288
    s_nop 0
    buffer_load_dwordx4 v48, s[16:19], s55 offen offset:0 sc1 lds
    s_waitcnt lgkmcnt(12)
    v_mfma_f32_16x16x32_bf16 v[172:175], a[12:15], a[76:79], v[172:175]
    ds_read_b64 a[36:37], v65 offset:288
    ds_read_b64 a[38:39], v65 offset:296
    v_mfma_f32_16x16x32_bf16 v[164:167], a[12:15], a[72:75], v[164:167]
    s_waitcnt lgkmcnt(12)
    v_mfma_f32_16x16x32_bf16 v[168:171], a[16:19], a[72:75], v[168:171]
    s_waitcnt lgkmcnt(10)
    v_mfma_f32_16x16x32_bf16 v[172:175], a[20:23], a[72:75], v[172:175]
    buffer_load_dwordx4 v49, s[16:19], s55 offen offset:1024 sc1 lds
    s_waitcnt lgkmcnt(9)
    v_mfma_f32_16x16x32_bf16 v[160:163], a[16:19], a[92:95], v[160:163]
    ds_read_b128 a[76:79], v66 offset:2944
    ds_read_b64 a[40:41], v65 offset:320
    v_mfma_f32_16x16x32_bf16 v[164:167], a[20:23], a[92:95], v[164:167]
    ds_read_b64 a[42:43], v65 offset:328
    ds_read_b128 a[72:75], v66 offset:2880
    s_waitcnt lgkmcnt(11)
    v_mfma_f32_16x16x32_bf16 v[168:171], a[24:27], a[92:95], v[168:171]
    ds_read_b64 a[44:45], v65 offset:352
    ds_read_b64 a[46:47], v65 offset:360
    s_waitcnt lgkmcnt(12)
    v_mfma_f32_16x16x32_bf16 v[160:163], a[24:27], a[88:91], v[160:163]
    ds_read_b64 a[48:49], v65 offset:384
    ds_read_b64 a[50:51], v65 offset:392
    buffer_load_dwordx4 v50, s[16:19], s55 offen offset:2048 sc1 lds
    s_waitcnt lgkmcnt(12)
    v_mfma_f32_16x16x32_bf16 v[172:175], a[28:31], a[92:95], v[172:175]
    ds_read_b64 a[52:53], v65 offset:416
    ds_read_b64 a[54:55], v65 offset:424
    v_mfma_f32_16x16x32_bf16 v[164:167], a[28:31], a[88:91], v[164:167]
    s_waitcnt lgkmcnt(12)
    v_mfma_f32_16x16x32_bf16 v[168:171], a[32:35], a[88:91], v[168:171]
    s_waitcnt lgkmcnt(10)
    v_mfma_f32_16x16x32_bf16 v[172:175], a[36:39], a[88:91], v[172:175]
    buffer_load_dwordx4 v51, s[16:19], s55 offen offset:3072 sc1 lds
    s_waitcnt lgkmcnt(9)
    v_mfma_f32_16x16x32_bf16 v[160:163], a[32:35], a[76:79], v[160:163]
    ds_read_b128 a[92:95], v66 offset:2784
    ds_read_b64 a[56:57], v65 offset:448
    v_mfma_f32_16x16x32_bf16 v[164:167], a[36:39], a[76:79], v[164:167]
    ds_read_b64 a[58:59], v65 offset:456
    ds_read_b128 a[88:91], v66 offset:2720
    s_waitcnt lgkmcnt(11)
    v_mfma_f32_16x16x32_bf16 v[168:171], a[40:43], a[76:79], v[168:171]
    ds_read_b64 a[60:61], v65 offset:480
    ds_read_b64 a[62:63], v65 offset:488
    s_waitcnt lgkmcnt(12)
    v_mfma_f32_16x16x32_bf16 v[160:163], a[40:43], a[72:75], v[160:163]
    ds_read_b64 a[0:1], v65 offset:512
    ds_read_b64 a[2:3], v65 offset:520
    s_add_u32 m0, s52, 16384
    s_nop 0
    buffer_load_dwordx4 v52, s[16:19], s55 offen offset:0 sc1 lds
    s_waitcnt lgkmcnt(12)
    v_mfma_f32_16x16x32_bf16 v[172:175], a[44:47], a[76:79], v[172:175]
    ds_read_b64 a[4:5], v65 offset:544
    ds_read_b64 a[6:7], v65 offset:552
    v_mfma_f32_16x16x32_bf16 v[164:167], a[44:47], a[72:75], v[164:167]
    s_waitcnt lgkmcnt(12)
    v_mfma_f32_16x16x32_bf16 v[168:171], a[48:51], a[72:75], v[168:171]
    s_waitcnt lgkmcnt(10)
    v_mfma_f32_16x16x32_bf16 v[172:175], a[52:55], a[72:75], v[172:175]
    s_waitcnt lgkmcnt(9)
    v_mfma_f32_16x16x32_bf16 v[160:163], a[48:51], a[92:95], v[160:163]
    ds_read_b128 a[76:79], v66 offset:2624
    ds_read_b64 a[8:9], v65 offset:576
    v_mfma_f32_16x16x32_bf16 v[164:167], a[52:55], a[92:95], v[164:167]
    ds_read_b64 a[10:11], v65 offset:584
    ds_read_b128 a[72:75], v66 offset:2560
    s_waitcnt lgkmcnt(11)
    v_mfma_f32_16x16x32_bf16 v[168:171], a[56:59], a[92:95], v[168:171]
    ds_read_b64 a[12:13], v65 offset:608
    ds_read_b64 a[14:15], v65 offset:616
    s_waitcnt lgkmcnt(12)
    v_mfma_f32_16x16x32_bf16 v[160:163], a[56:59], a[88:91], v[160:163]
    ds_read_b64 a[16:17], v65 offset:640
    ds_read_b64 a[18:19], v65 offset:648
    s_waitcnt lgkmcnt(12)
    v_mfma_f32_16x16x32_bf16 v[172:175], a[60:63], a[92:95], v[172:175]
    ds_read_b64 a[20:21], v65 offset:672
    ds_read_b64 a[22:23], v65 offset:680
    v_mfma_f32_16x16x32_bf16 v[164:167], a[60:63], a[88:91], v[164:167]
    s_waitcnt lgkmcnt(12)
    v_mfma_f32_16x16x32_bf16 v[168:171], a[0:3], a[88:91], v[168:171]
    s_waitcnt lgkmcnt(10)
    v_mfma_f32_16x16x32_bf16 v[172:175], a[4:7], a[88:91], v[172:175]
    s_waitcnt lgkmcnt(0)
    s_nop 7
    s_barrier
    s_mul_i32 s57, s21, 6144
    s_add_u32 s57, s57, 69632
    v_add_u32 v136, s57, v69
    v_add_u32 v137, 69632, v69
    s_cmp_lg_u32 s21, 0
    s_cbranch_scc1 Lw_29
    ds_write_b128 v136, v[152:155] offset:0
    ds_write_b128 v136, v[156:159] offset:1024
    ds_write_b128 v136, v[160:163] offset:2048
    ds_write_b128 v136, v[164:167] offset:3072
    ds_write_b128 v136, v[168:171] offset:4096
    ds_write_b128 v136, v[172:175] offset:5120
    v_mov_b32 v192, v144
    v_mov_b32 v193, v145
    v_mov_b32 v194, v146
    v_mov_b32 v195, v147
    v_mov_b32 v196, v148
    v_mov_b32 v197, v149
    v_mov_b32 v198, v150
    v_mov_b32 v199, v151
    s_waitcnt lgkmcnt(0)
    s_barrier
    ds_read_b128 v[144:147], v137 offset:6144
    ds_read_b128 v[148:151], v137 offset:7168
    ds_read_b128 v[152:155], v137 offset:12288
    ds_read_b128 v[156:159], v137 offset:13312
    ds_read_b128 v[160:163], v137 offset:18432
    ds_read_b128 v[164:167], v137 offset:19456
    s_waitcnt lgkmcnt(5)
    v_add_f32 v192, v192, v144
    v_add_f32 v193, v193, v145
    v_add_f32 v194, v194, v146
    v_add_f32 v195, v195, v147
    s_waitcnt lgkmcnt(4)
    v_add_f32 v196, v196, v148
    v_add_f32 v197, v197, v149
    v_add_f32 v198, v198, v150
    v_add_f32 v199, v199, v151
    s_waitcnt lgkmcnt(3)
    v_add_f32 v192, v192, v152
    v_add_f32 v193, v193, v153
    v_add_f32 v194, v194, v154
    v_add_f32 v195, v195, v155
    s_waitcnt lgkmcnt(2)
    v_add_f32 v196, v196, v156
    v_add_f32 v197, v197, v157
    v_add_f32 v198, v198, v158
    v_add_f32 v199, v199, v159
    s_waitcnt lgkmcnt(1)
    v_add_f32 v192, v192, v160
    v_add_f32 v193, v193, v161
    v_add_f32 v194, v194, v162
    v_add_f32 v195, v195, v163
    s_waitcnt lgkmcnt(0)
    v_add_f32 v196, v196, v164
    v_add_f32 v197, v197, v165
    v_add_f32 v198, v198, v166
    v_add_f32 v199, v199, v167
    s_branch Lw_27
Lw_29:
    s_cmp_lg_u32 s21, 1
    s_cbranch_scc1 Lw_30
    ds_write_b128 v136, v[144:147] offset:0
    ds_write_b128 v136, v[148:151] offset:1024
    ds_write_b128 v136, v[160:163] offset:2048
    ds_write_b128 v136, v[164:167] offset:3072
    ds_write_b128 v136, v[168:171] offset:4096
    ds_write_b128 v136, v[172:175] offset:5120
    v_mov_b32 v192, v152
    v_mov_b32 v193, v153
    v_mov_b32 v194, v154
    v_mov_b32 v195, v155
    v_mov_b32 v196, v156
    v_mov_b32 v197, v157
    v_mov_b32 v198, v158
    v_mov_b32 v199, v159
    s_waitcnt lgkmcnt(0)
    s_barrier
    ds_read_b128 v[144:147], v137 offset:0
    ds_read_b128 v[148:151], v137 offset:1024
    ds_read_b128 v[152:155], v137 offset:14336
    ds_read_b128 v[156:159], v137 offset:15360
    ds_read_b128 v[160:163], v137 offset:20480
    ds_read_b128 v[164:167], v137 offset:21504
    s_waitcnt lgkmcnt(5)
    v_add_f32 v192, v192, v144
    v_add_f32 v193, v193, v145
    v_add_f32 v194, v194, v146
    v_add_f32 v195, v195, v147
    s_waitcnt lgkmcnt(4)
    v_add_f32 v196, v196, v148
    v_add_f32 v197, v197, v149
    v_add_f32 v198, v198, v150
    v_add_f32 v199, v199, v151
    s_waitcnt lgkmcnt(3)
    v_add_f32 v192, v192, v152
    v_add_f32 v193, v193, v153
    v_add_f32 v194, v194, v154
    v_add_f32 v195, v195, v155
    s_waitcnt lgkmcnt(2)
    v_add_f32 v196, v196, v156
    v_add_f32 v197, v197, v157
    v_add_f32 v198, v198, v158
    v_add_f32 v199, v199, v159
    s_waitcnt lgkmcnt(1)
    v_add_f32 v192, v192, v160
    v_add_f32 v193, v193, v161
    v_add_f32 v194, v194, v162
    v_add_f32 v195, v195, v163
    s_waitcnt lgkmcnt(0)
    v_add_f32 v196, v196, v164
    v_add_f32 v197, v197, v165
    v_add_f32 v198, v198, v166
    v_add_f32 v199, v199, v167
    s_branch Lw_27
Lw_30:
    s_cmp_lg_u32 s21, 2
    s_cbranch_scc1 Lw_31
    ds_write_b128 v136, v[144:147] offset:0
    ds_write_b128 v136, v[148:151] offset:1024
    ds_write_b128 v136, v[152:155] offset:2048
    ds_write_b128 v136, v[156:159] offset:3072
    ds_write_b128 v136, v[168:171] offset:4096
    ds_write_b128 v136, v[172:175] offset:5120
    v_mov_b32 v192, v160
    v_mov_b32 v193, v161
    v_mov_b32 v194, v162
    v_mov_b32 v195, v163
    v_mov_b32 v196, v164
    v_mov_b32 v197, v165
    v_mov_b32 v198, v166
    v_mov_b32 v199, v167
    s_waitcnt lgkmcnt(0)
    s_barrier
    ds_read_b128 v[144:147], v137 offset:2048
    ds_read_b128 v[148:151], v137 offset:3072
    ds_read_b128 v[152:155], v137 offset:8192
    ds_read_b128 v[156:159], v137 offset:9216
    ds_read_b128 v[160:163], v137 offset:22528
    ds_read_b128 v[164:167], v137 offset:23552
    s_waitcnt lgkmcnt(5)
    v_add_f32 v192, v192, v144
    v_add_f32 v193, v193, v145
    v_add_f32 v194, v194, v146
    v_add_f32 v195, v195, v147
    s_waitcnt lgkmcnt(4)
    v_add_f32 v196, v196, v148
    v_add_f32 v197, v197, v149
    v_add_f32 v198, v198, v150
    v_add_f32 v199, v199, v151
    s_waitcnt lgkmcnt(3)
    v_add_f32 v192, v192, v152
    v_add_f32 v193, v193, v153
    v_add_f32 v194, v194, v154
    v_add_f32 v195, v195, v155
    s_waitcnt lgkmcnt(2)
    v_add_f32 v196, v196, v156
    v_add_f32 v197, v197, v157
    v_add_f32 v198, v198, v158
    v_add_f32 v199, v199, v159
    s_waitcnt lgkmcnt(1)
    v_add_f32 v192, v192, v160
    v_add_f32 v193, v193, v161
    v_add_f32 v194, v194, v162
    v_add_f32 v195, v195, v163
    s_waitcnt lgkmcnt(0)
    v_add_f32 v196, v196, v164
    v_add_f32 v197, v197, v165
    v_add_f32 v198, v198, v166
    v_add_f32 v199, v199, v167
    s_branch Lw_27
Lw_31:
    ds_write_b128 v136, v[144:147] offset:0
    ds_write_b128 v136, v[148:151] offset:1024
    ds_write_b128 v136, v[152:155] offset:2048
    ds_write_b128 v136, v[156:159] offset:3072
    ds_write_b128 v136, v[160:163] offset:4096
    ds_write_b128 v136, v[164:167] offset:5120
    v_mov_b32 v192, v168
    v_mov_b32 v193, v169
    v_mov_b32 v194, v170
    v_mov_b32 v195, v171
    v_mov_b32 v196, v172
    v_mov_b32 v197, v173
    v_mov_b32 v198, v174
    v_mov_b32 v199, v175
    s_waitcnt lgkmcnt(0)
    s_barrier
    ds_read_b128 v[144:147], v137 offset:4096
    ds_read_b128 v[148:151], v137 offset:5120
    ds_read_b128 v[152:155], v137 offset:10240
    ds_read_b128 v[156:159], v137 offset:11264
    ds_read_b128 v[160:163], v137 offset:16384
    ds_read_b128 v[164:167], v137 offset:17408
    s_waitcnt lgkmcnt(5)
    v_add_f32 v192, v192, v144
    v_add_f32 v193, v193, v145
    v_add_f32 v194, v194, v146
    v_add_f32 v195, v195, v147
    s_waitcnt lgkmcnt(4)
    v_add_f32 v196, v196, v148
    v_add_f32 v197, v197, v149
    v_add_f32 v198, v198, v150
    v_add_f32 v199, v199, v151
    s_waitcnt lgkmcnt(3)
    v_add_f32 v192, v192, v152
    v_add_f32 v193, v193, v153
    v_add_f32 v194, v194, v154
    v_add_f32 v195, v195, v155
    s_waitcnt lgkmcnt(2)
    v_add_f32 v196, v196, v156
    v_add_f32 v197, v197, v157
    v_add_f32 v198, v198, v158
    v_add_f32 v199, v199, v159
    s_waitcnt lgkmcnt(1)
    v_add_f32 v192, v192, v160
    v_add_f32 v193, v193, v161
    v_add_f32 v194, v194, v162
    v_add_f32 v195, v195, v163
    s_waitcnt lgkmcnt(0)
    v_add_f32 v196, v196, v164
    v_add_f32 v197, v197, v165
    v_add_f32 v198, v198, v166
    v_add_f32 v199, v199, v167
Lw_27:
    v_cvt_pk_bf16_f32 v192, v192, v193
    v_cvt_pk_bf16_f32 v193, v194, v195
    v_cvt_pk_bf16_f32 v196, v196, v197
    v_cvt_pk_bf16_f32 v197, v198, v199
    v_and_b32 v136, 15, v1
    v_lshlrev_b32 v136, 7, v136
    v_lshrrev_b32 v137, 4, v1
    v_lshl_add_u32 v136, v137, 3, v136
    s_lshr_b32 s57, s21, 1
    s_lshl_b32 s57, s57, 11
    s_and_b32 s58, s21, 1
    s_lshl_b32 s58, s58, 6
    s_add_u32 s57, s57, s58
    s_lshl_b32 s58, s86, 12
    s_add_u32 s57, s57, s58
    s_add_u32 s57, s57, 2621440
    buffer_store_dwordx2 v[192:193], v136, s[16:19], s57 offen offset:0 sc1
    buffer_store_dwordx2 v[196:197], v136, s[16:19], s57 offen offset:32 sc1
    s_waitcnt vmcnt(2)
    s_lshl_b32 s56, s21, 1
    s_add_u32 s56, s56, 1
    s_mul_i32 s56, s56, 7520
    s_add_u32 s56, s56, 87040
    v_add_u32 v65, s52, v63
    v_add_u32 v66, s56, v64
    v_subrev_u32 v66, 160, v66
    ds_read_b128 a[68:71], v66 offset:704
    ds_read_b128 a[64:67], v66 offset:640
    ds_read_b128 a[76:79], v66 offset:3264
    ds_read_b128 a[72:75], v66 offset:3200
    ds_read_b64 a[0:1], v65 offset:0
    ds_read_b64 a[2:3], v65 offset:8
    ds_read_b64 a[4:5], v65 offset:32
    ds_read_b64 a[6:7], v65 offset:40
    ds_read_b64 a[8:9], v65 offset:64
    ds_read_b64 a[10:11], v65 offset:72
    ds_read_b64 a[12:13], v65 offset:96
    ds_read_b64 a[14:15], v65 offset:104
    ds_read_b64 a[16:17], v65 offset:128
    ds_read_b64 a[18:19], v65 offset:136
    ds_read_b64 a[20:21], v65 offset:160
    ds_read_b64 a[22:23], v65 offset:168
    s_waitcnt lgkmcnt(10)
    v_mfma_f32_16x16x32_bf16 v[144:147], a[0:3], a[68:71], 0
    ds_read_b128 a[84:87], v66 offset:544
    v_mfma_f32_16x16x32_bf16 v[160:163], a[0:3], a[76:79], 0
    ds_read_b64 a[24:25], v65 offset:192
    s_waitcnt lgkmcnt(10)
    v_mfma_f32_16x16x32_bf16 v[148:151], a[4:7], a[68:71], 0
    ds_read_b64 a[26:27], v65 offset:200
    v_mfma_f32_16x16x32_bf16 v[164:167], a[4:7], a[76:79], 0
    ds_read_b128 a[80:83], v66 offset:480
    s_waitcnt lgkmcnt(10)
    v_mfma_f32_16x16x32_bf16 v[152:155], a[8:11], a[68:71], 0
    ds_read_b128 a[92:95], v66 offset:3104
    v_mfma_f32_16x16x32_bf16 v[168:171], a[8:11], a[76:79], 0
    ds_read_b128 a[88:91], v66 offset:3040
    v_mfma_f32_16x16x32_bf16 v[144:147], a[8:11], a[64:67], v[144:147]
    ds_read_b64 a[28:29], v65 offset:224
    v_mfma_f32_16x16x32_bf16 v[160:163], a[8:11], a[72:75], v[160:163]
    ds_read_b64 a[30:31], v65 offset:232
    s_waitcnt lgkmcnt(12)
    v_mfma_f32_16x16x32_bf16 v[156:159], a[12:15], a[68:71], 0
    ds_read_b64 a[32:33], v65 offset:256
    v_mfma_f32_16x16x32_bf16 v[172:175], a[12:15], a[76:79], 0
    ds_read_b64 a[34:35], v65 offset:264
    v_mfma_f32_16x16x32_bf16 v[148:151], a[12:15], a[64:67], v[148:151]
    ds_read_b64 a[36:37], v65 offset:288
    v_mfma_f32_16x16x32_bf16 v[164:167], a[12:15], a[72:75], v[164:167]
    ds_read_b64 a[38:39], v65 offset:296
    s_waitcnt lgkmcnt(14)
    v_mfma_f32_16x16x32_bf16 v[152:155], a[16:19], a[64:67], v[152:155]
    v_mfma_f32_16x16x32_bf16 v[168:171], a[16:19], a[72:75], v[168:171]
    s_waitcnt lgkmcnt(12)
    v_mfma_f32_16x16x32_bf16 v[156:159], a[20:23], a[64:67], v[156:159]
    v_mfma_f32_16x16x32_bf16 v[172:175], a[20:23], a[72:75], v[172:175]
    s_waitcnt lgkmcnt(11)
    v_mfma_f32_16x16x32_bf16 v[144:147], a[16:19], a[84:87], v[144:147]
    ds_read_b128 a[68:71], v66 offset:384
    s_waitcnt lgkmcnt(8)
    v_mfma_f32_16x16x32_bf16 v[160:163], a[16:19], a[92:95], v[160:163]
    ds_read_b64 a[40:41], v65 offset:320
    v_mfma_f32_16x16x32_bf16 v[148:151], a[20:23], a[84:87], v[148:151]
    ds_read_b64 a[42:43], v65 offset:328
    v_mfma_f32_16x16x32_bf16 v[164:167], a[20:23], a[92:95], v[164:167]
    ds_read_b128 a[64:67], v66 offset:320
    v_mfma_f32_16x16x32_bf16 v[152:155], a[24:27], a[84:87], v[152:155]
    ds_read_b128 a[76:79], v66 offset:2944
    v_mfma_f32_16x16x32_bf16 v[168:171], a[24:27], a[92:95], v[168:171]
    ds_read_b128 a[72:75], v66 offset:2880
    v_mfma_f32_16x16x32_bf16 v[144:147], a[24:27], a[80:83], v[144:147]
    ds_read_b64 a[44:45], v65 offset:352
    s_waitcnt lgkmcnt(13)
    v_mfma_f32_16x16x32_bf16 v[160:163], a[24:27], a[88:91], v[160:163]
    ds_read_b64 a[46:47], v65 offset:360
    s_waitcnt lgkmcnt(12)
    v_mfma_f32_16x16x32_bf16 v[156:159], a[28:31], a[84:87], v[156:159]
    ds_read_b64 a[48:49], v65 offset:384
    v_mfma_f32_16x16x32_bf16 v[172:175], a[28:31], a[92:95], v[172:175]
    ds_read_b64 a[50:51], v65 offset:392
    v_mfma_f32_16x16x32_bf16 v[148:151], a[28:31], a[80:83], v[148:151]
    ds_read_b64 a[52:53], v65 offset:416
    v_mfma_f32_16x16x32_bf16 v[164:167], a[28:31], a[88:91], v[164:167]
    ds_read_b64 a[54:55], v65 offset:424
    s_waitcnt lgkmcnt(14)
    v_mfma_f32_16x16x32_bf16 v[152:155], a[32:35], a[80:83], v[152:155]
    v_mfma_f32_16x16x32_bf16 v[168:171], a[32:35], a[88:91], v[168:171]
    s_waitcnt lgkmcnt(12)
    v_mfma_f32_16x16x32_bf16 v[156:159], a[36:39], a[80:83], v[156:159]
    v_mfma_f32_16x16x32_bf16 v[172:175], a[36:39], a[88:91], v[172:175]
    s_waitcnt lgkmcnt(11)
    v_mfma_f32_16x16x32_bf16 v[144:147], a[32:35], a[68:71], v[144:147]
    ds_read_b128 a[84:87], v66 offset:224
    s_waitcnt lgkmcnt(8)
    v_mfma_f32_16x16x32_bf16 v[160:163], a[32:35], a[76:79], v[160:163]
    ds_read_b64 a[56:57], v65 offset:448
    v_mfma_f32_16x16x32_bf16 v[148:151], a[36:39], a[68:71], v[148:151]
    ds_read_b64 a[58:59], v65 offset:456
    v_mfma_f32_16x16x32_bf16 v[164:167], a[36:39], a[76:79], v[164:167]
    ds_read_b128 a[80:83], v66 offset:160
    v_mfma_f32_16x16x32_bf16 v[152:155], a[40:43], a[68:71], v[152:155]
    ds_read_b128 a[92:95], v66 offset:2784
    v_mfma_f32_16x16x32_bf16 v[168:171], a[40:43], a[76:79], v[168:171]
    ds_read_b128 a[88:91], v66 offset:2720
    v_mfma_f32_16x16x32_bf16 v[144:147], a[40:43], a[64:67], v[144:147]
    ds_read_b64 a[60:61], v65 offset:480
    s_waitcnt lgkmcnt(13)
    v_mfma_f32_16x16x32_bf16 v[160:163], a[40:43], a[72:75], v[160:163]
    ds_read_b64 a[62:63], v65 offset:488
    s_waitcnt lgkmcnt(12)
    v_mfma_f32_16x16x32_bf16 v[156:159], a[44:47], a[68:71], v[156:159]
    ds_read_b64 a[0:1], v65 offset:512
    v_mfma_f32_16x16x32_bf16 v[172:175], a[44:47], a[76:79], v[172:175]
    ds_read_b64 a[2:3], v65 offset:520
    v_mfma_f32_16x16x32_bf16 v[148:151], a[44:47], a[64:67], v[148:151]
    ds_read_b64 a[4:5], v65 offset:544
    v_mfma_f32_16x16x32_bf16 v[164:167], a[44:47], a[72:75], v[164:167]
    ds_read_b64 a[6:7], v65 offset:552
    s_waitcnt lgkmcnt(14)
    v_mfma_f32_16x16x32_bf16 v[152:155], a[48:51], a[64:67], v[152:155]
    v_mfma_f32_16x16x32_bf16 v[168:171], a[48:51], a[72:75], v[168:171]
    s_waitcnt lgkmcnt(12)
    v_mfma_f32_16x16x32_bf16 v[156:159], a[52:55], a[64:67], v[156:159]
    v_mfma_f32_16x16x32_bf16 v[172:175], a[52:55], a[72:75], v[172:175]
    s_waitcnt lgkmcnt(11)
    v_mfma_f32_16x16x32_bf16 v[144:147], a[48:51], a[84:87], v[144:147]
    ds_read_b128 a[68:71], v66 offset:64
    s_waitcnt lgkmcnt(8)
    v_mfma_f32_16x16x32_bf16 v[160:163], a[48:51], a[92:95], v[160:163]
    ds_read_b64 a[8:9], v65 offset:576
    v_mfma_f32_16x16x32_bf16 v[148:151], a[52:55], a[84:87], v[148:151]
    ds_read_b64 a[10:11], v65 offset:584
    v_mfma_f32_16x16x32_bf16 v[164:167], a[52:55], a[92:95], v[164:167]
    ds_read_b128 a[64:67], v66 offset:0
    v_mfma_f32_16x16x32_bf16 v[152:155], a[56:59], a[84:87], v[152:155]
    ds_read_b128 a[76:79], v66 offset:2624
    v_mfma_f32_16x16x32_bf16 v[168:171], a[56:59], a[92:95], v[168:171]
    ds_read_b128 a[72:75], v66 offset:2560
    v_mfma_f32_16x16x32_bf16 v[144:147], a[56:59], a[80:83], v[144:147]
    ds_read_b64 a[12:13], v65 offset:608
    s_waitcnt lgkmcnt(13)
    v_mfma_f32_16x16x32_bf16 v[160:163], a[56:59], a[88:91], v[160:163]
    ds_read_b64 a[14:15], v65 offset:616
    s_waitcnt lgkmcnt(12)
    v_mfma_f32_16x16x32_bf16 v[156:159], a[60:63], a[84:87], v[156:159]
    ds_read_b64 a[16:17], v65 offset:640
    v_mfma_f32_16x16x32_bf16 v[172:175], a[60:63], a[92:95], v[172:175]
    ds_read_b64 a[18:19], v65 offset:648
    v_mfma_f32_16x16x32_bf16 v[148:151], a[60:63], a[80:83], v[148:151]
    ds_read_b64 a[20:21], v65 offset:672
    v_mfma_f32_16x16x32_bf16 v[164:167], a[60:63], a[88:91], v[164:167]
    ds_read_b64 a[22:23], v65 offset:680
    s_waitcnt lgkmcnt(14)
    v_mfma_f32_16x16x32_bf16 v[152:155], a[0:3], a[80:83], v[152:155]
    v_mfma_f32_16x16x32_bf16 v[168:171], a[0:3], a[88:91], v[168:171]
    s_waitcnt lgkmcnt(12)
    v_mfma_f32_16x16x32_bf16 v[156:159], a[4:7], a[80:83], v[156:159]
    v_mfma_f32_16x16x32_bf16 v[172:175], a[4:7], a[88:91], v[172:175]
    v_add_u32 v65, 512, v65
    v_subrev_u32 v66, 640, v66
    s_mov_b32 s54, 3
L_cBa:
    s_waitcnt lgkmcnt(11)
    v_mfma_f32_16x16x32_bf16 v[144:147], a[0:3], a[68:71], v[144:147]
    ds_read_b128 a[84:87], v66 offset:544
    s_waitcnt lgkmcnt(8)
    v_mfma_f32_16x16x32_bf16 v[160:163], a[0:3], a[76:79], v[160:163]
    ds_read_b64 a[24:25], v65 offset:192
    v_mfma_f32_16x16x32_bf16 v[148:151], a[4:7], a[68:71], v[148:151]
    ds_read_b64 a[26:27], v65 offset:200
    v_mfma_f32_16x16x32_bf16 v[164:167], a[4:7], a[76:79], v[164:167]
    ds_read_b128 a[80:83], v66 offset:480
    v_mfma_f32_16x16x32_bf16 v[152:155], a[8:11], a[68:71], v[152:155]
    ds_read_b128 a[92:95], v66 offset:3104
    v_mfma_f32_16x16x32_bf16 v[168:171], a[8:11], a[76:79], v[168:171]
    ds_read_b128 a[88:91], v66 offset:3040
    v_mfma_f32_16x16x32_bf16 v[144:147], a[8:11], a[64:67], v[144:147]
    ds_read_b64 a[28:29], v65 offset:224
    s_waitcnt lgkmcnt(13)
    v_mfma_f32_16x16x32_bf16 v[160:163], a[8:11], a[72:75], v[160:163]
    ds_read_b64 a[30:31], v65 offset:232
    s_waitcnt lgkmcnt(12)
    v_mfma_f32_16x16x32_bf16 v[156:159], a[12:15], a[68:71], v[156:159]
    ds_read_b64 a[32:33], v65 offset:256
    v_mfma_f32_16x16x32_bf16 v[172:175], a[12:15], a[76:79], v[172:175]
    ds_read_b64 a[34:35], v65 offset:264
    v_mfma_f32_16x16x32_bf16 v[148:151], a[12:15], a[64:67], v[148:151]
    ds_read_b64 a[36:37], v65 offset:288
    v_mfma_f32_16x16x32_bf16 v[164:167], a[12:15], a[72:75], v[164:167]
    ds_read_b64 a[38:39], v65 offset:296
    s_waitcnt lgkmcnt(14)
    v_mfma_f32_16x16x32_bf16 v[152:155], a[16:19], a[64:67], v[152:155]
    v_mfma_f32_16x16x32_bf16 v[168:171], a[16:19], a[72:75], v[168:171]
    s_waitcnt lgkmcnt(12)
    v_mfma_f32_16x16x32_bf16 v[156:159], a[20:23], a[64:67], v[156:159]
    v_mfma_f32_16x16x32_bf16 v[172:175], a[20:23], a[72:75], v[172:175]
    s_waitcnt lgkmcnt(11)
    v_mfma_f32_16x16x32_bf16 v[144:147], a[16:19], a[84:87], v[144:147]
    ds_read_b128 a[68:71], v66 offset:384
    s_waitcnt lgkmcnt(8)
    v_mfma_f32_16x16x32_bf16 v[160:163], a[16:19], a[92:95], v[160:163]
    ds_read_b64 a[40:41], v65 offset:320
    v_mfma_f32_16x16x32_bf16 v[148:151], a[20:23], a[84:87], v[148:151]
    ds_read_b64 a[42:43], v65 offset:328
    v_mfma_f32_16x16x32_bf16 v[164:167], a[20:23], a[92:95], v[164:167]
    ds_read_b128 a[64:67], v66 offset:320
    v_mfma_f32_16x16x32_bf16 v[152:155], a[24:27], a[84:87], v[152:155]
    ds_read_b128 a[76:79], v66 offset:2944
    v_mfma_f32_16x16x32_bf16 v[168:171], a[24:27], a[92:95], v[168:171]
    ds_read_b128 a[72:75], v66 offset:2880
    v_mfma_f32_16x16x32_bf16 v[144:147], a[24:27], a[80:83], v[144:147]
    ds_read_b64 a[44:45], v65 offset:352
    s_waitcnt lgkmcnt(13)
    v_mfma_f32_16x16x32_bf16 v[160:163], a[24:27], a[88:91], v[160:163]
    ds_read_b64 a[46:47], v65 offset:360
    s_waitcnt lgkmcnt(12)
    v_mfma_f32_16x16x32_bf16 v[156:159], a[28:31], a[84:87], v[156:159]
    ds_read_b64 a[48:49], v65 offset:384
    v_mfma_f32_16x16x32_bf16 v[172:175], a[28:31], a[92:95], v[172:175]
    ds_read_b64 a[50:51], v65 offset:392
    v_mfma_f32_16x16x32_bf16 v[148:151], a[28:31], a[80:83], v[148:151]
    ds_read_b64 a[52:53], v65 offset:416
    v_mfma_f32_16x16x32_bf16 v[164:167], a[28:31], a[88:91], v[164:167]
    ds_read_b64 a[54:55], v65 offset:424
    s_waitcnt lgkmcnt(14)
    v_mfma_f32_16x16x32_bf16 v[152:155], a[32:35], a[80:83], v[152:155]
    v_mfma_f32_16x16x32_bf16 v[168:171], a[32:35], a[88:91], v[168:171]
    s_waitcnt lgkmcnt(12)
    v_mfma_f32_16x16x32_bf16 v[156:159], a[36:39], a[80:83], v[156:159]
    v_mfma_f32_16x16x32_bf16 v[172:175], a[36:39], a[88:91], v[172:175]
    s_waitcnt lgkmcnt(11)
    v_mfma_f32_16x16x32_bf16 v[144:147], a[32:35], a[68:71], v[144:147]
    ds_read_b128 a[84:87], v66 offset:224
    s_waitcnt lgkmcnt(8)
    v_mfma_f32_16x16x32_bf16 v[160:163], a[32:35], a[76:79], v[160:163]
    ds_read_b64 a[56:57], v65 offset:448
    v_mfma_f32_16x16x32_bf16 v[148:151], a[36:39], a[68:71], v[148:151]
    ds_read_b64 a[58:59], v65 offset:456
    v_mfma_f32_16x16x32_bf16 v[164:167], a[36:39], a[76:79], v[164:167]
    ds_read_b128 a[80:83], v66 offset:160
    v_mfma_f32_16x16x32_bf16 v[152:155], a[40:43], a[68:71], v[152:155]
    ds_read_b128 a[92:95], v66 offset:2784
    v_mfma_f32_16x16x32_bf16 v[168:171], a[40:43], a[76:79], v[168:171]
    ds_read_b128 a[88:91], v66 offset:2720
    v_mfma_f32_16x16x32_bf16 v[144:147], a[40:43], a[64:67], v[144:147]
    ds_read_b64 a[60:61], v65 offset:480
    s_waitcnt lgkmcnt(13)
    v_mfma_f32_16x16x32_bf16 v[160:163], a[40:43], a[72:75], v[160:163]
    ds_read_b64 a[62:63], v65 offset:488
    s_waitcnt lgkmcnt(12)
    v_mfma_f32_16x16x32_bf16 v[156:159], a[44:47], a[68:71], v[156:159]
    ds_read_b64 a[0:1], v65 offset:512
    v_mfma_f32_16x16x32_bf16 v[172:175], a[44:47], a[76:79], v[172:175]
    ds_read_b64 a[2:3], v65 offset:520
    v_mfma_f32_16x16x32_bf16 v[148:151], a[44:47], a[64:67], v[148:151]
    ds_read_b64 a[4:5], v65 offset:544
    v_mfma_f32_16x16x32_bf16 v[164:167], a[44:47], a[72:75], v[164:167]
    ds_read_b64 a[6:7], v65 offset:552
    s_waitcnt lgkmcnt(14)
    v_mfma_f32_16x16x32_bf16 v[152:155], a[48:51], a[64:67], v[152:155]
    v_mfma_f32_16x16x32_bf16 v[168:171], a[48:51], a[72:75], v[168:171]
    s_waitcnt lgkmcnt(12)
    v_mfma_f32_16x16x32_bf16 v[156:159], a[52:55], a[64:67], v[156:159]
    v_mfma_f32_16x16x32_bf16 v[172:175], a[52:55], a[72:75], v[172:175]
    s_waitcnt lgkmcnt(11)
    v_mfma_f32_16x16x32_bf16 v[144:147], a[48:51], a[84:87], v[144:147]
    ds_read_b128 a[68:71], v66 offset:64
    s_waitcnt lgkmcnt(8)
    v_mfma_f32_16x16x32_bf16 v[160:163], a[48:51], a[92:95], v[160:163]
    ds_read_b64 a[8:9], v65 offset:576
    v_mfma_f32_16x16x32_bf16 v[148:151], a[52:55], a[84:87], v[148:151]
    ds_read_b64 a[10:11], v65 offset:584
    v_mfma_f32_16x16x32_bf16 v[164:167], a[52:55], a[92:95], v[164:167]
    ds_read_b128 a[64:67], v66 offset:0
    v_mfma_f32_16x16x32_bf16 v[152:155], a[56:59], a[84:87], v[152:155]
    ds_read_b128 a[76:79], v66 offset:2624
    v_mfma_f32_16x16x32_bf16 v[168:171], a[56:59], a[92:95], v[168:171]
    ds_read_b128 a[72:75], v66 offset:2560
    v_mfma_f32_16x16x32_bf16 v[144:147], a[56:59], a[80:83], v[144:147]
    ds_read_b64 a[12:13], v65 offset:608
    s_waitcnt lgkmcnt(13)
    v_mfma_f32_16x16x32_bf16 v[160:163], a[56:59], a[88:91], v[160:163]
    ds_read_b64 a[14:15], v65 offset:616
    s_waitcnt lgkmcnt(12)
    v_mfma_f32_16x16x32_bf16 v[156:159], a[60:63], a[84:87], v[156:159]
    ds_read_b64 a[16:17], v65 offset:640
    v_mfma_f32_16x16x32_bf16 v[172:175], a[60:63], a[92:95], v[172:175]
    ds_read_b64 a[18:19], v65 offset:648
    v_mfma_f32_16x16x32_bf16 v[148:151], a[60:63], a[80:83], v[148:151]
    ds_read_b64 a[20:21], v65 offset:672
    v_mfma_f32_16x16x32_bf16 v[164:167], a[60:63], a[88:91], v[164:167]
    ds_read_b64 a[22:23], v65 offset:680
    s_waitcnt lgkmcnt(14)
    v_mfma_f32_16x16x32_bf16 v[152:155], a[0:3], a[80:83], v[152:155]
    v_mfma_f32_16x16x32_bf16 v[168:171], a[0:3], a[88:91], v[168:171]
    s_waitcnt lgkmcnt(12)
    v_mfma_f32_16x16x32_bf16 v[156:159], a[4:7], a[80:83], v[156:159]
    v_mfma_f32_16x16x32_bf16 v[172:175], a[4:7], a[88:91], v[172:175]
    v_add_u32 v65, 512, v65
    v_subrev_u32 v66, 640, v66
    s_sub_u32 s54, s54, 1
    s_cmp_lg_u32 s54, 0
    s_cbranch_scc1 L_cBa
    s_waitcnt lgkmcnt(7)
    v_mfma_f32_16x16x32_bf16 v[160:163], a[0:3], a[76:79], v[160:163]
    ds_read_b128 a[92:95], v66 offset:3104
    ds_read_b64 a[24:25], v65 offset:192
    v_mfma_f32_16x16x32_bf16 v[164:167], a[4:7], a[76:79], v[164:167]
    ds_read_b64 a[26:27], v65 offset:200
    ds_read_b128 a[88:91], v66 offset:3040
    v_mfma_f32_16x16x32_bf16 v[168:171], a[8:11], a[76:79], v[168:171]
    ds_read_b64 a[28:29], v65 offset:224
    ds_read_b64 a[30:31], v65 offset:232
    s_waitcnt lgkmcnt(12)
    v_mfma_f32_16x16x32_bf16 v[160:163], a[8:11], a[72:75], v[160:163]
    ds_read_b64 a[32:33], v65 offset:256
    ds_read_b64 a[34:35], v65 offset:264
    s_waitcnt lgkmcnt(12)
    v_mfma_f32_16x16x32_bf16 v[172:175], a[12:15], a[76:79], v[172:175]
    ds_read_b64 a[36:37], v65 offset:288
    ds_read_b64 a[38:39], v65 offset:296
    v_mfma_f32_16x16x32_bf16 v[164:167], a[12:15], a[72:75], v[164:167]
    s_waitcnt lgkmcnt(12)
    v_mfma_f32_16x16x32_bf16 v[168:171], a[16:19], a[72:75], v[168:171]
    s_waitcnt lgkmcnt(10)
    v_mfma_f32_16x16x32_bf16 v[172:175], a[20:23], a[72:75], v[172:175]
    s_waitcnt lgkmcnt(9)
    v_mfma_f32_16x16x32_bf16 v[160:163], a[16:19], a[92:95], v[160:163]
    ds_read_b128 a[76:79], v66 offset:2944
    ds_read_b64 a[40:41], v65 offset:320
    v_mfma_f32_16x16x32_bf16 v[164:167], a[20:23], a[92:95], v[164:167]
    ds_read_b64 a[42:43], v65 offset:328
    ds_read_b128 a[72:75], v66 offset:2880
    s_waitcnt lgkmcnt(11)
    v_mfma_f32_16x16x32_bf16 v[168:171], a[24:27], a[92:95], v[168:171]
    ds_read_b64 a[44:45], v65 offset:352
    ds_read_b64 a[46:47], v65 offset:360
    s_waitcnt lgkmcnt(12)
    v_mfma_f32_16x16x32_bf16 v[160:163], a[24:27], a[88:91], v[160:163]
    ds_read_b64 a[48:49], v65 offset:384
    ds_read_b64 a[50:51], v65 offset:392
    s_waitcnt lgkmcnt(12)
    v_mfma_f32_16x16x32_bf16 v[172:175], a[28:31], a[92:95], v[172:175]
    ds_read_b64 a[52:53], v65 offset:416
    ds_read_b64 a[54:55], v65 offset:424
    v_mfma_f32_16x16x32_bf16 v[164:167], a[28:31], a[88:91], v[164:167]
    s_waitcnt lgkmcnt(12)
    v_mfma_f32_16x16x32_bf16 v[168:171], a[32:35], a[88:91], v[168:171]
    s_waitcnt lgkmcnt(10)
    v_mfma_f32_16x16x32_bf16 v[172:175], a[36:39], a[88:91], v[172:175]
    s_waitcnt lgkmcnt(9)
    v_mfma_f32_16x16x32_bf16 v[160:163], a[32:35], a[76:79], v[160:163]
    ds_read_b128 a[92:95], v66 offset:2784
    ds_read_b64 a[56:57], v65 offset:448
    v_mfma_f32_16x16x32_bf16 v[164:167], a[36:39], a[76:79], v[164:167]
    ds_read_b64 a[58:59], v65 offset:456
    ds_read_b128 a[88:91], v66 offset:2720
    s_waitcnt lgkmcnt(11)
    v_mfma_f32_16x16x32_bf16 v[168:171], a[40:43], a[76:79], v[168:171]
    ds_read_b64 a[60:61], v65 offset:480
    ds_read_b64 a[62:63], v65 offset:488
    s_waitcnt lgkmcnt(12)
    v_mfma_f32_16x16x32_bf16 v[160:163], a[40:43], a[72:75], v[160:163]
    ds_read_b64 a[0:1], v65 offset:512
    ds_read_b64 a[2:3], v65 offset:520
    s_waitcnt lgkmcnt(12)
    v_mfma_f32_16x16x32_bf16 v[172:175], a[44:47], a[76:79], v[172:175]
    ds_read_b64 a[4:5], v65 offset:544
    ds_read_b64 a[6:7], v65 offset:552
    v_mfma_f32_16x16x32_bf16 v[164:167], a[44:47], a[72:75], v[164:167]
    s_waitcnt lgkmcnt(12)
    v_mfma_f32_16x16x32_bf16 v[168:171], a[48:51], a[72:75], v[168:171]
    s_waitcnt lgkmcnt(10)
    v_mfma_f32_16x16x32_bf16 v[172:175], a[52:55], a[72:75], v[172:175]
    s_waitcnt lgkmcnt(9)
    v_mfma_f32_16x16x32_bf16 v[160:163], a[48:51], a[92:95], v[160:163]
    ds_read_b128 a[76:79], v66 offset:2624
    ds_read_b64 a[8:9], v65 offset:576
    v_mfma_f32_16x16x32_bf16 v[164:167], a[52:55], a[92:95], v[164:167]
    ds_read_b64 a[10:11], v65 offset:584
    ds_read_b128 a[72:75], v66 offset:2560
    s_waitcnt lgkmcnt(11)
    v_mfma_f32_16x16x32_bf16 v[168:171], a[56:59], a[92:95], v[168:171]
    ds_read_b64 a[12:13], v65 offset:608
    ds_read_b64 a[14:15], v65 offset:616
    s_waitcnt lgkmcnt(12)
    v_mfma_f32_16x16x32_bf16 v[160:163], a[56:59], a[88:91], v[160:163]
    ds_read_b64 a[16:17], v65 offset:640
    ds_read_b64 a[18:19], v65 offset:648
    s_waitcnt lgkmcnt(12)
    v_mfma_f32_16x16x32_bf16 v[172:175], a[60:63], a[92:95], v[172:175]
    ds_read_b64 a[20:21], v65 offset:672
    ds_read_b64 a[22:23], v65 offset:680
    v_mfma_f32_16x16x32_bf16 v[164:167], a[60:63], a[88:91], v[164:167]
    s_waitcnt lgkmcnt(12)
    v_mfma_f32_16x16x32_bf16 v[168:171], a[0:3], a[88:91], v[168:171]
    s_waitcnt lgkmcnt(10)
    v_mfma_f32_16x16x32_bf16 v[172:175], a[4:7], a[88:91], v[172:175]
    v_add_u32 v65, 512, v65
    v_subrev_u32 v66, 640, v66
    s_mov_b32 s54, 3
L_cBb:
    s_waitcnt lgkmcnt(9)
    v_mfma_f32_16x16x32_bf16 v[160:163], a[0:3], a[76:79], v[160:163]
    ds_read_b128 a[92:95], v66 offset:3104
    ds_read_b64 a[24:25], v65 offset:192
    v_mfma_f32_16x16x32_bf16 v[164:167], a[4:7], a[76:79], v[164:167]
    ds_read_b64 a[26:27], v65 offset:200
    ds_read_b128 a[88:91], v66 offset:3040
    s_waitcnt lgkmcnt(11)
    v_mfma_f32_16x16x32_bf16 v[168:171], a[8:11], a[76:79], v[168:171]
    ds_read_b64 a[28:29], v65 offset:224
    ds_read_b64 a[30:31], v65 offset:232
    s_waitcnt lgkmcnt(12)
    v_mfma_f32_16x16x32_bf16 v[160:163], a[8:11], a[72:75], v[160:163]
    ds_read_b64 a[32:33], v65 offset:256
    ds_read_b64 a[34:35], v65 offset:264
    s_waitcnt lgkmcnt(12)
    v_mfma_f32_16x16x32_bf16 v[172:175], a[12:15], a[76:79], v[172:175]
    ds_read_b64 a[36:37], v65 offset:288
    ds_read_b64 a[38:39], v65 offset:296
    v_mfma_f32_16x16x32_bf16 v[164:167], a[12:15], a[72:75], v[164:167]
    s_waitcnt lgkmcnt(12)
    v_mfma_f32_16x16x32_bf16 v[168:171], a[16:19], a[72:75], v[168:171]
    s_waitcnt lgkmcnt(10)
    v_mfma_f32_16x16x32_bf16 v[172:175], a[20:23], a[72:75], v[172:175]
    s_waitcnt lgkmcnt(9)
    v_mfma_f32_16x16x32_bf16 v[160:163], a[16:19], a[92:95], v[160:163]
    ds_read_b128 a[76:79], v66 offset:2944
    ds_read_b64 a[40:41], v65 offset:320
    v_mfma_f32_16x16x32_bf16 v[164:167], a[20:23], a[92:95], v[164:167]
    ds_read_b64 a[42:43], v65 offset:328
    ds_read_b128 a[72:75], v66 offset:2880
    s_waitcnt lgkmcnt(11)
    v_mfma_f32_16x16x32_bf16 v[168:171], a[24:27], a[92:95], v[168:171]
    ds_read_b64 a[44:45], v65 offset:352
    ds_read_b64 a[46:47], v65 offset:360
    s_waitcnt lgkmcnt(12)
    v_mfma_f32_16x16x32_bf16 v[160:163], a[24:27], a[88:91], v[160:163]
    ds_read_b64 a[48:49], v65 offset:384
    ds_read_b64 a[50:51], v65 offset:392
    s_waitcnt lgkmcnt(12)
    v_mfma_f32_16x16x32_bf16 v[172:175], a[28:31], a[92:95], v[172:175]
    ds_read_b64 a[52:53], v65 offset:416
    ds_read_b64 a[54:55], v65 offset:424
    v_mfma_f32_16x16x32_bf16 v[164:167], a[28:31], a[88:91], v[164:167]
    s_waitcnt lgkmcnt(12)
    v_mfma_f32_16x16x32_bf16 v[168:171], a[32:35], a[88:91], v[168:171]
    s_waitcnt lgkmcnt(10)
    v_mfma_f32_16x16x32_bf16 v[172:175], a[36:39], a[88:91], v[172:175]
    s_waitcnt lgkmcnt(9)
    v_mfma_f32_16x16x32_bf16 v[160:163], a[32:35], a[76:79], v[160:163]
    ds_read_b128 a[92:95], v66 offset:2784
    ds_read_b64 a[56:57], v65 offset:448
    v_mfma_f32_16x16x32_bf16 v[164:167], a[36:39], a[76:79], v[164:167]
    ds_read_b64 a[58:59], v65 offset:456
    ds_read_b128 a[88:91], v66 offset:2720
    s_waitcnt lgkmcnt(11)
    v_mfma_f32_16x16x32_bf16 v[168:171], a[40:43], a[76:79], v[168:171]
    ds_read_b64 a[60:61], v65 offset:480
    ds_read_b64 a[62:63], v65 offset:488
    s_waitcnt lgkmcnt(12)
    v_mfma_f32_16x16x32_bf16 v[160:163], a[40:43], a[72:75], v[160:163]
    ds_read_b64 a[0:1], v65 offset:512
    ds_read_b64 a[2:3], v65 offset:520
    s_waitcnt lgkmcnt(12)
    v_mfma_f32_16x16x32_bf16 v[172:175], a[44:47], a[76:79], v[172:175]
    ds_read_b64 a[4:5], v65 offset:544
    ds_read_b64 a[6:7], v65 offset:552
    v_mfma_f32_16x16x32_bf16 v[164:167], a[44:47], a[72:75], v[164:167]
    s_waitcnt lgkmcnt(12)
    v_mfma_f32_16x16x32_bf16 v[168:171], a[48:51], a[72:75], v[168:171]
    s_waitcnt lgkmcnt(10)
    v_mfma_f32_16x16x32_bf16 v[172:175], a[52:55], a[72:75], v[172:175]
    s_waitcnt lgkmcnt(9)
    v_mfma_f32_16x16x32_bf16 v[160:163], a[48:51], a[92:95], v[160:163]
    ds_read_b128 a[76:79], v66 offset:2624
    ds_read_b64 a[8:9], v65 offset:576
    v_mfma_f32_16x16x32_bf16 v[164:167], a[52:55], a[92:95], v[164:167]
    ds_read_b64 a[10:11], v65 offset:584
    ds_read_b128 a[72:75], v66 offset:2560
    s_waitcnt lgkmcnt(11)
    v_mfma_f32_16x16x32_bf16 v[168:171], a[56:59], a[92:95], v[168:171]
    ds_read_b64 a[12:13], v65 offset:608
    ds_read_b64 a[14:15], v65 offset:616
    s_waitcnt lgkmcnt(12)
    v_mfma_f32_16x16x32_bf16 v[160:163], a[56:59], a[88:91], v[160:163]
    ds_read_b64 a[16:17], v65 offset:640
    ds_read_b64 a[18:19], v65 offset:648
    s_waitcnt lgkmcnt(12)
    v_mfma_f32_16x16x32_bf16 v[172:175], a[60:63], a[92:95], v[172:175]
    ds_read_b64 a[20:21], v65 offset:672
    ds_read_b64 a[22:23], v65 offset:680
    v_mfma_f32_16x16x32_bf16 v[164:167], a[60:63], a[88:91], v[164:167]
    s_waitcnt lgkmcnt(12)
    v_mfma_f32_16x16x32_bf16 v[168:171], a[0:3], a[88:91], v[168:171]
    s_waitcnt lgkmcnt(10)
    v_mfma_f32_16x16x32_bf16 v[172:175], a[4:7], a[88:91], v[172:175]
    v_add_u32 v65, 512, v65
    v_subrev_u32 v66, 640, v66
    s_sub_u32 s54, s54, 1
    s_cmp_lg_u32 s54, 0
    s_cbranch_scc1 L_cBb
    s_waitcnt lgkmcnt(0)
    s_nop 7
    v_cvt_pk_bf16_f32 v144, v144, v145
    v_cvt_pk_bf16_f32 v145, v146, v147
    v_cvt_pk_bf16_f32 v148, v148, v149
    v_cvt_pk_bf16_f32 v149, v150, v151
    v_cvt_pk_bf16_f32 v152, v152, v153
    v_cvt_pk_bf16_f32 v153, v154, v155
    v_cvt_pk_bf16_f32 v156, v156, v157
    v_cvt_pk_bf16_f32 v157, v158, v159
    v_cvt_pk_bf16_f32 v160, v160, v161
    v_cvt_pk_bf16_f32 v161, v162, v163
    v_cvt_pk_bf16_f32 v164, v164, v165
    v_cvt_pk_bf16_f32 v165, v166, v167
    v_cvt_pk_bf16_f32 v168, v168, v169
    v_cvt_pk_bf16_f32 v169, v170, v171
    v_cvt_pk_bf16_f32 v172, v172, v173
    v_cvt_pk_bf16_f32 v173, v174, v175
    v_add_u32 v136, s56, v67
    v_add_u32 v137, s56, v68
    ds_write_b64 v136, v[144:145] offset:0
    ds_write_b64 v136, v[148:149] offset:32
    ds_write_b64 v136, v[152:153] offset:64
    ds_write_b64 v136, v[156:157] offset:96
    ds_write_b64 v136, v[160:161] offset:2304
    ds_write_b64 v136, v[164:165] offset:2336
    ds_write_b64 v136, v[168:169] offset:2368
    ds_write_b64 v136, v[172:173] offset:2400
    ds_read_b128 v[192:195], v137 offset:0
    ds_read_b128 v[196:199], v137 offset:1152
    ds_read_b128 v[200:203], v137 offset:2304
    ds_read_b128 v[204:207], v137 offset:3456
    s_lshl_b32 s55, s87, 12
    s_add_u32 s55, s55, 2621440
    s_waitcnt lgkmcnt(3)
    buffer_store_dwordx4 v[192:195], v69, s[16:19], s55 offen offset:0 sc1
    s_waitcnt lgkmcnt(2)
    buffer_store_dwordx4 v[196:199], v69, s[16:19], s55 offen offset:1024 sc1
    s_waitcnt lgkmcnt(1)
    buffer_store_dwordx4 v[200:203], v69, s[16:19], s55 offen offset:2048 sc1
    s_waitcnt lgkmcnt(0)
    buffer_store_dwordx4 v[204:207], v69, s[16:19], s55 offen offset:3072 sc1
    s_waitcnt vmcnt(0)
    s_barrier
    s_lshl_b32 s57, s20, 7
    s_add_u32 s57, s57, 33587200
    v_mov_b32 v136, s22
    s_mov_b64 exec, 1
    buffer_store_dword v136, off, s[16:19], s57 sc1
    s_mov_b64 exec, -1
    s_or_b32 s57, s20, s21
    s_cmp_lg_u32 s57, 0
    s_cbranch_scc1 Lne_32
    s_mov_b32 s59, 33554432
    v_lshlrev_b32 v140, 7, v1
    s_mov_b32 s82, 0
Lpoll_33:
    buffer_load_dword v136, v140, s[16:19], s59 offen sc1
    s_waitcnt vmcnt(0)
    v_cmp_ne_u32 vcc, s22, v136
    s_add_u32 s82, s82, 1
    s_cmp_ge_u32 s82, 0x200000
    s_cbranch_scc1 Lpolld_34
    s_nop 1
    s_cbranch_vccnz Lpoll_33
Lpolld_34:
    s_mov_b32 s59, 33562624
    v_lshlrev_b32 v140, 7, v1
    s_mov_b32 s82, 0
Lpoll_35:
    buffer_load_dword v136, v140, s[16:19], s59 offen sc1
    s_waitcnt vmcnt(0)
    v_cmp_ne_u32 vcc, s22, v136
    s_add_u32 s82, s82, 1
    s_cmp_ge_u32 s82, 0x200000
    s_cbranch_scc1 Lpolld_36
    s_nop 1
    s_cbranch_vccnz Lpoll_35
Lpolld_36:
    s_mov_b32 s59, 33570816
    v_lshlrev_b32 v140, 7, v1
    s_mov_b32 s82, 0
Lpoll_37:
    buffer_load_dword v136, v140, s[16:19], s59 offen sc1
    s_waitcnt vmcnt(0)
    v_cmp_ne_u32 vcc, s22, v136
    s_add_u32 s82, s82, 1
    s_cmp_ge_u32 s82, 0x200000
    s_cbranch_scc1 Lpolld_38
    s_nop 1
    s_cbranch_vccnz Lpoll_37
Lpolld_38:
    s_mov_b32 s59, 33587200
    s_mov_b32 s82, 0
Lpoll_39:
    buffer_load_dword v136, v140, s[16:19], s59 offen sc1
    s_waitcnt vmcnt(0)
    v_cmp_ne_u32 vcc, s22, v136
    s_add_u32 s82, s82, 1
    s_cmp_ge_u32 s82, 0x200000
    s_cbranch_scc1 Lpolld_40
    s_nop 1
    s_cbranch_vccnz Lpoll_39
Lpolld_40:
    v_mov_b32 v136, s22
    s_mov_b64 exec, 1
    s_mov_b32 s59, 0
    buffer_store_dword v136, off, s[16:19], s59
    s_mov_b64 exec, -1
Lne_32:
    s_waitcnt vmcnt(0)
L_end:
    s_endpgm
L_code_end:

.section .rodata,"a"
.p2align 6
.amdhsa_kernel recurrent_scan__ssm_conv_s4d__dense_activation_silu__prompt_kernel
  .amdhsa_next_free_vgpr 512
  .amdhsa_next_free_sgpr 102
  .amdhsa_accum_offset 256
  .amdhsa_group_segment_fixed_size 0
  .amdhsa_kernarg_size 104
  .amdhsa_user_sgpr_count 2
  .amdhsa_user_sgpr_kernarg_segment_ptr 1
  .amdhsa_system_sgpr_workgroup_id_x 1
.end_amdhsa_kernel
```
